```python
import torch

def _softmax(x, axis=-1):
    return torch.softmax(x, dim=axis)
def _gelu(x):
    return torch.nn.functional.gelu(x, approximate="tanh")
def _silu(x):
    return torch.nn.functional.silu(x)
def _sigmoid(x):
    return torch.sigmoid(x)
def _layernorm(x, axis=-1, eps=1e-5):
    m = x.mean(dim=axis, keepdim=True)
    v = x.var(dim=axis, keepdim=True, unbiased=False)
    return (x - m) / torch.sqrt(v + eps)
def _scatter_add(tgt, idx, src, axis=0):
    return tgt.clone().index_add_(axis, idx, src)
def _segment_sum(src, seg, n):
    out = torch.zeros((n,) + src.shape[1:], dtype=src.dtype)
    return out.index_add_(0, seg, src)
def _pad(x, pw):
    flat = tuple(v for pair in reversed(pw) for v in pair)
    return torch.nn.functional.pad(x, flat)

kernel_name = 'interleave_layers__sliding_local_dilated__glu_gated_geglu__prompt'

def setup_inputs():

    _w = (lambda a: (lambda t: t.to(torch.bfloat16) if t.is_floating_point() else t)(torch.as_tensor(a)))
    def _A_setup():
        B, S, D = 1, 2048, 640
        return {
            "x": _w((lambda *s: torch.randn(*s, dtype=torch.bfloat16) * 0.05)(B, S, D)),
            "wqkv": _w((lambda *s: torch.randn(*s, dtype=torch.bfloat16) * 0.05)(D, 3 * D)),
            "wo": _w((lambda *s: torch.randn(*s, dtype=torch.bfloat16) * 0.05)(D, D)),
        }
    _A_in = _A_setup()

    def _B_setup():
        B, S, Dm, Df = 1, 2048, 640, 1728
        return {
            "x": _w((lambda *s: torch.randn(*s, dtype=torch.bfloat16) * 0.05)(B, S, Dm)),
            "w_gate": _w((lambda *s: torch.randn(*s, dtype=torch.bfloat16) * 0.8)(Dm, Df) * (Dm ** -0.5)),
            "w_up": _w((lambda *s: torch.randn(*s, dtype=torch.bfloat16) * 0.8)(Dm, Df) * (Dm ** -0.5)),
            "w_down": _w((lambda *s: torch.randn(*s, dtype=torch.bfloat16) * 0.8)(Df, Dm) * (Df ** -0.5)),
        }
    _B_in = _B_setup()

    return {
        "A_x": _A_in["x"],
        "A_wqkv": _A_in["wqkv"],
        "A_wo": _A_in["wo"],
        "B_x": _B_in["x"],
        "B_w_gate": _B_in["w_gate"],
        "B_w_up": _B_in["w_up"],
        "B_w_down": _B_in["w_down"],
    }

def reference(A_x, A_wqkv, A_wo, B_x, B_w_gate, B_w_up, B_w_down):
    def _A_ref(x, wqkv, wo):
        B, S, D = x.shape
        H = 32; Dh = D // H
        W, dil = 8, 2
        qkv = (lambda x, *d: x.permute(*d))((x @ wqkv).reshape(B, S, 3, H, Dh), 2, 0, 3, 1, 4)
        q, k, v = qkv[0], qkv[1], qkv[2]
        scale = Dh ** -0.5
        pos = torch.arange(S)
        off = torch.arange(W) * dil
        idx = pos[:, None] - off[None, :]
        mask = idx >= 0
        idx_c = torch.where(mask, idx, 0).reshape(-1)
        kg = k[:, :, idx_c, :].reshape(B, H, S, W, Dh)
        vg = v[:, :, idx_c, :].reshape(B, H, S, W, Dh)
        logits = torch.einsum("bhsd,bhswd->bhsw", q, kg) * scale
        logits = torch.where(mask[None, None, :, :], logits, -1e9)
        attn = _softmax(logits, axis=-1)
        o = torch.einsum("bhsw,bhswd->bhsd", attn, vg)
        return (lambda x, *d: x.permute(*d))(o, 0, 2, 1, 3).reshape(B, S, D) @ wo

    def _B_ref(x, w_gate, w_up, w_down):
        g = torch.einsum("bsd,df->bsf", x, w_gate)
        u = torch.einsum("bsd,df->bsf", x, w_up)
        h = _gelu(g) * u
        return torch.einsum("bsf,fd->bsd", h, w_down)

    x = A_x
    x = x + _A_ref(_layernorm(x, axis=-1), A_wqkv, A_wo)
    x = x + _B_ref(_layernorm(x, axis=-1), B_w_gate, B_w_up, B_w_down)
    x = x + _A_ref(_layernorm(x, axis=-1), A_wqkv, A_wo)
    x = x + _B_ref(_layernorm(x, axis=-1), B_w_gate, B_w_up, B_w_down)
    return x
```

```asm
; @launch grid=(256,1,1) block=(256,1,1) lds=163840
.amdgcn_target "amdgcn-amd-amdhsa--gfx950"
.text
.globl interleave_layers__sliding_local_dilated__glu_gated_geglu__prompt_kernel
.p2align 8
.type interleave_layers__sliding_local_dilated__glu_gated_geglu__prompt_kernel,@function
interleave_layers__sliding_local_dilated__glu_gated_geglu__prompt_kernel:
    s_cmp_ge_u32 s2, 256
    s_cbranch_scc1 L_END
    s_load_dwordx16 s[40:55], s[0:1], 0
    s_load_dwordx4 s[56:59], s[0:1], 64
    s_getpc_b64 s[100:101]
L_PC:
    s_and_b32 s28, s2, 7
    s_lshr_b32 s29, s2, 3
    v_lshrrev_b32 v1, 6, v0
    v_and_b32 v0, 63, v0
    v_readfirstlane_b32 s30, v1
    s_and_b32 s94, s29, 15
    s_mul_i32 s94, s94, 20
    s_add_u32 s94, s94, s28
    s_lshr_b32 s3, s29, 4
    s_lshl_b32 s3, s3, 3
    s_add_u32 s87, s94, s3
    s_add_u32 s88, s94, 16
    s_lshl_b32 s89, s29, 2
    s_add_u32 s89, s89, s28
    s_add_u32 s89, s89, 316
    s_add_u32 s90, s2, 256
    s_cmp_lt_u32 s29, 16
    s_cselect_b32 s89, s89, s90
    s_lshl_b32 s3, s29, 3
    s_or_b32 s3, s3, s28
    s_cmp_lt_u32 s29, 16
    s_cselect_b32 s3, s28, 99
    s_cmp_lt_u32 s3, 4
    s_cselect_b32 s88, s88, s89
    s_lshl_b32 s94, s30, 8
    s_add_u32 s94, s94, s2
    s_cmp_eq_u32 s30, 0
    s_cselect_b32 s94, s87, s94
    s_cmp_eq_u32 s30, 1
    s_cselect_b32 s94, s88, s94
    s_add_u32 s95, s2, 1024
    s_cmp_lg_u32 s30, 2
    s_cselect_b32 s95, 2000, s95
    s_cmp_ge_u32 s95, 1230
    s_cselect_b32 s95, 2000, s95
    s_add_u32 s0, s100, relayout_tab-L_PC
    s_addc_u32 s1, s101, 0
    s_mov_b32 s90, 0
    s_mov_b32 s87, s94
    s_cmp_ge_u32 s94, 320
    s_cselect_b32 s90, 1, s90
    s_sub_u32 s89, s94, 320
    s_cmp_ge_u32 s94, 860
    s_cselect_b32 s90, 2, s90
    s_sub_u32 s89, s94, 860
    s_cmp_ge_u32 s94, 1130
    s_cselect_b32 s90, 3, s90
    s_sub_u32 s89, s94, 1130
    s_cmp_ge_u32 s94, 1230
    s_cselect_b32 s90, 4, s90
    s_sub_u32 s89, s94, 1230
    s_sub_u32 s89, s94, 320
    s_cmp_ge_u32 s94, 320
    s_cselect_b32 s87, s89, s87
    s_sub_u32 s89, s94, 860
    s_cmp_ge_u32 s94, 860
    s_cselect_b32 s87, s89, s87
    s_sub_u32 s89, s94, 1130
    s_cmp_ge_u32 s94, 1130
    s_cselect_b32 s87, s89, s87
    s_sub_u32 s89, s94, 1230
    s_cmp_ge_u32 s94, 1230
    s_cselect_b32 s87, s89, s87
    s_cmp_lt_u32 s90, 2
    s_cselect_b32 s88, 3277, 0
    s_cselect_b32 s89, 20, 5
    s_cmp_ge_u32 s90, 2
    s_cselect_b32 s88, 13108, s88
    s_mul_i32 s88, s88, s87
    s_lshr_b32 s88, s88, 16
    s_mul_i32 s89, s89, s88
    s_sub_u32 s89, s87, s89
    s_min_u32 s91, s90, 3
    s_cmp_eq_u32 s90, 3
    s_cselect_b32 s92, s88, 0
    s_cmp_ge_u32 s92, 16
    s_cselect_b32 s91, 4, s91
    s_lshl_b32 s91, s91, 6
    s_add_u32 s92, s89, 2
    s_cmp_eq_u32 s90, 3
    s_cselect_b32 s93, 5, 0
    s_add_u32 s92, s92, s93
    s_cmp_lt_u32 s90, 2
    s_cselect_b32 s92, s90, s92
    s_min_u32 s92, s92, 11
    s_lshl_b32 s92, s92, 5
    s_add_u32 s92, s92, 320
    s_load_dwordx16 s[60:75], s[0:1], s91
    s_load_dwordx8 s[76:83], s[0:1], s92
    v_lshlrev_b32 v1, 4, v0
    s_lshl_b32 s3, s29, 2
    s_add_u32 s3, s3, s30
    s_and_b32 s3, s3, 15
    s_lshl_b32 s3, s3, 12
    v_lshlrev_b32 v24, 7, v0
    v_add_u32 v24, s3, v24
    s_mov_b32 exec_lo, 0xffffffff
    s_mov_b32 exec_hi, 0x0
    global_load_dword v255, v24, s[100:101]
    s_mov_b64 exec, -1
    s_lshr_b32 s100, s30, 1
    s_and_b32 s101, s30, 1
    s_lshl_b32 s101, s101, 1
    s_add_u32 s101, s101, s100
    s_mov_b32 s101, s30
    s_lshr_b32 s31, s29, 4
    s_and_b32 s32, s29, 15
    s_lshr_b32 s33, s29, 3
    s_and_b32 s34, s29, 7
    v_add_u32 v22, 0x10000, v1
    v_add_u32 v23, 0x20000, v1
    s_mul_i32 s37, s28, 6955008
    s_add_u32 s37, s37, 10354688
    s_getreg_b32 s38, hwreg(HW_REG_XCC_ID)
    s_and_b32 s38, s38, 15
    s_mov_b32 s35, 0
    s_mov_b32 s36, 0
    s_mov_b32 s39, 0
    s_waitcnt lgkmcnt(0)
    s_mov_b32 s4, s58
    s_and_b32 s5, s59, 0xffff
    s_mov_b32 s6, 0x3ef4000
    s_mov_b32 s7, 0x20000
    s_mov_b32 s8, s40
    s_and_b32 s9, s41, 0xffff
    s_mov_b32 s10, 0x280000
    s_mov_b32 s11, 0x20000
    s_mov_b32 s12, s54
    s_and_b32 s13, s55, 0xffff
    s_mov_b32 s14, 0x280000
    s_mov_b32 s15, 0x20000
    s_mov_b32 s16, s56
    s_and_b32 s17, s57, 0xffff
    s_mov_b32 s18, 0x100
    s_mov_b32 s19, 0x20000
    s_mov_b32 s46, s52
    s_mov_b32 s47, s53
    s_or_b32 s3, s2, s30
    s_cmp_lg_u32 s3, 0
    s_cbranch_scc1 NW_1
    s_memrealtime s[84:85]
    s_waitcnt lgkmcnt(0)
    s_and_b32 s84, s84, 0xffffff00
    s_max_u32 s84, s84, 0x100
    v_mov_b32 v24, s84
    v_mov_b32 v25, 0
    s_mov_b32 exec_lo, 0x1
    s_mov_b32 exec_hi, 0x0
    buffer_store_dword v24, v25, s[16:19], 0 offen sc1
    s_mov_b64 exec, -1
NW_1:
    s_mov_b32 s20, s42
    s_cmp_eq_u32 s90, 1
    s_cselect_b32 s20, s48, s20
    s_cmp_eq_u32 s90, 2
    s_cselect_b32 s20, s46, s20
    s_cmp_eq_u32 s90, 3
    s_cselect_b32 s20, s44, s20
    s_mov_b32 s21, s43
    s_cmp_eq_u32 s90, 1
    s_cselect_b32 s21, s49, s21
    s_cmp_eq_u32 s90, 2
    s_cselect_b32 s21, s47, s21
    s_cmp_eq_u32 s90, 3
    s_cselect_b32 s21, s45, s21
    s_and_b32 s21, s21, 0xffff
    s_mov_b32 s22, s75
    s_mov_b32 s23, 0x20000
    s_mov_b32 s24, s42
    s_cmp_eq_u32 s90, 1
    s_cselect_b32 s24, s50, s24
    s_cmp_eq_u32 s90, 2
    s_cselect_b32 s24, s46, s24
    s_cmp_eq_u32 s90, 3
    s_cselect_b32 s24, s44, s24
    s_mov_b32 s25, s43
    s_cmp_eq_u32 s90, 1
    s_cselect_b32 s25, s51, s25
    s_cmp_eq_u32 s90, 2
    s_cselect_b32 s25, s47, s25
    s_cmp_eq_u32 s90, 3
    s_cselect_b32 s25, s45, s25
    s_and_b32 s25, s25, 0xffff
    s_mov_b32 s26, s75
    s_mov_b32 s27, 0x20000
    s_cmp_lt_u32 s90, 2
    s_cselect_b32 s91, s89, s88
    s_sub_u32 s92, s88, 16
    s_cmp_eq_u32 s74, 204800
    s_cselect_b32 s91, s92, s91
    s_mul_i32 s91, s91, s74
    s_add_u32 s60, s60, s91
    s_add_u32 s61, s61, s91
    s_add_u32 s62, s62, s91
    s_add_u32 s63, s63, s91
    s_add_u32 s64, s64, s91
    s_add_u32 s65, s65, s91
    s_add_u32 s66, s66, s91
    s_add_u32 s67, s67, s91
    s_cmp_lt_u32 s90, 2
    s_cselect_b32 s91, s88, s89
    s_mul_i32 s73, s73, s91
    s_mul_i32 s91, s88, 163840
    s_lshl_b32 s92, s89, 10
    s_add_u32 s91, s91, s92
    s_add_u32 s92, s91, s92
    s_add_u32 s92, s92, 3440640
    s_cmp_eq_u32 s90, 1
    s_cselect_b32 s91, s92, s91
    s_mul_i32 s92, s88, 5120
    s_add_u32 s74, s92, 7864320
    s_cmp_eq_u32 s90, 2
    s_cselect_b32 s91, s74, s91
    s_add_u32 s74, s92, 2621440
    s_cmp_eq_u32 s90, 3
    s_cselect_b32 s91, s74, s91
    s_cmp_eq_u32 s90, 4
    s_cselect_b32 s91, 0x40000000, s91
    s_cselect_b32 s72, 0, s72
    s_add_u32 s76, s76, s91
    s_add_u32 s77, s77, s91
    s_add_u32 s78, s78, s91
    s_add_u32 s79, s79, s91
    s_add_u32 s80, s80, s91
    s_add_u32 s81, s81, s91
    s_add_u32 s82, s82, s91
    s_add_u32 s83, s83, s91
    s_mul_i32 s91, s88, 10240
    s_lshl_b32 s92, s89, 7
    s_add_u32 s91, s91, s92
    s_add_u32 s91, s91, 10076160
    s_cmp_eq_u32 s90, 1
    s_cselect_b32 s96, s91, 0x40000000
    s_lshl_b32 s91, s88, 7
    s_lshl_b32 s92, s89, 2
    s_add_u32 s91, s91, s92
    s_add_u32 s91, s91, 65994752
    s_cmp_eq_u32 s90, 0
    s_cselect_b32 s98, s91, 0x40000000
    v_lshrrev_b32 v24, 4, v0
    v_and_b32 v25, 15, v0
    v_lshlrev_b32 v26, 1, v24
    v_xor_b32 v25, v25, v26
    v_mul_lo_u32 v24, v24, s68
    v_xor_b32 v27, 0, v25
    v_mul_lo_u32 v28, v27, s69
    v_lshrrev_b32 v28, 8, v28
    v_mul_lo_u32 v34, v28, s70
    v_sub_u32 v34, v27, v34
    v_lshlrev_b32 v34, 4, v34
    v_mul_lo_u32 v28, v28, s71
    v_add_u32 v34, v34, v28
    v_add_u32 v34, v34, v24
    v_add_u32 v34, s73, v34
    v_cmp_le_u32 vcc, s72, v27
    v_mov_b32 v28, 0x40000000
    s_nop 0
    v_cndmask_b32 v34, v34, v28, vcc
    v_xor_b32 v27, 8, v25
    v_mul_lo_u32 v28, v27, s69
    v_lshrrev_b32 v28, 8, v28
    v_mul_lo_u32 v35, v28, s70
    v_sub_u32 v35, v27, v35
    v_lshlrev_b32 v35, 4, v35
    v_mul_lo_u32 v28, v28, s71
    v_add_u32 v35, v35, v28
    v_add_u32 v35, v35, v24
    v_add_u32 v35, s73, v35
    v_cmp_le_u32 vcc, s72, v27
    v_mov_b32 v28, 0x40000000
    s_nop 0
    v_cndmask_b32 v35, v35, v28, vcc
    s_cmp_lg_u32 s98, 0x40000000
    s_cbranch_scc0 SN_2
    s_lshl_b32 s3, s30, 13
    s_add_u32 s3, s3, 0
    s_add_u32 m0, s3, 0
    s_nop 0
    buffer_load_dwordx4 v34, s[20:23], s60 offen lds
    s_add_u32 m0, s3, 1024
    s_nop 0
    buffer_load_dwordx4 v34, s[20:23], s61 offen lds
    s_add_u32 m0, s3, 2048
    s_nop 0
    buffer_load_dwordx4 v35, s[24:27], s62 offen lds
    s_add_u32 m0, s3, 3072
    s_nop 0
    buffer_load_dwordx4 v35, s[24:27], s63 offen lds
    s_add_u32 m0, s3, 4096
    s_nop 0
    buffer_load_dwordx4 v34, s[20:23], s64 offen lds
    s_add_u32 m0, s3, 5120
    s_nop 0
    buffer_load_dwordx4 v34, s[20:23], s65 offen lds
    s_add_u32 m0, s3, 6144
    s_nop 0
    buffer_load_dwordx4 v35, s[24:27], s66 offen lds
    s_add_u32 m0, s3, 7168
    s_nop 0
    buffer_load_dwordx4 v35, s[24:27], s67 offen lds
    v_mov_b32 v25, 0
    buffer_load_dword v112, v25, s[16:19], 0 offen sc1
    v_lshrrev_b32 v24, 4, v0
    s_lshl_b32 s91, s30, 3
    s_add_u32 s91, s91, 0
    v_add_u32 v24, s91, v24
    v_mul_u32_u24 v25, 26, v24
    v_lshrrev_b32 v25, 8, v25
    v_mul_u32_u24 v26, 10, v25
    v_sub_u32 v26, v24, v26
    v_cmp_le_u32 vcc, 5, v26
    s_nop 1
    v_cndmask_b32 v27, 0, 1, vcc
    v_lshlrev_b32 v28, 3, v26
    v_lshlrev_b32 v27, 3, v27
    v_add_u32 v27, v27, v28
    v_add_u32 v29, 112, v27
    v_add_u32 v28, 208, v28
    v_cmp_eq_u32 vcc, 1, v25
    s_nop 1
    v_cndmask_b32 v27, v27, v29, vcc
    v_cmp_eq_u32 vcc, 2, v25
    s_nop 1
    v_cndmask_b32 v27, v27, v28, vcc
    v_mov_b32 v28, 40
    v_cmp_eq_u32 vcc, 30, v24
    s_nop 1
    v_cndmask_b32 v27, v27, v28, vcc
    v_mov_b32 v28, 88
    v_cmp_eq_u32 vcc, 31, v24
    s_nop 1
    v_cndmask_b32 v27, v27, v28, vcc
    v_and_b32 v28, 15, v0
    v_mul_u32_u24 v28, 296, v28
    v_add_u32 v27, v27, v28
    v_add_u32 v20, 65536, v27
    v_lshrrev_b32 v24, 4, v0
    s_lshl_b32 s91, s30, 3
    s_add_u32 s91, s91, 4
    v_add_u32 v24, s91, v24
    v_mul_u32_u24 v25, 26, v24
    v_lshrrev_b32 v25, 8, v25
    v_mul_u32_u24 v26, 10, v25
    v_sub_u32 v26, v24, v26
    v_cmp_le_u32 vcc, 5, v26
    s_nop 1
    v_cndmask_b32 v27, 0, 1, vcc
    v_lshlrev_b32 v28, 3, v26
    v_lshlrev_b32 v27, 3, v27
    v_add_u32 v27, v27, v28
    v_add_u32 v29, 112, v27
    v_add_u32 v28, 208, v28
    v_cmp_eq_u32 vcc, 1, v25
    s_nop 1
    v_cndmask_b32 v27, v27, v29, vcc
    v_cmp_eq_u32 vcc, 2, v25
    s_nop 1
    v_cndmask_b32 v27, v27, v28, vcc
    v_mov_b32 v28, 40
    v_cmp_eq_u32 vcc, 30, v24
    s_nop 1
    v_cndmask_b32 v27, v27, v28, vcc
    v_mov_b32 v28, 88
    v_cmp_eq_u32 vcc, 31, v24
    s_nop 1
    v_cndmask_b32 v27, v27, v28, vcc
    v_and_b32 v28, 15, v0
    v_mul_u32_u24 v28, 296, v28
    v_add_u32 v27, v27, v28
    v_add_u32 v21, 65536, v27
    v_and_b32 v60, 15, v0
    v_lshrrev_b32 v61, 4, v0
    v_mul_u32_u24 v62, 296, v60
    v_add_u32 v62, 65536, v62
    v_lshlrev_b32 v63, 4, v61
    v_add_u32 v42, v62, v63
    v_cmp_eq_u32 vcc, 3, v61
    v_add_u32 v40, 96, v62
    s_nop 0
    v_cndmask_b32 v40, v42, v40, vcc
    v_add_u32 v41, 48, v42
    v_add_u32 v63, 96, v62
    v_cndmask_b32 v41, v41, v63, vcc
    v_bfe_u32 v62, v0, 2, 2
    v_lshlrev_b32 v63, 2, v61
    v_add_u32 v62, v62, v63
    v_mul_u32_u24 v62, 296, v62
    v_and_b32 v63, 3, v0
    v_lshlrev_b32 v63, 3, v63
    v_add_u32 v62, v62, v63
    v_add_u32 v43, 65536, v62
    v_lshlrev_b32 v61, 2, v61
    v_sub_u32 v60, v60, v61
    v_mov_b32 v63, 0xf149f2ca
    v_add_u32 v61, 16, v60
    v_and_b32 v62, 0xfffffff1, v61
    v_cmp_eq_u32 vcc, 0, v62
    s_nop 1
    v_cndmask_b32 v44, v63, 0, vcc
    v_add_u32 v61, 15, v60
    v_and_b32 v62, 0xfffffff1, v61
    v_cmp_eq_u32 vcc, 0, v62
    s_nop 1
    v_cndmask_b32 v45, v63, 0, vcc
    v_add_u32 v61, 14, v60
    v_and_b32 v62, 0xfffffff1, v61
    v_cmp_eq_u32 vcc, 0, v62
    s_nop 1
    v_cndmask_b32 v46, v63, 0, vcc
    v_add_u32 v61, 13, v60
    v_and_b32 v62, 0xfffffff1, v61
    v_cmp_eq_u32 vcc, 0, v62
    s_nop 1
    v_cndmask_b32 v47, v63, 0, vcc
    v_add_u32 v61, 0, v60
    v_and_b32 v62, 0xfffffff1, v61
    v_cmp_eq_u32 vcc, 0, v62
    s_nop 1
    v_cndmask_b32 v48, v63, 0, vcc
    v_add_u32 v61, -1, v60
    v_and_b32 v62, 0xfffffff1, v61
    v_cmp_eq_u32 vcc, 0, v62
    s_nop 1
    v_cndmask_b32 v49, v63, 0, vcc
    v_add_u32 v61, -2, v60
    v_and_b32 v62, 0xfffffff1, v61
    v_cmp_eq_u32 vcc, 0, v62
    s_nop 1
    v_cndmask_b32 v50, v63, 0, vcc
    v_add_u32 v61, -3, v60
    v_and_b32 v62, 0xfffffff1, v61
    v_cmp_eq_u32 vcc, 0, v62
    s_nop 1
    v_cndmask_b32 v51, v63, 0, vcc
    v_add_u32 v60, 153600, v1
    ds_write_b128 v60, v[40:43] offset:0
    ds_write_b128 v60, v[44:47] offset:1024
    ds_write_b128 v60, v[48:51] offset:2048
    s_waitcnt vmcnt(0)
    s_barrier
    v_readfirstlane_b32 s86, v112
    s_nop 1
    s_cmp_lg_u32 s86, 0
    s_cbranch_scc1 NO_7
    s_mov_b32 s87, 0
    v_mov_b32 v25, 0
NP_6:
    buffer_load_dword v112, v25, s[16:19], 0 offen sc1
    s_add_u32 s87, s87, 1
    s_cmp_gt_u32 s87, 200000
    s_cbranch_scc1 L_END
    s_waitcnt vmcnt(0)
    v_readfirstlane_b32 s86, v112
    s_nop 1
    s_cmp_eq_u32 s86, 0
    s_cbranch_scc1 NP_6
NO_7:
    v_lshrrev_b32 v24, 4, v0
    v_bfe_u32 v25, v0, 2, 2
    v_and_b32 v26, 3, v0
    v_lshlrev_b32 v27, 3, v24
    v_add_u32 v27, v27, v25
    v_lshlrev_b32 v27, 8, v27
    v_lshlrev_b32 v26, 3, v26
    v_add_u32 v27, v27, v26
    v_and_b32 v24, 1, v24
    v_lshlrev_b32 v24, 2, v24
    v_add_u32 v24, v24, v25
    v_lshlrev_b32 v24, 5, v24
    v_xor_b32 v27, v27, v24
    s_lshl_b32 s3, s30, 13
    s_add_u32 s3, s3, 0
    v_add_u32 v27, s3, v27
    v_xor_b32 v28, 0, v27
    ds_read_b64_tr_b16 v[40:41], v28
    ds_read_b64_tr_b16 v[42:43], v28 offset:1024
    v_xor_b32 v29, 32, v27
    ds_read_b64_tr_b16 v[44:45], v29
    ds_read_b64_tr_b16 v[46:47], v29 offset:1024
    v_xor_b32 v28, 64, v27
    ds_read_b64_tr_b16 v[48:49], v28
    ds_read_b64_tr_b16 v[50:51], v28 offset:1024
    v_xor_b32 v29, 96, v27
    ds_read_b64_tr_b16 v[52:53], v29
    ds_read_b64_tr_b16 v[54:55], v29 offset:1024
    v_xor_b32 v28, 128, v27
    ds_read_b64_tr_b16 v[56:57], v28
    ds_read_b64_tr_b16 v[58:59], v28 offset:1024
    v_xor_b32 v29, 160, v27
    ds_read_b64_tr_b16 v[60:61], v29
    ds_read_b64_tr_b16 v[62:63], v29 offset:1024
    v_xor_b32 v28, 192, v27
    ds_read_b64_tr_b16 v[64:65], v28
    ds_read_b64_tr_b16 v[66:67], v28 offset:1024
    v_xor_b32 v29, 224, v27
    ds_read_b64_tr_b16 v[68:69], v29
    ds_read_b64_tr_b16 v[70:71], v29 offset:1024
    s_waitcnt lgkmcnt(14)
    buffer_store_dwordx4 v[40:43], v1, s[4:7], s76 offen sc1
    s_waitcnt lgkmcnt(12)
    buffer_store_dwordx4 v[44:47], v1, s[4:7], s77 offen sc1
    s_waitcnt lgkmcnt(10)
    buffer_store_dwordx4 v[48:51], v1, s[4:7], s78 offen sc1
    s_waitcnt lgkmcnt(8)
    buffer_store_dwordx4 v[52:55], v1, s[4:7], s79 offen sc1
    s_waitcnt lgkmcnt(6)
    buffer_store_dwordx4 v[56:59], v1, s[4:7], s80 offen sc1
    s_waitcnt lgkmcnt(4)
    buffer_store_dwordx4 v[60:63], v1, s[4:7], s81 offen sc1
    s_waitcnt lgkmcnt(2)
    buffer_store_dwordx4 v[64:67], v1, s[4:7], s82 offen sc1
    s_waitcnt lgkmcnt(0)
    buffer_store_dwordx4 v[68:71], v1, s[4:7], s83 offen sc1
    s_cmp_eq_u32 s96, 0x40000000
    s_cbranch_scc1 NC_8
    v_mov_b32 v24, 0x3f803f80
    v_and_b32 v25, 31, v0
    v_lshlrev_b32 v25, 2, v25
    v_mov_b32 v26, 0
    v_mov_b32 v27, 0
    v_mov_b32 v28, 0
    v_mov_b32 v29, 0
    v_dot2_f32_bf16 v26, v40, v24, v26
    v_dot2_f32_bf16 v27, v44, v24, v27
    v_dot2_f32_bf16 v28, v48, v24, v28
    v_dot2_f32_bf16 v29, v52, v24, v29
    v_dot2_f32_bf16 v26, v41, v24, v26
    v_dot2_f32_bf16 v27, v45, v24, v27
    v_dot2_f32_bf16 v28, v49, v24, v28
    v_dot2_f32_bf16 v29, v53, v24, v29
    v_dot2_f32_bf16 v26, v42, v24, v26
    v_dot2_f32_bf16 v27, v46, v24, v27
    v_dot2_f32_bf16 v28, v50, v24, v28
    v_dot2_f32_bf16 v29, v54, v24, v29
    v_dot2_f32_bf16 v26, v43, v24, v26
    v_dot2_f32_bf16 v27, v47, v24, v27
    v_dot2_f32_bf16 v28, v51, v24, v28
    v_dot2_f32_bf16 v29, v55, v24, v29
    v_dot2_f32_bf16 v26, v56, v24, v26
    v_dot2_f32_bf16 v27, v60, v24, v27
    v_dot2_f32_bf16 v28, v64, v24, v28
    v_dot2_f32_bf16 v29, v68, v24, v29
    v_dot2_f32_bf16 v26, v57, v24, v26
    v_dot2_f32_bf16 v27, v61, v24, v27
    v_dot2_f32_bf16 v28, v65, v24, v28
    v_dot2_f32_bf16 v29, v69, v24, v29
    v_dot2_f32_bf16 v26, v58, v24, v26
    v_dot2_f32_bf16 v27, v62, v24, v27
    v_dot2_f32_bf16 v28, v66, v24, v28
    v_dot2_f32_bf16 v29, v70, v24, v29
    v_dot2_f32_bf16 v26, v59, v24, v26
    v_dot2_f32_bf16 v27, v63, v24, v27
    v_dot2_f32_bf16 v28, v67, v24, v28
    v_dot2_f32_bf16 v29, v71, v24, v29
    v_mov_b32 v30, v26
    v_mov_b32 v31, v27
    v_mov_b32 v32, v28
    v_mov_b32 v33, v29
    v_permlane32_swap_b32 v26, v30
    v_permlane32_swap_b32 v27, v31
    v_permlane32_swap_b32 v28, v32
    v_permlane32_swap_b32 v29, v33
    v_add_f32 v26, v26, v30
    v_add_f32 v27, v27, v31
    v_add_f32 v28, v28, v32
    v_add_f32 v29, v29, v33
    s_mov_b32 exec_lo, 0xffffffff
    s_mov_b32 exec_hi, 0x0
    buffer_store_dword v26, v25, s[4:7], s96 offen offset:0 sc1
    buffer_store_dword v27, v25, s[4:7], s96 offen offset:2560 sc1
    s_add_u32 s3, s96, 5120
    buffer_store_dword v28, v25, s[4:7], s3 offen sc1
    s_add_u32 s3, s96, 7680
    buffer_store_dword v29, v25, s[4:7], s3 offen sc1
    s_mov_b64 exec, -1
NC_8:
    s_waitcnt vmcnt(0)
    s_add_u32 s3, s86, 1
    v_mov_b32 v24, s3
    v_mov_b32 v25, 0
    s_mov_b32 exec_lo, 0x1
    s_mov_b32 exec_hi, 0x0
    buffer_store_dword v24, v25, s[4:7], s98 offen sc1
    s_mov_b64 exec, -1
    v_and_b32 v32, 15, v0
    v_lshrrev_b32 v33, 4, v0
    v_mul_u32_u24 v32, 1280, v32
    v_lshlrev_b32 v33, 3, v33
    v_add_u32 v32, v32, v33
    s_lshl_b32 s91, s28, 8
    s_lshl_b32 s3, s33, 6
    s_add_u32 s91, s91, s3
    s_lshl_b32 s3, s101, 4
    s_add_u32 s91, s91, s3
    s_mul_i32 s91, s91, 1280
    s_mul_i32 s3, s34, 160
    s_add_u32 s91, s91, s3
    buffer_load_dwordx2 v[2:3], v32, s[8:11], s91 offen offset:0
    buffer_load_dwordx2 v[4:5], v32, s[8:11], s91 offen offset:32
    buffer_load_dwordx2 v[6:7], v32, s[8:11], s91 offen offset:64
    buffer_load_dwordx2 v[8:9], v32, s[8:11], s91 offen offset:96
    buffer_load_dwordx2 v[10:11], v32, s[8:11], s91 offen offset:128
    v_and_b32 v24, 15, v0
    v_lshrrev_b32 v25, 4, v0
    v_mul_u32_u24 v172, 1280, v24
    v_lshlrev_b32 v25, 4, v25
    v_add_u32 v172, v172, v25
    v_lshrrev_b32 v24, 3, v0
    v_and_b32 v25, 7, v0
    v_xor_b32 v25, v25, v24
    v_lshlrev_b32 v25, 4, v25
    v_mul_u32_u24 v173, 1280, v24
    v_add_u32 v173, v173, v25
    v_and_b32 v24, 15, v0
    v_lshrrev_b32 v25, 4, v0
    v_and_b32 v26, 7, v24
    v_xor_b32 v25, v25, v26
    v_lshlrev_b32 v25, 4, v25
    v_lshlrev_b32 v24, 7, v24
    v_add_u32 v24, v24, v25
    v_add_u32 v221, 65536, v24
    v_xor_b32 v222, 64, v221
    s_lshl_b32 s84, s28, 8
    s_lshl_b32 s3, s31, 7
    s_add_u32 s84, s84, s3
    s_lshl_b32 s3, s30, 5
    s_add_u32 s84, s84, s3
    s_mul_i32 s84, s84, 1280
    s_lshl_b32 s85, s30, 12
    s_add_u32 s85, s85, 65536
    s_add_u32 s3, s84, 0
    s_add_u32 m0, s85, 0
    s_nop 0
    buffer_load_dwordx4 v173, s[8:11], s3 offen lds
    s_add_u32 s3, s84, 10240
    s_add_u32 m0, s85, 1024
    s_nop 0
    buffer_load_dwordx4 v173, s[8:11], s3 offen lds
    s_add_u32 s3, s84, 20480
    s_add_u32 m0, s85, 2048
    s_nop 0
    buffer_load_dwordx4 v173, s[8:11], s3 offen lds
    s_add_u32 s3, s84, 30720
    s_add_u32 m0, s85, 3072
    s_nop 0
    buffer_load_dwordx4 v173, s[8:11], s3 offen lds
    s_add_u32 s3, s84, 128
    s_add_u32 m0, s85, 16384
    s_nop 0
    buffer_load_dwordx4 v173, s[8:11], s3 offen lds
    s_add_u32 s3, s84, 10368
    s_add_u32 m0, s85, 17408
    s_nop 0
    buffer_load_dwordx4 v173, s[8:11], s3 offen lds
    s_add_u32 s3, s84, 20608
    s_add_u32 m0, s85, 18432
    s_nop 0
    buffer_load_dwordx4 v173, s[8:11], s3 offen lds
    s_add_u32 s3, s84, 30848
    s_add_u32 m0, s85, 19456
    s_nop 0
    buffer_load_dwordx4 v173, s[8:11], s3 offen lds
    s_add_u32 s3, s84, 256
    s_add_u32 m0, s85, 32768
    s_nop 0
    buffer_load_dwordx4 v173, s[8:11], s3 offen lds
    s_add_u32 s3, s84, 10496
    s_add_u32 m0, s85, 33792
    s_nop 0
    buffer_load_dwordx4 v173, s[8:11], s3 offen lds
    s_add_u32 s3, s84, 20736
    s_add_u32 m0, s85, 34816
    s_nop 0
    buffer_load_dwordx4 v173, s[8:11], s3 offen lds
    s_add_u32 s3, s84, 30976
    s_add_u32 m0, s85, 35840
    s_nop 0
    buffer_load_dwordx4 v173, s[8:11], s3 offen lds
    s_waitcnt vmcnt(12)
    v_mov_b32 v34, 0x3f803f80
    v_mov_b32 v32, 0
    v_mov_b32 v33, 0
    v_mov_b32 v37, 0
    v_mov_b32 v38, 0
    v_dot2_f32_bf16 v32, v2, v34, v32
    v_dot2_f32_bf16 v33, v2, v2, v33
    v_dot2_f32_bf16 v37, v3, v34, v37
    v_dot2_f32_bf16 v38, v3, v3, v38
    v_dot2_f32_bf16 v32, v4, v34, v32
    v_dot2_f32_bf16 v33, v4, v4, v33
    v_dot2_f32_bf16 v37, v5, v34, v37
    v_dot2_f32_bf16 v38, v5, v5, v38
    v_dot2_f32_bf16 v32, v6, v34, v32
    v_dot2_f32_bf16 v33, v6, v6, v33
    v_dot2_f32_bf16 v37, v7, v34, v37
    v_dot2_f32_bf16 v38, v7, v7, v38
    v_dot2_f32_bf16 v32, v8, v34, v32
    v_dot2_f32_bf16 v33, v8, v8, v33
    v_dot2_f32_bf16 v37, v9, v34, v37
    v_dot2_f32_bf16 v38, v9, v9, v38
    v_dot2_f32_bf16 v32, v10, v34, v32
    v_dot2_f32_bf16 v33, v10, v10, v33
    v_dot2_f32_bf16 v37, v11, v34, v37
    v_dot2_f32_bf16 v38, v11, v11, v38
    s_nop 1
    v_add_f32 v32, v32, v37
    v_add_f32 v33, v33, v38
    v_mov_b32 v35, v32
    v_mov_b32 v36, v33
    s_nop 0
    v_permlane32_swap_b32 v32, v35
    v_permlane32_swap_b32 v33, v36
    v_add_f32 v32, v32, v35
    v_add_f32 v33, v33, v36
    v_mov_b32 v35, v32
    v_mov_b32 v36, v33
    s_nop 0
    v_permlane16_swap_b32 v32, v35
    v_permlane16_swap_b32 v33, v36
    v_add_f32 v32, v32, v35
    v_add_f32 v33, v33, v36
    v_and_b32 v30, 15, v0
    v_lshlrev_b32 v30, 3, v30
    s_lshl_b32 s91, s34, 11
    s_lshl_b32 s3, s33, 2
    s_add_u32 s3, s3, s101
    s_lshl_b32 s3, s3, 7
    s_add_u32 s91, s91, s3
    s_add_u32 s91, s91, s37
    s_add_u32 s91, s91, 6914048
    s_mov_b32 exec_lo, 0xffff
    s_mov_b32 exec_hi, 0x0
    buffer_store_dwordx2 v[32:33], v30, s[4:7], s91 offen sc1
    s_mov_b64 exec, -1
    s_branch SJ_3
SN_2:
    v_and_b32 v32, 15, v0
    v_lshrrev_b32 v33, 4, v0
    v_mul_u32_u24 v32, 1280, v32
    v_lshlrev_b32 v33, 3, v33
    v_add_u32 v32, v32, v33
    s_lshl_b32 s91, s28, 8
    s_lshl_b32 s3, s33, 6
    s_add_u32 s91, s91, s3
    s_lshl_b32 s3, s101, 4
    s_add_u32 s91, s91, s3
    s_mul_i32 s91, s91, 1280
    s_mul_i32 s3, s34, 160
    s_add_u32 s91, s91, s3
    buffer_load_dwordx2 v[2:3], v32, s[8:11], s91 offen offset:0
    buffer_load_dwordx2 v[4:5], v32, s[8:11], s91 offen offset:32
    buffer_load_dwordx2 v[6:7], v32, s[8:11], s91 offen offset:64
    buffer_load_dwordx2 v[8:9], v32, s[8:11], s91 offen offset:96
    buffer_load_dwordx2 v[10:11], v32, s[8:11], s91 offen offset:128
    v_and_b32 v24, 15, v0
    v_lshrrev_b32 v25, 4, v0
    v_mul_u32_u24 v172, 1280, v24
    v_lshlrev_b32 v25, 4, v25
    v_add_u32 v172, v172, v25
    v_lshrrev_b32 v24, 3, v0
    v_and_b32 v25, 7, v0
    v_xor_b32 v25, v25, v24
    v_lshlrev_b32 v25, 4, v25
    v_mul_u32_u24 v173, 1280, v24
    v_add_u32 v173, v173, v25
    v_and_b32 v24, 15, v0
    v_lshrrev_b32 v25, 4, v0
    v_and_b32 v26, 7, v24
    v_xor_b32 v25, v25, v26
    v_lshlrev_b32 v25, 4, v25
    v_lshlrev_b32 v24, 7, v24
    v_add_u32 v24, v24, v25
    v_add_u32 v221, 65536, v24
    v_xor_b32 v222, 64, v221
    s_lshl_b32 s84, s28, 8
    s_lshl_b32 s3, s31, 7
    s_add_u32 s84, s84, s3
    s_lshl_b32 s3, s30, 5
    s_add_u32 s84, s84, s3
    s_mul_i32 s84, s84, 1280
    s_lshl_b32 s85, s30, 12
    s_add_u32 s85, s85, 65536
    s_add_u32 s3, s84, 0
    s_add_u32 m0, s85, 0
    s_nop 0
    buffer_load_dwordx4 v173, s[8:11], s3 offen lds
    s_add_u32 s3, s84, 10240
    s_add_u32 m0, s85, 1024
    s_nop 0
    buffer_load_dwordx4 v173, s[8:11], s3 offen lds
    s_add_u32 s3, s84, 20480
    s_add_u32 m0, s85, 2048
    s_nop 0
    buffer_load_dwordx4 v173, s[8:11], s3 offen lds
    s_add_u32 s3, s84, 30720
    s_add_u32 m0, s85, 3072
    s_nop 0
    buffer_load_dwordx4 v173, s[8:11], s3 offen lds
    s_add_u32 s3, s84, 128
    s_add_u32 m0, s85, 16384
    s_nop 0
    buffer_load_dwordx4 v173, s[8:11], s3 offen lds
    s_add_u32 s3, s84, 10368
    s_add_u32 m0, s85, 17408
    s_nop 0
    buffer_load_dwordx4 v173, s[8:11], s3 offen lds
    s_add_u32 s3, s84, 20608
    s_add_u32 m0, s85, 18432
    s_nop 0
    buffer_load_dwordx4 v173, s[8:11], s3 offen lds
    s_add_u32 s3, s84, 30848
    s_add_u32 m0, s85, 19456
    s_nop 0
    buffer_load_dwordx4 v173, s[8:11], s3 offen lds
    s_add_u32 s3, s84, 256
    s_add_u32 m0, s85, 32768
    s_nop 0
    buffer_load_dwordx4 v173, s[8:11], s3 offen lds
    s_add_u32 s3, s84, 10496
    s_add_u32 m0, s85, 33792
    s_nop 0
    buffer_load_dwordx4 v173, s[8:11], s3 offen lds
    s_add_u32 s3, s84, 20736
    s_add_u32 m0, s85, 34816
    s_nop 0
    buffer_load_dwordx4 v173, s[8:11], s3 offen lds
    s_add_u32 s3, s84, 30976
    s_add_u32 m0, s85, 35840
    s_nop 0
    buffer_load_dwordx4 v173, s[8:11], s3 offen lds
    v_lshrrev_b32 v24, 4, v0
    s_lshl_b32 s91, s30, 3
    s_add_u32 s91, s91, 0
    v_add_u32 v24, s91, v24
    v_mul_u32_u24 v25, 26, v24
    v_lshrrev_b32 v25, 8, v25
    v_mul_u32_u24 v26, 10, v25
    v_sub_u32 v26, v24, v26
    v_cmp_le_u32 vcc, 5, v26
    s_nop 1
    v_cndmask_b32 v27, 0, 1, vcc
    v_lshlrev_b32 v28, 3, v26
    v_lshlrev_b32 v27, 3, v27
    v_add_u32 v27, v27, v28
    v_add_u32 v29, 112, v27
    v_add_u32 v28, 208, v28
    v_cmp_eq_u32 vcc, 1, v25
    s_nop 1
    v_cndmask_b32 v27, v27, v29, vcc
    v_cmp_eq_u32 vcc, 2, v25
    s_nop 1
    v_cndmask_b32 v27, v27, v28, vcc
    v_mov_b32 v28, 40
    v_cmp_eq_u32 vcc, 30, v24
    s_nop 1
    v_cndmask_b32 v27, v27, v28, vcc
    v_mov_b32 v28, 88
    v_cmp_eq_u32 vcc, 31, v24
    s_nop 1
    v_cndmask_b32 v27, v27, v28, vcc
    v_and_b32 v28, 15, v0
    v_mul_u32_u24 v28, 296, v28
    v_add_u32 v27, v27, v28
    v_add_u32 v20, 65536, v27
    v_lshrrev_b32 v24, 4, v0
    s_lshl_b32 s91, s30, 3
    s_add_u32 s91, s91, 4
    v_add_u32 v24, s91, v24
    v_mul_u32_u24 v25, 26, v24
    v_lshrrev_b32 v25, 8, v25
    v_mul_u32_u24 v26, 10, v25
    v_sub_u32 v26, v24, v26
    v_cmp_le_u32 vcc, 5, v26
    s_nop 1
    v_cndmask_b32 v27, 0, 1, vcc
    v_lshlrev_b32 v28, 3, v26
    v_lshlrev_b32 v27, 3, v27
    v_add_u32 v27, v27, v28
    v_add_u32 v29, 112, v27
    v_add_u32 v28, 208, v28
    v_cmp_eq_u32 vcc, 1, v25
    s_nop 1
    v_cndmask_b32 v27, v27, v29, vcc
    v_cmp_eq_u32 vcc, 2, v25
    s_nop 1
    v_cndmask_b32 v27, v27, v28, vcc
    v_mov_b32 v28, 40
    v_cmp_eq_u32 vcc, 30, v24
    s_nop 1
    v_cndmask_b32 v27, v27, v28, vcc
    v_mov_b32 v28, 88
    v_cmp_eq_u32 vcc, 31, v24
    s_nop 1
    v_cndmask_b32 v27, v27, v28, vcc
    v_and_b32 v28, 15, v0
    v_mul_u32_u24 v28, 296, v28
    v_add_u32 v27, v27, v28
    v_add_u32 v21, 65536, v27
    v_and_b32 v60, 15, v0
    v_lshrrev_b32 v61, 4, v0
    v_mul_u32_u24 v62, 296, v60
    v_add_u32 v62, 65536, v62
    v_lshlrev_b32 v63, 4, v61
    v_add_u32 v42, v62, v63
    v_cmp_eq_u32 vcc, 3, v61
    v_add_u32 v40, 96, v62
    s_nop 0
    v_cndmask_b32 v40, v42, v40, vcc
    v_add_u32 v41, 48, v42
    v_add_u32 v63, 96, v62
    v_cndmask_b32 v41, v41, v63, vcc
    v_bfe_u32 v62, v0, 2, 2
    v_lshlrev_b32 v63, 2, v61
    v_add_u32 v62, v62, v63
    v_mul_u32_u24 v62, 296, v62
    v_and_b32 v63, 3, v0
    v_lshlrev_b32 v63, 3, v63
    v_add_u32 v62, v62, v63
    v_add_u32 v43, 65536, v62
    v_lshlrev_b32 v61, 2, v61
    v_sub_u32 v60, v60, v61
    v_mov_b32 v63, 0xf149f2ca
    v_add_u32 v61, 16, v60
    v_and_b32 v62, 0xfffffff1, v61
    v_cmp_eq_u32 vcc, 0, v62
    s_nop 1
    v_cndmask_b32 v44, v63, 0, vcc
    v_add_u32 v61, 15, v60
    v_and_b32 v62, 0xfffffff1, v61
    v_cmp_eq_u32 vcc, 0, v62
    s_nop 1
    v_cndmask_b32 v45, v63, 0, vcc
    v_add_u32 v61, 14, v60
    v_and_b32 v62, 0xfffffff1, v61
    v_cmp_eq_u32 vcc, 0, v62
    s_nop 1
    v_cndmask_b32 v46, v63, 0, vcc
    v_add_u32 v61, 13, v60
    v_and_b32 v62, 0xfffffff1, v61
    v_cmp_eq_u32 vcc, 0, v62
    s_nop 1
    v_cndmask_b32 v47, v63, 0, vcc
    v_add_u32 v61, 0, v60
    v_and_b32 v62, 0xfffffff1, v61
    v_cmp_eq_u32 vcc, 0, v62
    s_nop 1
    v_cndmask_b32 v48, v63, 0, vcc
    v_add_u32 v61, -1, v60
    v_and_b32 v62, 0xfffffff1, v61
    v_cmp_eq_u32 vcc, 0, v62
    s_nop 1
    v_cndmask_b32 v49, v63, 0, vcc
    v_add_u32 v61, -2, v60
    v_and_b32 v62, 0xfffffff1, v61
    v_cmp_eq_u32 vcc, 0, v62
    s_nop 1
    v_cndmask_b32 v50, v63, 0, vcc
    v_add_u32 v61, -3, v60
    v_and_b32 v62, 0xfffffff1, v61
    v_cmp_eq_u32 vcc, 0, v62
    s_nop 1
    v_cndmask_b32 v51, v63, 0, vcc
    v_add_u32 v60, 153600, v1
    ds_write_b128 v60, v[40:43] offset:0
    ds_write_b128 v60, v[44:47] offset:1024
    ds_write_b128 v60, v[48:51] offset:2048
    s_barrier
    s_lshl_b32 s3, s30, 13
    s_add_u32 s3, s3, 0
    s_add_u32 m0, s3, 0
    s_nop 0
    buffer_load_dwordx4 v34, s[20:23], s60 offen lds
    s_add_u32 m0, s3, 1024
    s_nop 0
    buffer_load_dwordx4 v34, s[20:23], s61 offen lds
    s_add_u32 m0, s3, 2048
    s_nop 0
    buffer_load_dwordx4 v35, s[24:27], s62 offen lds
    s_add_u32 m0, s3, 3072
    s_nop 0
    buffer_load_dwordx4 v35, s[24:27], s63 offen lds
    s_add_u32 m0, s3, 4096
    s_nop 0
    buffer_load_dwordx4 v34, s[20:23], s64 offen lds
    s_add_u32 m0, s3, 5120
    s_nop 0
    buffer_load_dwordx4 v34, s[20:23], s65 offen lds
    s_add_u32 m0, s3, 6144
    s_nop 0
    buffer_load_dwordx4 v35, s[24:27], s66 offen lds
    s_add_u32 m0, s3, 7168
    s_nop 0
    buffer_load_dwordx4 v35, s[24:27], s67 offen lds
    s_cmp_ge_u32 s95, 1230
    s_cbranch_scc1 NB_4
    s_mov_b32 s90, 0
    s_mov_b32 s87, s95
    s_cmp_ge_u32 s95, 320
    s_cselect_b32 s90, 1, s90
    s_sub_u32 s89, s95, 320
    s_cmp_ge_u32 s95, 860
    s_cselect_b32 s90, 2, s90
    s_sub_u32 s89, s95, 860
    s_cmp_ge_u32 s95, 1130
    s_cselect_b32 s90, 3, s90
    s_sub_u32 s89, s95, 1130
    s_cmp_ge_u32 s95, 1230
    s_cselect_b32 s90, 4, s90
    s_sub_u32 s89, s95, 1230
    s_sub_u32 s89, s95, 320
    s_cmp_ge_u32 s95, 320
    s_cselect_b32 s87, s89, s87
    s_sub_u32 s89, s95, 860
    s_cmp_ge_u32 s95, 860
    s_cselect_b32 s87, s89, s87
    s_sub_u32 s89, s95, 1130
    s_cmp_ge_u32 s95, 1130
    s_cselect_b32 s87, s89, s87
    s_sub_u32 s89, s95, 1230
    s_cmp_ge_u32 s95, 1230
    s_cselect_b32 s87, s89, s87
    s_cmp_lt_u32 s90, 2
    s_cselect_b32 s88, 3277, 0
    s_cselect_b32 s89, 20, 5
    s_cmp_ge_u32 s90, 2
    s_cselect_b32 s88, 13108, s88
    s_mul_i32 s88, s88, s87
    s_lshr_b32 s88, s88, 16
    s_mul_i32 s89, s89, s88
    s_sub_u32 s89, s87, s89
    s_min_u32 s91, s90, 3
    s_cmp_eq_u32 s90, 3
    s_cselect_b32 s92, s88, 0
    s_cmp_ge_u32 s92, 16
    s_cselect_b32 s91, 4, s91
    s_lshl_b32 s91, s91, 6
    s_add_u32 s92, s89, 2
    s_cmp_eq_u32 s90, 3
    s_cselect_b32 s93, 5, 0
    s_add_u32 s92, s92, s93
    s_cmp_lt_u32 s90, 2
    s_cselect_b32 s92, s90, s92
    s_min_u32 s92, s92, 11
    s_lshl_b32 s92, s92, 5
    s_add_u32 s92, s92, 320
    s_load_dwordx16 s[60:75], s[0:1], s91
    s_load_dwordx8 s[52:59], s[0:1], s92
    s_waitcnt lgkmcnt(0)
    s_mov_b32 s20, s42
    s_cmp_eq_u32 s90, 1
    s_cselect_b32 s20, s48, s20
    s_cmp_eq_u32 s90, 2
    s_cselect_b32 s20, s46, s20
    s_cmp_eq_u32 s90, 3
    s_cselect_b32 s20, s44, s20
    s_mov_b32 s21, s43
    s_cmp_eq_u32 s90, 1
    s_cselect_b32 s21, s49, s21
    s_cmp_eq_u32 s90, 2
    s_cselect_b32 s21, s47, s21
    s_cmp_eq_u32 s90, 3
    s_cselect_b32 s21, s45, s21
    s_and_b32 s21, s21, 0xffff
    s_mov_b32 s22, s75
    s_mov_b32 s23, 0x20000
    s_mov_b32 s24, s42
    s_cmp_eq_u32 s90, 1
    s_cselect_b32 s24, s50, s24
    s_cmp_eq_u32 s90, 2
    s_cselect_b32 s24, s46, s24
    s_cmp_eq_u32 s90, 3
    s_cselect_b32 s24, s44, s24
    s_mov_b32 s25, s43
    s_cmp_eq_u32 s90, 1
    s_cselect_b32 s25, s51, s25
    s_cmp_eq_u32 s90, 2
    s_cselect_b32 s25, s47, s25
    s_cmp_eq_u32 s90, 3
    s_cselect_b32 s25, s45, s25
    s_and_b32 s25, s25, 0xffff
    s_mov_b32 s26, s75
    s_mov_b32 s27, 0x20000
    s_cmp_lt_u32 s90, 2
    s_cselect_b32 s91, s89, s88
    s_sub_u32 s92, s88, 16
    s_cmp_eq_u32 s74, 204800
    s_cselect_b32 s91, s92, s91
    s_mul_i32 s91, s91, s74
    s_add_u32 s60, s60, s91
    s_add_u32 s61, s61, s91
    s_add_u32 s62, s62, s91
    s_add_u32 s63, s63, s91
    s_add_u32 s64, s64, s91
    s_add_u32 s65, s65, s91
    s_add_u32 s66, s66, s91
    s_add_u32 s67, s67, s91
    s_cmp_lt_u32 s90, 2
    s_cselect_b32 s91, s88, s89
    s_mul_i32 s73, s73, s91
    s_mul_i32 s91, s88, 163840
    s_lshl_b32 s92, s89, 10
    s_add_u32 s91, s91, s92
    s_add_u32 s92, s91, s92
    s_add_u32 s92, s92, 3440640
    s_cmp_eq_u32 s90, 1
    s_cselect_b32 s91, s92, s91
    s_mul_i32 s92, s88, 5120
    s_add_u32 s74, s92, 7864320
    s_cmp_eq_u32 s90, 2
    s_cselect_b32 s91, s74, s91
    s_add_u32 s74, s92, 2621440
    s_cmp_eq_u32 s90, 3
    s_cselect_b32 s91, s74, s91
    s_cmp_eq_u32 s90, 4
    s_cselect_b32 s91, 0x40000000, s91
    s_cselect_b32 s72, 0, s72
    s_add_u32 s52, s52, s91
    s_add_u32 s53, s53, s91
    s_add_u32 s54, s54, s91
    s_add_u32 s55, s55, s91
    s_add_u32 s56, s56, s91
    s_add_u32 s57, s57, s91
    s_add_u32 s58, s58, s91
    s_add_u32 s59, s59, s91
    s_mul_i32 s91, s88, 10240
    s_lshl_b32 s92, s89, 7
    s_add_u32 s91, s91, s92
    s_add_u32 s91, s91, 10076160
    s_cmp_eq_u32 s90, 1
    s_cselect_b32 s97, s91, 0x40000000
    s_lshl_b32 s91, s88, 7
    s_lshl_b32 s92, s89, 2
    s_add_u32 s91, s91, s92
    s_add_u32 s91, s91, 65994752
    s_cmp_eq_u32 s90, 0
    s_cselect_b32 s99, s91, 0x40000000
    v_lshrrev_b32 v24, 4, v0
    v_and_b32 v25, 15, v0
    v_lshlrev_b32 v26, 1, v24
    v_xor_b32 v25, v25, v26
    v_mul_lo_u32 v24, v24, s68
    v_xor_b32 v27, 0, v25
    v_mul_lo_u32 v28, v27, s69
    v_lshrrev_b32 v28, 8, v28
    v_mul_lo_u32 v34, v28, s70
    v_sub_u32 v34, v27, v34
    v_lshlrev_b32 v34, 4, v34
    v_mul_lo_u32 v28, v28, s71
    v_add_u32 v34, v34, v28
    v_add_u32 v34, v34, v24
    v_add_u32 v34, s73, v34
    v_cmp_le_u32 vcc, s72, v27
    v_mov_b32 v28, 0x40000000
    s_nop 0
    v_cndmask_b32 v34, v34, v28, vcc
    v_xor_b32 v27, 8, v25
    v_mul_lo_u32 v28, v27, s69
    v_lshrrev_b32 v28, 8, v28
    v_mul_lo_u32 v35, v28, s70
    v_sub_u32 v35, v27, v35
    v_lshlrev_b32 v35, 4, v35
    v_mul_lo_u32 v28, v28, s71
    v_add_u32 v35, v35, v28
    v_add_u32 v35, v35, v24
    v_add_u32 v35, s73, v35
    v_cmp_le_u32 vcc, s72, v27
    v_mov_b32 v28, 0x40000000
    s_nop 0
    v_cndmask_b32 v35, v35, v28, vcc
    s_lshl_b32 s3, s30, 13
    s_add_u32 s3, s3, 32768
    s_add_u32 m0, s3, 0
    s_nop 0
    buffer_load_dwordx4 v34, s[20:23], s60 offen lds
    s_add_u32 m0, s3, 1024
    s_nop 0
    buffer_load_dwordx4 v34, s[20:23], s61 offen lds
    s_add_u32 m0, s3, 2048
    s_nop 0
    buffer_load_dwordx4 v35, s[24:27], s62 offen lds
    s_add_u32 m0, s3, 3072
    s_nop 0
    buffer_load_dwordx4 v35, s[24:27], s63 offen lds
    s_add_u32 m0, s3, 4096
    s_nop 0
    buffer_load_dwordx4 v34, s[20:23], s64 offen lds
    s_add_u32 m0, s3, 5120
    s_nop 0
    buffer_load_dwordx4 v34, s[20:23], s65 offen lds
    s_add_u32 m0, s3, 6144
    s_nop 0
    buffer_load_dwordx4 v35, s[24:27], s66 offen lds
    s_add_u32 m0, s3, 7168
    s_nop 0
    buffer_load_dwordx4 v35, s[24:27], s67 offen lds
NB_4:
    v_mov_b32 v25, 0
    buffer_load_dword v112, v25, s[16:19], 0 offen sc1
    s_waitcnt vmcnt(9)
    v_mov_b32 v34, 0x3f803f80
    v_mov_b32 v32, 0
    v_mov_b32 v33, 0
    v_mov_b32 v37, 0
    v_mov_b32 v38, 0
    v_dot2_f32_bf16 v32, v2, v34, v32
    v_dot2_f32_bf16 v33, v2, v2, v33
    v_dot2_f32_bf16 v37, v3, v34, v37
    v_dot2_f32_bf16 v38, v3, v3, v38
    v_dot2_f32_bf16 v32, v4, v34, v32
    v_dot2_f32_bf16 v33, v4, v4, v33
    v_dot2_f32_bf16 v37, v5, v34, v37
    v_dot2_f32_bf16 v38, v5, v5, v38
    v_dot2_f32_bf16 v32, v6, v34, v32
    v_dot2_f32_bf16 v33, v6, v6, v33
    v_dot2_f32_bf16 v37, v7, v34, v37
    v_dot2_f32_bf16 v38, v7, v7, v38
    v_dot2_f32_bf16 v32, v8, v34, v32
    v_dot2_f32_bf16 v33, v8, v8, v33
    v_dot2_f32_bf16 v37, v9, v34, v37
    v_dot2_f32_bf16 v38, v9, v9, v38
    v_dot2_f32_bf16 v32, v10, v34, v32
    v_dot2_f32_bf16 v33, v10, v10, v33
    v_dot2_f32_bf16 v37, v11, v34, v37
    v_dot2_f32_bf16 v38, v11, v11, v38
    s_nop 1
    v_add_f32 v32, v32, v37
    v_add_f32 v33, v33, v38
    v_mov_b32 v35, v32
    v_mov_b32 v36, v33
    s_nop 0
    v_permlane32_swap_b32 v32, v35
    v_permlane32_swap_b32 v33, v36
    v_add_f32 v32, v32, v35
    v_add_f32 v33, v33, v36
    v_mov_b32 v35, v32
    v_mov_b32 v36, v33
    s_nop 0
    v_permlane16_swap_b32 v32, v35
    v_permlane16_swap_b32 v33, v36
    v_add_f32 v32, v32, v35
    v_add_f32 v33, v33, v36
    v_and_b32 v30, 15, v0
    v_lshlrev_b32 v30, 3, v30
    s_lshl_b32 s91, s34, 11
    s_lshl_b32 s3, s33, 2
    s_add_u32 s3, s3, s101
    s_lshl_b32 s3, s3, 7
    s_add_u32 s91, s91, s3
    s_add_u32 s91, s91, s37
    s_add_u32 s91, s91, 6914048
    s_mov_b32 exec_lo, 0xffff
    s_mov_b32 exec_hi, 0x0
    buffer_store_dwordx2 v[32:33], v30, s[4:7], s91 offen sc1
    s_mov_b64 exec, -1
    s_waitcnt vmcnt(1)
    v_readfirstlane_b32 s86, v112
    s_nop 1
    s_cmp_lg_u32 s86, 0
    s_cbranch_scc1 NO_10
    s_mov_b32 s87, 0
    v_mov_b32 v25, 0
NP_9:
    buffer_load_dword v112, v25, s[16:19], 0 offen sc1
    s_add_u32 s87, s87, 1
    s_cmp_gt_u32 s87, 200000
    s_cbranch_scc1 L_END
    s_waitcnt vmcnt(0)
    v_readfirstlane_b32 s86, v112
    s_nop 1
    s_cmp_eq_u32 s86, 0
    s_cbranch_scc1 NP_9
NO_10:
    v_lshrrev_b32 v24, 4, v0
    v_bfe_u32 v25, v0, 2, 2
    v_and_b32 v26, 3, v0
    v_lshlrev_b32 v27, 3, v24
    v_add_u32 v27, v27, v25
    v_lshlrev_b32 v27, 8, v27
    v_lshlrev_b32 v26, 3, v26
    v_add_u32 v27, v27, v26
    v_and_b32 v24, 1, v24
    v_lshlrev_b32 v24, 2, v24
    v_add_u32 v24, v24, v25
    v_lshlrev_b32 v24, 5, v24
    v_xor_b32 v27, v27, v24
    s_lshl_b32 s3, s30, 13
    s_add_u32 s3, s3, 0
    v_add_u32 v27, s3, v27
    v_xor_b32 v28, 0, v27
    ds_read_b64_tr_b16 v[40:41], v28
    ds_read_b64_tr_b16 v[42:43], v28 offset:1024
    v_xor_b32 v29, 32, v27
    ds_read_b64_tr_b16 v[44:45], v29
    ds_read_b64_tr_b16 v[46:47], v29 offset:1024
    v_xor_b32 v28, 64, v27
    ds_read_b64_tr_b16 v[48:49], v28
    ds_read_b64_tr_b16 v[50:51], v28 offset:1024
    v_xor_b32 v29, 96, v27
    ds_read_b64_tr_b16 v[52:53], v29
    ds_read_b64_tr_b16 v[54:55], v29 offset:1024
    v_xor_b32 v28, 128, v27
    ds_read_b64_tr_b16 v[56:57], v28
    ds_read_b64_tr_b16 v[58:59], v28 offset:1024
    v_xor_b32 v29, 160, v27
    ds_read_b64_tr_b16 v[60:61], v29
    ds_read_b64_tr_b16 v[62:63], v29 offset:1024
    v_xor_b32 v28, 192, v27
    ds_read_b64_tr_b16 v[64:65], v28
    ds_read_b64_tr_b16 v[66:67], v28 offset:1024
    v_xor_b32 v29, 224, v27
    ds_read_b64_tr_b16 v[68:69], v29
    ds_read_b64_tr_b16 v[70:71], v29 offset:1024
    s_waitcnt lgkmcnt(14)
    buffer_store_dwordx4 v[40:43], v1, s[4:7], s76 offen sc1
    s_waitcnt lgkmcnt(12)
    buffer_store_dwordx4 v[44:47], v1, s[4:7], s77 offen sc1
    s_waitcnt lgkmcnt(10)
    buffer_store_dwordx4 v[48:51], v1, s[4:7], s78 offen sc1
    s_waitcnt lgkmcnt(8)
    buffer_store_dwordx4 v[52:55], v1, s[4:7], s79 offen sc1
    s_waitcnt lgkmcnt(6)
    buffer_store_dwordx4 v[56:59], v1, s[4:7], s80 offen sc1
    s_waitcnt lgkmcnt(4)
    buffer_store_dwordx4 v[60:63], v1, s[4:7], s81 offen sc1
    s_waitcnt lgkmcnt(2)
    buffer_store_dwordx4 v[64:67], v1, s[4:7], s82 offen sc1
    s_waitcnt lgkmcnt(0)
    buffer_store_dwordx4 v[68:71], v1, s[4:7], s83 offen sc1
    s_cmp_eq_u32 s96, 0x40000000
    s_cbranch_scc1 NC_11
    v_mov_b32 v24, 0x3f803f80
    v_and_b32 v25, 31, v0
    v_lshlrev_b32 v25, 2, v25
    v_mov_b32 v26, 0
    v_mov_b32 v27, 0
    v_mov_b32 v28, 0
    v_mov_b32 v29, 0
    v_dot2_f32_bf16 v26, v40, v24, v26
    v_dot2_f32_bf16 v27, v44, v24, v27
    v_dot2_f32_bf16 v28, v48, v24, v28
    v_dot2_f32_bf16 v29, v52, v24, v29
    v_dot2_f32_bf16 v26, v41, v24, v26
    v_dot2_f32_bf16 v27, v45, v24, v27
    v_dot2_f32_bf16 v28, v49, v24, v28
    v_dot2_f32_bf16 v29, v53, v24, v29
    v_dot2_f32_bf16 v26, v42, v24, v26
    v_dot2_f32_bf16 v27, v46, v24, v27
    v_dot2_f32_bf16 v28, v50, v24, v28
    v_dot2_f32_bf16 v29, v54, v24, v29
    v_dot2_f32_bf16 v26, v43, v24, v26
    v_dot2_f32_bf16 v27, v47, v24, v27
    v_dot2_f32_bf16 v28, v51, v24, v28
    v_dot2_f32_bf16 v29, v55, v24, v29
    v_dot2_f32_bf16 v26, v56, v24, v26
    v_dot2_f32_bf16 v27, v60, v24, v27
    v_dot2_f32_bf16 v28, v64, v24, v28
    v_dot2_f32_bf16 v29, v68, v24, v29
    v_dot2_f32_bf16 v26, v57, v24, v26
    v_dot2_f32_bf16 v27, v61, v24, v27
    v_dot2_f32_bf16 v28, v65, v24, v28
    v_dot2_f32_bf16 v29, v69, v24, v29
    v_dot2_f32_bf16 v26, v58, v24, v26
    v_dot2_f32_bf16 v27, v62, v24, v27
    v_dot2_f32_bf16 v28, v66, v24, v28
    v_dot2_f32_bf16 v29, v70, v24, v29
    v_dot2_f32_bf16 v26, v59, v24, v26
    v_dot2_f32_bf16 v27, v63, v24, v27
    v_dot2_f32_bf16 v28, v67, v24, v28
    v_dot2_f32_bf16 v29, v71, v24, v29
    v_mov_b32 v30, v26
    v_mov_b32 v31, v27
    v_mov_b32 v32, v28
    v_mov_b32 v33, v29
    v_permlane32_swap_b32 v26, v30
    v_permlane32_swap_b32 v27, v31
    v_permlane32_swap_b32 v28, v32
    v_permlane32_swap_b32 v29, v33
    v_add_f32 v26, v26, v30
    v_add_f32 v27, v27, v31
    v_add_f32 v28, v28, v32
    v_add_f32 v29, v29, v33
    s_mov_b32 exec_lo, 0xffffffff
    s_mov_b32 exec_hi, 0x0
    buffer_store_dword v26, v25, s[4:7], s96 offen offset:0 sc1
    buffer_store_dword v27, v25, s[4:7], s96 offen offset:2560 sc1
    s_add_u32 s3, s96, 5120
    buffer_store_dword v28, v25, s[4:7], s3 offen sc1
    s_add_u32 s3, s96, 7680
    buffer_store_dword v29, v25, s[4:7], s3 offen sc1
    s_mov_b64 exec, -1
NC_11:
    s_cmp_ge_u32 s95, 1230
    s_cbranch_scc1 NB2_5
    v_lshrrev_b32 v24, 4, v0
    v_bfe_u32 v25, v0, 2, 2
    v_and_b32 v26, 3, v0
    v_lshlrev_b32 v27, 3, v24
    v_add_u32 v27, v27, v25
    v_lshlrev_b32 v27, 8, v27
    v_lshlrev_b32 v26, 3, v26
    v_add_u32 v27, v27, v26
    v_and_b32 v24, 1, v24
    v_lshlrev_b32 v24, 2, v24
    v_add_u32 v24, v24, v25
    v_lshlrev_b32 v24, 5, v24
    v_xor_b32 v27, v27, v24
    s_lshl_b32 s3, s30, 13
    s_add_u32 s3, s3, 32768
    v_add_u32 v27, s3, v27
    v_xor_b32 v28, 0, v27
    ds_read_b64_tr_b16 v[40:41], v28
    ds_read_b64_tr_b16 v[42:43], v28 offset:1024
    v_xor_b32 v29, 32, v27
    ds_read_b64_tr_b16 v[44:45], v29
    ds_read_b64_tr_b16 v[46:47], v29 offset:1024
    v_xor_b32 v28, 64, v27
    ds_read_b64_tr_b16 v[48:49], v28
    ds_read_b64_tr_b16 v[50:51], v28 offset:1024
    v_xor_b32 v29, 96, v27
    ds_read_b64_tr_b16 v[52:53], v29
    ds_read_b64_tr_b16 v[54:55], v29 offset:1024
    v_xor_b32 v28, 128, v27
    ds_read_b64_tr_b16 v[56:57], v28
    ds_read_b64_tr_b16 v[58:59], v28 offset:1024
    v_xor_b32 v29, 160, v27
    ds_read_b64_tr_b16 v[60:61], v29
    ds_read_b64_tr_b16 v[62:63], v29 offset:1024
    v_xor_b32 v28, 192, v27
    ds_read_b64_tr_b16 v[64:65], v28
    ds_read_b64_tr_b16 v[66:67], v28 offset:1024
    v_xor_b32 v29, 224, v27
    ds_read_b64_tr_b16 v[68:69], v29
    ds_read_b64_tr_b16 v[70:71], v29 offset:1024
    s_waitcnt lgkmcnt(14)
    buffer_store_dwordx4 v[40:43], v1, s[4:7], s52 offen sc1
    s_waitcnt lgkmcnt(12)
    buffer_store_dwordx4 v[44:47], v1, s[4:7], s53 offen sc1
    s_waitcnt lgkmcnt(10)
    buffer_store_dwordx4 v[48:51], v1, s[4:7], s54 offen sc1
    s_waitcnt lgkmcnt(8)
    buffer_store_dwordx4 v[52:55], v1, s[4:7], s55 offen sc1
    s_waitcnt lgkmcnt(6)
    buffer_store_dwordx4 v[56:59], v1, s[4:7], s56 offen sc1
    s_waitcnt lgkmcnt(4)
    buffer_store_dwordx4 v[60:63], v1, s[4:7], s57 offen sc1
    s_waitcnt lgkmcnt(2)
    buffer_store_dwordx4 v[64:67], v1, s[4:7], s58 offen sc1
    s_waitcnt lgkmcnt(0)
    buffer_store_dwordx4 v[68:71], v1, s[4:7], s59 offen sc1
    s_cmp_eq_u32 s97, 0x40000000
    s_cbranch_scc1 NC_12
    v_mov_b32 v24, 0x3f803f80
    v_and_b32 v25, 31, v0
    v_lshlrev_b32 v25, 2, v25
    v_mov_b32 v26, 0
    v_mov_b32 v27, 0
    v_mov_b32 v28, 0
    v_mov_b32 v29, 0
    v_dot2_f32_bf16 v26, v40, v24, v26
    v_dot2_f32_bf16 v27, v44, v24, v27
    v_dot2_f32_bf16 v28, v48, v24, v28
    v_dot2_f32_bf16 v29, v52, v24, v29
    v_dot2_f32_bf16 v26, v41, v24, v26
    v_dot2_f32_bf16 v27, v45, v24, v27
    v_dot2_f32_bf16 v28, v49, v24, v28
    v_dot2_f32_bf16 v29, v53, v24, v29
    v_dot2_f32_bf16 v26, v42, v24, v26
    v_dot2_f32_bf16 v27, v46, v24, v27
    v_dot2_f32_bf16 v28, v50, v24, v28
    v_dot2_f32_bf16 v29, v54, v24, v29
    v_dot2_f32_bf16 v26, v43, v24, v26
    v_dot2_f32_bf16 v27, v47, v24, v27
    v_dot2_f32_bf16 v28, v51, v24, v28
    v_dot2_f32_bf16 v29, v55, v24, v29
    v_dot2_f32_bf16 v26, v56, v24, v26
    v_dot2_f32_bf16 v27, v60, v24, v27
    v_dot2_f32_bf16 v28, v64, v24, v28
    v_dot2_f32_bf16 v29, v68, v24, v29
    v_dot2_f32_bf16 v26, v57, v24, v26
    v_dot2_f32_bf16 v27, v61, v24, v27
    v_dot2_f32_bf16 v28, v65, v24, v28
    v_dot2_f32_bf16 v29, v69, v24, v29
    v_dot2_f32_bf16 v26, v58, v24, v26
    v_dot2_f32_bf16 v27, v62, v24, v27
    v_dot2_f32_bf16 v28, v66, v24, v28
    v_dot2_f32_bf16 v29, v70, v24, v29
    v_dot2_f32_bf16 v26, v59, v24, v26
    v_dot2_f32_bf16 v27, v63, v24, v27
    v_dot2_f32_bf16 v28, v67, v24, v28
    v_dot2_f32_bf16 v29, v71, v24, v29
    v_mov_b32 v30, v26
    v_mov_b32 v31, v27
    v_mov_b32 v32, v28
    v_mov_b32 v33, v29
    v_permlane32_swap_b32 v26, v30
    v_permlane32_swap_b32 v27, v31
    v_permlane32_swap_b32 v28, v32
    v_permlane32_swap_b32 v29, v33
    v_add_f32 v26, v26, v30
    v_add_f32 v27, v27, v31
    v_add_f32 v28, v28, v32
    v_add_f32 v29, v29, v33
    s_mov_b32 exec_lo, 0xffffffff
    s_mov_b32 exec_hi, 0x0
    buffer_store_dword v26, v25, s[4:7], s97 offen offset:0 sc1
    buffer_store_dword v27, v25, s[4:7], s97 offen offset:2560 sc1
    s_add_u32 s3, s97, 5120
    buffer_store_dword v28, v25, s[4:7], s3 offen sc1
    s_add_u32 s3, s97, 7680
    buffer_store_dword v29, v25, s[4:7], s3 offen sc1
    s_mov_b64 exec, -1
NC_12:
NB2_5:
SJ_3:
    v_and_b32 v24, 15, v0
    v_lshrrev_b32 v25, 4, v0
    v_mul_u32_u24 v172, 1280, v24
    v_lshlrev_b32 v25, 4, v25
    v_add_u32 v172, v172, v25
    v_lshrrev_b32 v24, 3, v0
    v_and_b32 v25, 7, v0
    v_xor_b32 v25, v25, v24
    v_lshlrev_b32 v25, 4, v25
    v_mul_u32_u24 v173, 1280, v24
    v_add_u32 v173, v173, v25
    v_and_b32 v24, 15, v0
    v_lshrrev_b32 v25, 4, v0
    v_and_b32 v26, 7, v24
    v_xor_b32 v25, v25, v26
    v_lshlrev_b32 v25, 4, v25
    v_lshlrev_b32 v24, 7, v24
    v_add_u32 v24, v24, v25
    v_add_u32 v221, 65536, v24
    v_xor_b32 v222, 64, v221
    s_lshl_b32 s79, s28, 8
    s_lshl_b32 s20, s31, 7
    s_add_u32 s79, s79, s20
    s_lshl_b32 s20, s30, 5
    s_add_u32 s79, s79, s20
    s_mul_i32 s79, s79, 1280
    s_lshl_b32 s80, s30, 12
    s_add_u32 s80, s80, 65536
    s_waitcnt vmcnt(0)
    s_waitcnt lgkmcnt(0)
    s_barrier
    s_cmp_lg_u32 s30, 0
    s_cbranch_scc1 SF_13
    s_add_u32 s24, s86, s38
    s_add_u32 s24, s24, 0x10
    s_lshl_b32 s25, s28, 7
    s_lshl_b32 s3, s29, 2
    s_add_u32 s25, s25, s3
    s_add_u32 s25, s25, 65996800
    v_mov_b32 v24, s24
    v_mov_b32 v25, 0
    s_mov_b32 exec_lo, 0x1
    s_mov_b32 exec_hi, 0x0
    buffer_store_dword v24, v25, s[4:7], s25 offen sc1
    s_mov_b64 exec, -1
SF_13:
    s_cmp_lg_u32 s30, 0
    s_cbranch_scc1 QW_14
    s_lshl_b32 s90, s32, 7
    s_add_u32 s90, s90, 65994752
    s_add_u32 s91, s86, 1
    s_mov_b32 s88, 0xfffff
    s_mov_b32 s89, 0
    v_lshlrev_b32 v178, 2, v0
    s_mov_b32 s87, 0
PL_16:
    s_add_u32 s87, s87, 1
    s_cmp_gt_u32 s87, 200000
    s_cbranch_scc1 L_END
    s_sleep 2
    buffer_load_dword v175, v178, s[4:7], s90 offen sc1
    s_waitcnt vmcnt(0)
    v_subrev_u32 v24, s91, v175
    v_cmp_le_u32 vcc, 1, v24
    s_nop 1
    s_and_b64 s[84:85], vcc, s[88:89]
    s_cmp_eq_u64 s[84:85], 0
    s_cbranch_scc0 PL_16
PK_15:
QW_14:
    s_barrier
    v_add_u32 v174, 20480, v1
    s_lshl_b32 s90, s32, 3
    s_lshl_b32 s91, s30, 1
    s_add_u32 s90, s90, s91
    s_mul_i32 s90, s90, 20480
    s_add_u32 s91, s90, 0
    buffer_load_dwordx4 a[0:3], v1, s[4:7], s91 offen
    buffer_load_dwordx4 a[80:83], v174, s[4:7], s91 offen
    s_add_u32 s91, s90, 1024
    buffer_load_dwordx4 a[4:7], v1, s[4:7], s91 offen
    buffer_load_dwordx4 a[84:87], v174, s[4:7], s91 offen
    s_add_u32 s91, s90, 2048
    buffer_load_dwordx4 a[8:11], v1, s[4:7], s91 offen
    buffer_load_dwordx4 a[88:91], v174, s[4:7], s91 offen
    s_add_u32 s91, s90, 3072
    buffer_load_dwordx4 a[12:15], v1, s[4:7], s91 offen
    buffer_load_dwordx4 a[92:95], v174, s[4:7], s91 offen
    s_add_u32 s91, s90, 4096
    buffer_load_dwordx4 a[16:19], v1, s[4:7], s91 offen
    buffer_load_dwordx4 a[96:99], v174, s[4:7], s91 offen
    s_add_u32 s91, s90, 5120
    buffer_load_dwordx4 a[20:23], v1, s[4:7], s91 offen
    buffer_load_dwordx4 a[100:103], v174, s[4:7], s91 offen
    v_mov_b32 v168, 0x3f803f80
    v_mov_b32 v169, 0x3f803f80
    v_mov_b32 v170, 0x3f803f80
    v_mov_b32 v171, 0x3f803f80
    s_lshl_b32 s82, s28, 8
    s_lshl_b32 s20, s31, 7
    s_add_u32 s82, s82, s20
    s_cmp_eq_u32 s82, 0
    s_cselect_b32 s21, 1, 0
    s_sub_u32 s82, s82, 16
    s_mul_i32 s82, s82, 1280
    s_cmp_eq_u32 s21, 1
    s_cselect_b32 s82, 0x40000000, s82
    s_lshl_b32 s81, s32, 3
    s_lshl_b32 s20, s30, 1
    s_add_u32 s81, s81, s20
    s_mul_i32 s81, s81, 20480
    s_mov_b32 s90, 65996800
    s_add_u32 s91, s86, 0x10
    v_lshlrev_b32 v178, 4, v0
    s_waitcnt vmcnt(21)
    s_barrier
    ds_read_b128 v[136:139], v221 offset:0
    ds_read_b128 v[140:143], v221 offset:2048
    ds_read_b128 v[144:147], v221 offset:4096
    ds_read_b128 v[148:151], v221 offset:6144
    ds_read_b128 v[152:155], v221 offset:8192
    ds_read_b128 v[156:159], v221 offset:10240
    ds_read_b128 v[160:163], v221 offset:12288
    ds_read_b128 v[164:167], v221 offset:14336
    s_add_u32 s22, s81, 6144
    buffer_load_dwordx4 a[24:27], v1, s[4:7], s22 offen
    buffer_load_dwordx4 a[104:107], v174, s[4:7], s22 offen
    s_waitcnt vmcnt(12)
    v_mfma_f32_16x16x32_bf16 v[12:15], a[0:3], v[168:171], 0
    v_mfma_f32_16x16x32_bf16 v[16:19], a[80:83], v[168:171], 0
    s_waitcnt lgkmcnt(6)
    v_mfma_f32_16x16x32_bf16 v[64:67], a[0:3], v[136:139], 0
    s_mul_i32 s60, s30, 5120
    s_mul_i32 s61, s34, 102400
    v_mfma_f32_16x16x32_bf16 v[68:71], a[80:83], v[136:139], 0
    ds_read_b128 v[136:139], v222 offset:0
    s_add_u32 s61, s61, 2621440
    s_add_u32 s61, s61, s60
    v_mfma_f32_16x16x32_bf16 v[72:75], a[0:3], v[140:143], 0
    s_mul_i32 s64, s32, 7
    s_mul_i32 s88, s32, 6
    v_mfma_f32_16x16x32_bf16 v[76:79], a[80:83], v[140:143], 0
    ds_read_b128 v[140:143], v222 offset:2048
    s_add_u32 s88, s88, 12
    s_cmp_lt_u32 s32, 12
    s_cselect_b32 s64, s64, s88
    s_waitcnt lgkmcnt(6)
    v_mfma_f32_16x16x32_bf16 v[80:83], a[0:3], v[144:147], 0
    s_mul_i32 s62, s34, 276480
    s_add_u32 s62, s62, 7864320
    v_mfma_f32_16x16x32_bf16 v[84:87], a[80:83], v[144:147], 0
    ds_read_b128 v[144:147], v222 offset:4096
    s_add_u32 s62, s62, s60
    s_add_u32 s94, s62, 266240
    v_mfma_f32_16x16x32_bf16 v[88:91], a[0:3], v[148:151], 0
    s_cmp_lt_u32 s30, 2
    s_cselect_b32 s63, s94, 0x40000000
    s_add_u32 s93, s62, 286720
    v_mfma_f32_16x16x32_bf16 v[92:95], a[80:83], v[148:151], 0
    ds_read_b128 v[148:151], v222 offset:6144
    s_mul_i32 s95, s33, 10
    s_mul_i32 s95, s95, 21846
    s_waitcnt lgkmcnt(6)
    v_mfma_f32_16x16x32_bf16 v[96:99], a[0:3], v[152:155], 0
    s_lshr_b32 s95, s95, 16
    s_lshl_b32 s65, s28, 9
    v_mfma_f32_16x16x32_bf16 v[100:103], a[80:83], v[152:155], 0
    ds_read_b128 v[152:155], v222 offset:8192
    s_add_u32 s65, s65, 66002944
    s_mul_i32 s77, s64, 40960
    v_mfma_f32_16x16x32_bf16 v[104:107], a[0:3], v[156:159], 0
    s_add_u32 s77, s77, 3440640
    s_add_u32 s77, s77, s60
    v_mfma_f32_16x16x32_bf16 v[108:111], a[80:83], v[156:159], 0
    ds_read_b128 v[156:159], v222 offset:10240
    s_mul_i32 s88, s31, 0
    s_add_i32 s88, s88, 0
    s_waitcnt lgkmcnt(6)
    v_mfma_f32_16x16x32_bf16 v[112:115], a[0:3], v[160:163], 0
    s_mul_i32 s89, s88, 40960
    s_add_u32 s40, s77, s89
    v_mfma_f32_16x16x32_bf16 v[116:119], a[80:83], v[160:163], 0
    ds_read_b128 v[160:163], v222 offset:12288
    s_add_u32 s75, s64, s88
    s_lshr_b32 s76, s75, 1
    v_mfma_f32_16x16x32_bf16 v[120:123], a[0:3], v[164:167], 0
    s_lshl_b32 s76, s76, 10
    s_and_b32 s75, s75, 1
    v_mfma_f32_16x16x32_bf16 v[124:127], a[80:83], v[164:167], 0
    ds_read_b128 v[164:167], v222 offset:14336
    s_lshl_b32 s75, s75, 9
    s_add_u32 s47, s75, s76
    s_barrier
    s_waitcnt vmcnt(10)
    v_mfma_f32_16x16x32_bf16 v[12:15], a[4:7], v[168:171], v[12:15]
    v_mfma_f32_16x16x32_bf16 v[16:19], a[84:87], v[168:171], v[16:19]
    s_waitcnt lgkmcnt(6)
    v_mfma_f32_16x16x32_bf16 v[64:67], a[4:7], v[136:139], v[64:67]
    s_add_u32 s20, s79, 384
    s_add_u32 m0, s80, 49152
    v_mfma_f32_16x16x32_bf16 v[68:71], a[84:87], v[136:139], v[68:71]
    ds_read_b128 v[136:139], v221 offset:16384
    buffer_load_dwordx4 v173, s[8:11], s20 offen lds
    v_mfma_f32_16x16x32_bf16 v[72:75], a[4:7], v[140:143], v[72:75]
    s_add_u32 s20, s79, 10624
    s_add_u32 m0, s80, 50176
    v_mfma_f32_16x16x32_bf16 v[76:79], a[84:87], v[140:143], v[76:79]
    ds_read_b128 v[140:143], v221 offset:18432
    s_cmp_eq_u32 s88, 6
    s_cselect_b32 s75, 1, 0
    s_cmp_ge_u32 s32, 12
    s_cselect_b32 s75, s75, 0
    s_waitcnt lgkmcnt(6)
    v_mfma_f32_16x16x32_bf16 v[80:83], a[4:7], v[144:147], v[80:83]
    buffer_load_dwordx4 v173, s[8:11], s20 offen lds
    s_add_u32 s20, s79, 20864
    v_mfma_f32_16x16x32_bf16 v[84:87], a[84:87], v[144:147], v[84:87]
    ds_read_b128 v[144:147], v221 offset:20480
    s_add_u32 m0, s80, 51200
    v_mfma_f32_16x16x32_bf16 v[88:91], a[4:7], v[148:151], v[88:91]
    s_cmp_eq_u32 s75, 1
    s_cselect_b32 s40, 0x40000000, s40
    s_cselect_b32 s47, 0x40000000, s47
    s_mul_i32 s88, s31, 0
    v_mfma_f32_16x16x32_bf16 v[92:95], a[84:87], v[148:151], v[92:95]
    ds_read_b128 v[148:151], v221 offset:22528
    buffer_load_dwordx4 v173, s[8:11], s20 offen lds
    s_waitcnt lgkmcnt(6)
    v_mfma_f32_16x16x32_bf16 v[96:99], a[4:7], v[152:155], v[96:99]
    s_add_u32 s20, s79, 31104
    s_add_u32 m0, s80, 52224
    v_mfma_f32_16x16x32_bf16 v[100:103], a[84:87], v[152:155], v[100:103]
    ds_read_b128 v[152:155], v221 offset:24576
    s_add_i32 s88, s88, 1
    s_mul_i32 s89, s88, 40960
    v_mfma_f32_16x16x32_bf16 v[104:107], a[4:7], v[156:159], v[104:107]
    buffer_load_dwordx4 v173, s[8:11], s20 offen lds
    s_add_u32 s22, s81, 7168
    v_mfma_f32_16x16x32_bf16 v[108:111], a[84:87], v[156:159], v[108:111]
    ds_read_b128 v[156:159], v221 offset:26624
    s_add_u32 s41, s77, s89
    s_add_u32 s75, s64, s88
    s_waitcnt lgkmcnt(6)
    v_mfma_f32_16x16x32_bf16 v[112:115], a[4:7], v[160:163], v[112:115]
    s_lshr_b32 s76, s75, 1
    s_lshl_b32 s76, s76, 10
    v_mfma_f32_16x16x32_bf16 v[116:119], a[84:87], v[160:163], v[116:119]
    ds_read_b128 v[160:163], v221 offset:28672
    buffer_load_dwordx4 a[28:31], v1, s[4:7], s22 offen
    v_mfma_f32_16x16x32_bf16 v[120:123], a[4:7], v[164:167], v[120:123]
    s_and_b32 s75, s75, 1
    s_lshl_b32 s75, s75, 9
    v_mfma_f32_16x16x32_bf16 v[124:127], a[84:87], v[164:167], v[124:127]
    ds_read_b128 v[164:167], v221 offset:30720
    s_add_u32 s48, s75, s76
    s_cmp_eq_u32 s88, 6
    s_cselect_b32 s75, 1, 0
    s_waitcnt vmcnt(13)
    v_mfma_f32_16x16x32_bf16 v[12:15], a[8:11], v[168:171], v[12:15]
    v_mfma_f32_16x16x32_bf16 v[16:19], a[88:91], v[168:171], v[16:19]
    s_waitcnt lgkmcnt(6)
    v_mfma_f32_16x16x32_bf16 v[64:67], a[8:11], v[136:139], v[64:67]
    buffer_load_dwordx4 a[108:111], v174, s[4:7], s22 offen
    s_add_u32 s22, s81, 8192
    v_mfma_f32_16x16x32_bf16 v[68:71], a[88:91], v[136:139], v[68:71]
    ds_read_b128 v[136:139], v222 offset:16384
    s_cmp_ge_u32 s32, 12
    s_cselect_b32 s75, s75, 0
    s_cmp_eq_u32 s75, 1
    s_cselect_b32 s41, 0x40000000, s41
    s_cselect_b32 s48, 0x40000000, s48
    v_mfma_f32_16x16x32_bf16 v[72:75], a[8:11], v[140:143], v[72:75]
    s_mul_i32 s88, s31, 0
    s_add_i32 s88, s88, 2
    v_mfma_f32_16x16x32_bf16 v[76:79], a[88:91], v[140:143], v[76:79]
    ds_read_b128 v[140:143], v222 offset:18432
    buffer_load_dwordx4 a[32:35], v1, s[4:7], s22 offen
    s_waitcnt lgkmcnt(6)
    v_mfma_f32_16x16x32_bf16 v[80:83], a[8:11], v[144:147], v[80:83]
    s_mul_i32 s89, s88, 40960
    s_add_u32 s42, s77, s89
    v_mfma_f32_16x16x32_bf16 v[84:87], a[88:91], v[144:147], v[84:87]
    ds_read_b128 v[144:147], v222 offset:20480
    s_add_u32 s75, s64, s88
    s_lshr_b32 s76, s75, 1
    v_mfma_f32_16x16x32_bf16 v[88:91], a[8:11], v[148:151], v[88:91]
    buffer_load_dwordx4 a[112:115], v174, s[4:7], s22 offen
    s_lshl_b32 s76, s76, 10
    v_mfma_f32_16x16x32_bf16 v[92:95], a[88:91], v[148:151], v[92:95]
    ds_read_b128 v[148:151], v222 offset:22528
    s_and_b32 s75, s75, 1
    s_lshl_b32 s75, s75, 9
    s_waitcnt lgkmcnt(6)
    v_mfma_f32_16x16x32_bf16 v[96:99], a[8:11], v[152:155], v[96:99]
    s_add_u32 s49, s75, s76
    s_cmp_eq_u32 s88, 6
    s_cselect_b32 s75, 1, 0
    v_mfma_f32_16x16x32_bf16 v[100:103], a[88:91], v[152:155], v[100:103]
    ds_read_b128 v[152:155], v222 offset:24576
    s_cmp_ge_u32 s32, 12
    s_cselect_b32 s75, s75, 0
    s_cmp_eq_u32 s75, 1
    s_cselect_b32 s42, 0x40000000, s42
    s_cselect_b32 s49, 0x40000000, s49
    v_mfma_f32_16x16x32_bf16 v[104:107], a[8:11], v[156:159], v[104:107]
    s_mul_i32 s88, s31, 0
    s_add_i32 s88, s88, 3
    v_mfma_f32_16x16x32_bf16 v[108:111], a[88:91], v[156:159], v[108:111]
    ds_read_b128 v[156:159], v222 offset:26624
    s_mul_i32 s89, s88, 40960
    s_add_u32 s43, s77, s89
    s_waitcnt lgkmcnt(6)
    v_mfma_f32_16x16x32_bf16 v[112:115], a[8:11], v[160:163], v[112:115]
    s_add_u32 s75, s64, s88
    s_lshr_b32 s76, s75, 1
    v_mfma_f32_16x16x32_bf16 v[116:119], a[88:91], v[160:163], v[116:119]
    ds_read_b128 v[160:163], v222 offset:28672
    s_lshl_b32 s76, s76, 10
    s_and_b32 s75, s75, 1
    v_mfma_f32_16x16x32_bf16 v[120:123], a[8:11], v[164:167], v[120:123]
    s_lshl_b32 s75, s75, 9
    s_add_u32 s50, s75, s76
    v_mfma_f32_16x16x32_bf16 v[124:127], a[88:91], v[164:167], v[124:127]
    ds_read_b128 v[164:167], v222 offset:30720
    s_cmp_eq_u32 s88, 6
    s_cselect_b32 s75, 1, 0
    s_cmp_ge_u32 s32, 12
    s_cselect_b32 s75, s75, 0
    s_barrier
    s_waitcnt vmcnt(14)
    v_mfma_f32_16x16x32_bf16 v[12:15], a[12:15], v[168:171], v[12:15]
    v_mfma_f32_16x16x32_bf16 v[16:19], a[92:95], v[168:171], v[16:19]
    s_waitcnt lgkmcnt(6)
    v_mfma_f32_16x16x32_bf16 v[64:67], a[12:15], v[136:139], v[64:67]
    s_add_u32 s20, s79, 512
    s_add_u32 m0, s80, 0
    v_mfma_f32_16x16x32_bf16 v[68:71], a[92:95], v[136:139], v[68:71]
    ds_read_b128 v[136:139], v221 offset:32768
    buffer_load_dwordx4 v173, s[8:11], s20 offen lds
    v_mfma_f32_16x16x32_bf16 v[72:75], a[12:15], v[140:143], v[72:75]
    s_add_u32 s20, s79, 10752
    s_add_u32 m0, s80, 1024
    v_mfma_f32_16x16x32_bf16 v[76:79], a[92:95], v[140:143], v[76:79]
    ds_read_b128 v[140:143], v221 offset:34816
    s_cmp_eq_u32 s75, 1
    s_cselect_b32 s43, 0x40000000, s43
    s_cselect_b32 s50, 0x40000000, s50
    s_mul_i32 s88, s31, 0
    s_waitcnt lgkmcnt(6)
    v_mfma_f32_16x16x32_bf16 v[80:83], a[12:15], v[144:147], v[80:83]
    buffer_load_dwordx4 v173, s[8:11], s20 offen lds
    s_add_u32 s20, s79, 20992
    v_mfma_f32_16x16x32_bf16 v[84:87], a[92:95], v[144:147], v[84:87]
    ds_read_b128 v[144:147], v221 offset:36864
    s_add_u32 m0, s80, 2048
    v_mfma_f32_16x16x32_bf16 v[88:91], a[12:15], v[148:151], v[88:91]
    s_add_i32 s88, s88, 4
    s_mul_i32 s89, s88, 40960
    v_mfma_f32_16x16x32_bf16 v[92:95], a[92:95], v[148:151], v[92:95]
    ds_read_b128 v[148:151], v221 offset:38912
    buffer_load_dwordx4 v173, s[8:11], s20 offen lds
    s_waitcnt lgkmcnt(6)
    v_mfma_f32_16x16x32_bf16 v[96:99], a[12:15], v[152:155], v[96:99]
    s_add_u32 s20, s79, 31232
    s_add_u32 m0, s80, 3072
    v_mfma_f32_16x16x32_bf16 v[100:103], a[92:95], v[152:155], v[100:103]
    ds_read_b128 v[152:155], v221 offset:40960
    s_add_u32 s44, s77, s89
    s_add_u32 s75, s64, s88
    v_mfma_f32_16x16x32_bf16 v[104:107], a[12:15], v[156:159], v[104:107]
    buffer_load_dwordx4 v173, s[8:11], s20 offen lds
    s_add_u32 s22, s81, 9216
    v_mfma_f32_16x16x32_bf16 v[108:111], a[92:95], v[156:159], v[108:111]
    ds_read_b128 v[156:159], v221 offset:43008
    s_lshr_b32 s76, s75, 1
    s_lshl_b32 s76, s76, 10
    s_waitcnt lgkmcnt(6)
    v_mfma_f32_16x16x32_bf16 v[112:115], a[12:15], v[160:163], v[112:115]
    s_and_b32 s75, s75, 1
    s_lshl_b32 s75, s75, 9
    v_mfma_f32_16x16x32_bf16 v[116:119], a[92:95], v[160:163], v[116:119]
    ds_read_b128 v[160:163], v221 offset:45056
    buffer_load_dwordx4 a[36:39], v1, s[4:7], s22 offen
    v_mfma_f32_16x16x32_bf16 v[120:123], a[12:15], v[164:167], v[120:123]
    s_add_u32 s51, s75, s76
    s_cmp_eq_u32 s88, 6
    s_cselect_b32 s75, 1, 0
    v_mfma_f32_16x16x32_bf16 v[124:127], a[92:95], v[164:167], v[124:127]
    ds_read_b128 v[164:167], v221 offset:47104
    s_cmp_ge_u32 s32, 12
    s_cselect_b32 s75, s75, 0
    s_cmp_eq_u32 s75, 1
    s_cselect_b32 s44, 0x40000000, s44
    s_cselect_b32 s51, 0x40000000, s51
    buffer_load_dwordx4 a[116:119], v174, s[4:7], s22 offen
    s_add_u32 s22, s81, 10240
    buffer_load_dwordx4 a[40:43], v1, s[4:7], s22 offen
    buffer_load_dwordx4 a[120:123], v174, s[4:7], s22 offen
    s_waitcnt vmcnt(20)
    v_mfma_f32_16x16x32_bf16 v[12:15], a[16:19], v[168:171], v[12:15]
    v_mfma_f32_16x16x32_bf16 v[16:19], a[96:99], v[168:171], v[16:19]
    s_waitcnt lgkmcnt(6)
    v_mfma_f32_16x16x32_bf16 v[64:67], a[16:19], v[136:139], v[64:67]
    s_mul_i32 s88, s31, 0
    s_add_i32 s88, s88, 5
    v_mfma_f32_16x16x32_bf16 v[68:71], a[96:99], v[136:139], v[68:71]
    ds_read_b128 v[136:139], v222 offset:32768
    s_mul_i32 s89, s88, 40960
    s_add_u32 s45, s77, s89
    v_mfma_f32_16x16x32_bf16 v[72:75], a[16:19], v[140:143], v[72:75]
    s_add_u32 s75, s64, s88
    s_lshr_b32 s76, s75, 1
    v_mfma_f32_16x16x32_bf16 v[76:79], a[96:99], v[140:143], v[76:79]
    ds_read_b128 v[140:143], v222 offset:34816
    s_lshl_b32 s76, s76, 10
    s_and_b32 s75, s75, 1
    s_waitcnt lgkmcnt(6)
    v_mfma_f32_16x16x32_bf16 v[80:83], a[16:19], v[144:147], v[80:83]
    s_lshl_b32 s75, s75, 9
    s_add_u32 s52, s75, s76
    v_mfma_f32_16x16x32_bf16 v[84:87], a[96:99], v[144:147], v[84:87]
    ds_read_b128 v[144:147], v222 offset:36864
    s_cmp_eq_u32 s88, 6
    s_cselect_b32 s75, 1, 0
    s_cmp_ge_u32 s32, 12
    s_cselect_b32 s75, s75, 0
    v_mfma_f32_16x16x32_bf16 v[88:91], a[16:19], v[148:151], v[88:91]
    s_cmp_eq_u32 s75, 1
    s_cselect_b32 s45, 0x40000000, s45
    s_cselect_b32 s52, 0x40000000, s52
    s_mul_i32 s88, s31, 0
    v_mfma_f32_16x16x32_bf16 v[92:95], a[96:99], v[148:151], v[92:95]
    ds_read_b128 v[148:151], v222 offset:38912
    s_add_i32 s88, s88, 6
    s_mul_i32 s89, s88, 40960
    s_waitcnt lgkmcnt(6)
    v_mfma_f32_16x16x32_bf16 v[96:99], a[16:19], v[152:155], v[96:99]
    s_add_u32 s46, s77, s89
    s_add_u32 s75, s64, s88
    v_mfma_f32_16x16x32_bf16 v[100:103], a[96:99], v[152:155], v[100:103]
    ds_read_b128 v[152:155], v222 offset:40960
    s_lshr_b32 s76, s75, 1
    s_lshl_b32 s76, s76, 10
    v_mfma_f32_16x16x32_bf16 v[104:107], a[16:19], v[156:159], v[104:107]
    s_and_b32 s75, s75, 1
    s_lshl_b32 s75, s75, 9
    v_mfma_f32_16x16x32_bf16 v[108:111], a[96:99], v[156:159], v[108:111]
    ds_read_b128 v[156:159], v222 offset:43008
    s_add_u32 s53, s75, s76
    s_cmp_eq_u32 s88, 6
    s_cselect_b32 s75, 1, 0
    s_waitcnt lgkmcnt(6)
    v_mfma_f32_16x16x32_bf16 v[112:115], a[16:19], v[160:163], v[112:115]
    s_cmp_ge_u32 s32, 12
    s_cselect_b32 s75, s75, 0
    s_cmp_eq_u32 s75, 1
    s_cselect_b32 s46, 0x40000000, s46
    s_cselect_b32 s53, 0x40000000, s53
    v_mfma_f32_16x16x32_bf16 v[116:119], a[96:99], v[160:163], v[116:119]
    ds_read_b128 v[160:163], v222 offset:45056
    s_lshl_b32 s88, s31, 3
    s_lshl_b32 s89, s30, 1
    v_mfma_f32_16x16x32_bf16 v[120:123], a[16:19], v[164:167], v[120:123]
    s_add_u32 s88, s88, s89
    s_mul_i32 s88, s88, 20480
    v_mfma_f32_16x16x32_bf16 v[124:127], a[96:99], v[164:167], v[124:127]
    ds_read_b128 v[164:167], v222 offset:47104
    s_lshl_b32 s89, s32, 10
    s_add_u32 s66, s88, s89
    s_waitcnt vmcnt(12)
    s_barrier
    v_mfma_f32_16x16x32_bf16 v[12:15], a[20:23], v[168:171], v[12:15]
    v_mfma_f32_16x16x32_bf16 v[16:19], a[100:103], v[168:171], v[16:19]
    s_waitcnt lgkmcnt(6)
    v_mfma_f32_16x16x32_bf16 v[64:67], a[20:23], v[136:139], v[64:67]
    s_add_u32 s20, s79, 640
    s_add_u32 m0, s80, 16384
    v_mfma_f32_16x16x32_bf16 v[68:71], a[100:103], v[136:139], v[68:71]
    ds_read_b128 v[136:139], v221 offset:49152
    buffer_load_dwordx4 v173, s[8:11], s20 offen lds
    v_mfma_f32_16x16x32_bf16 v[72:75], a[20:23], v[140:143], v[72:75]
    s_add_u32 s20, s79, 10880
    s_add_u32 m0, s80, 17408
    v_mfma_f32_16x16x32_bf16 v[76:79], a[100:103], v[140:143], v[76:79]
    ds_read_b128 v[140:143], v221 offset:51200
    s_lshr_b32 s89, s32, 2
    s_add_u32 s89, s89, 16
    s_waitcnt lgkmcnt(6)
    v_mfma_f32_16x16x32_bf16 v[80:83], a[20:23], v[144:147], v[80:83]
    buffer_load_dwordx4 v173, s[8:11], s20 offen lds
    s_add_u32 s20, s79, 21120
    v_mfma_f32_16x16x32_bf16 v[84:87], a[100:103], v[144:147], v[84:87]
    ds_read_b128 v[144:147], v221 offset:53248
    s_add_u32 m0, s80, 18432
    v_mfma_f32_16x16x32_bf16 v[88:91], a[20:23], v[148:151], v[88:91]
    s_lshl_b32 s89, s89, 10
    s_add_u32 s88, s88, s89
    v_mfma_f32_16x16x32_bf16 v[92:95], a[100:103], v[148:151], v[92:95]
    ds_read_b128 v[148:151], v221 offset:55296
    buffer_load_dwordx4 v173, s[8:11], s20 offen lds
    s_waitcnt lgkmcnt(6)
    v_mfma_f32_16x16x32_bf16 v[96:99], a[20:23], v[152:155], v[96:99]
    s_add_u32 s20, s79, 31360
    s_add_u32 m0, s80, 19456
    v_mfma_f32_16x16x32_bf16 v[100:103], a[100:103], v[152:155], v[100:103]
    ds_read_b128 v[152:155], v221 offset:57344
    s_and_b32 s89, s32, 3
    s_lshl_b32 s89, s89, 8
    v_mfma_f32_16x16x32_bf16 v[104:107], a[20:23], v[156:159], v[104:107]
    buffer_load_dwordx4 v173, s[8:11], s20 offen lds
    s_add_u32 s22, s81, 11264
    v_mfma_f32_16x16x32_bf16 v[108:111], a[100:103], v[156:159], v[108:111]
    ds_read_b128 v[156:159], v221 offset:59392
    s_add_u32 s67, s88, s89
    s_lshl_b32 s88, s33, 2
    s_waitcnt lgkmcnt(6)
    v_mfma_f32_16x16x32_bf16 v[112:115], a[20:23], v[160:163], v[112:115]
    s_add_u32 s88, s88, s30
    s_mul_i32 s68, s88, 20480
    v_mfma_f32_16x16x32_bf16 v[116:119], a[100:103], v[160:163], v[116:119]
    ds_read_b128 v[160:163], v221 offset:61440
    buffer_load_dwordx4 a[44:47], v1, s[4:7], s22 offen
    v_mfma_f32_16x16x32_bf16 v[120:123], a[20:23], v[164:167], v[120:123]
    s_mul_i32 s74, s88, 55296
    s_add_u32 s74, s74, 655360
    v_mfma_f32_16x16x32_bf16 v[124:127], a[100:103], v[164:167], v[124:127]
    ds_read_b128 v[164:167], v221 offset:63488
    s_lshl_b32 s88, s33, 2
    s_add_u32 s88, s88, s101
    v_mfma_f32_16x16x32_bf16 v[12:15], a[24:27], v[168:171], v[12:15]
    v_mfma_f32_16x16x32_bf16 v[16:19], a[104:107], v[168:171], v[16:19]
    s_waitcnt lgkmcnt(6)
    v_mfma_f32_16x16x32_bf16 v[64:67], a[24:27], v[136:139], v[64:67]
    buffer_load_dwordx4 a[124:127], v174, s[4:7], s22 offen
    s_add_u32 s22, s81, 12288
    v_mfma_f32_16x16x32_bf16 v[68:71], a[104:107], v[136:139], v[68:71]
    ds_read_b128 v[136:139], v222 offset:49152
    s_lshr_b32 s89, s88, 1
    s_mul_i32 s69, s89, 40960
    v_mfma_f32_16x16x32_bf16 v[72:75], a[24:27], v[140:143], v[72:75]
    s_mul_i32 s89, s34, 5120
    s_add_u32 s69, s69, s89
    v_mfma_f32_16x16x32_bf16 v[76:79], a[104:107], v[140:143], v[76:79]
    ds_read_b128 v[140:143], v222 offset:51200
    buffer_load_dwordx4 a[48:51], v1, s[4:7], s22 offen
    s_waitcnt lgkmcnt(6)
    v_mfma_f32_16x16x32_bf16 v[80:83], a[24:27], v[144:147], v[80:83]
    s_and_b32 s89, s88, 1
    s_lshl_b32 s89, s89, 8
    v_mfma_f32_16x16x32_bf16 v[84:87], a[104:107], v[144:147], v[84:87]
    ds_read_b128 v[144:147], v222 offset:53248
    s_add_u32 s69, s69, s89
    s_lshl_b32 s70, s34, 11
    v_mfma_f32_16x16x32_bf16 v[88:91], a[24:27], v[148:151], v[88:91]
    buffer_load_dwordx4 a[128:131], v174, s[4:7], s22 offen
    s_lshl_b32 s89, s88, 7
    v_mfma_f32_16x16x32_bf16 v[92:95], a[104:107], v[148:151], v[92:95]
    ds_read_b128 v[148:151], v222 offset:55296
    s_add_u32 s70, s70, s89
    s_lshl_b32 s88, s31, 2
    s_waitcnt lgkmcnt(6)
    v_mfma_f32_16x16x32_bf16 v[96:99], a[24:27], v[152:155], v[96:99]
    s_add_u32 s88, s88, s30
    s_mul_i32 s71, s88, 40960
    v_mfma_f32_16x16x32_bf16 v[100:103], a[104:107], v[152:155], v[100:103]
    ds_read_b128 v[152:155], v222 offset:57344
    s_lshl_b32 s72, s88, 8
    s_mul_i32 s73, s88, 110592
    v_mfma_f32_16x16x32_bf16 v[104:107], a[24:27], v[156:159], v[104:107]
    s_add_u32 s73, s73, 655360
    v_mov_b32 v31, 0x40000000
    v_mfma_f32_16x16x32_bf16 v[108:111], a[104:107], v[156:159], v[108:111]
    ds_read_b128 v[156:159], v222 offset:59392
    v_lshrrev_b32 v24, 3, v0
    v_mul_u32_u24 v24, 20480, v24
    s_waitcnt lgkmcnt(6)
    v_mfma_f32_16x16x32_bf16 v[112:115], a[24:27], v[160:163], v[112:115]
    v_and_b32 v25, 7, v0
    v_lshlrev_b32 v25, 7, v25
    v_mfma_f32_16x16x32_bf16 v[116:119], a[104:107], v[160:163], v[116:119]
    ds_read_b128 v[160:163], v222 offset:61440
    v_add_u32 v24, v24, v25
    v_add_u32 v24, s66, v24
    v_mfma_f32_16x16x32_bf16 v[120:123], a[24:27], v[164:167], v[120:123]
    v_bfe_u32 v25, v0, 1, 1
    v_mul_u32_u24 v25, 20480, v25
    v_mfma_f32_16x16x32_bf16 v[124:127], a[104:107], v[164:167], v[124:127]
    ds_read_b128 v[164:167], v222 offset:63488
    v_and_b32 v26, 1, v0
    v_lshlrev_b32 v26, 7, v26
    s_waitcnt vmcnt(12)
    s_barrier
    v_mfma_f32_16x16x32_bf16 v[12:15], a[28:31], v[168:171], v[12:15]
    v_mfma_f32_16x16x32_bf16 v[16:19], a[108:111], v[168:171], v[16:19]
    s_waitcnt lgkmcnt(6)
    v_mfma_f32_16x16x32_bf16 v[64:67], a[28:31], v[136:139], v[64:67]
    s_add_u32 s20, s79, 768
    s_add_u32 m0, s80, 32768
    v_mfma_f32_16x16x32_bf16 v[68:71], a[108:111], v[136:139], v[68:71]
    ds_read_b128 v[136:139], v221 offset:0
    buffer_load_dwordx4 v173, s[8:11], s20 offen lds
    v_mfma_f32_16x16x32_bf16 v[72:75], a[28:31], v[140:143], v[72:75]
    s_add_u32 s20, s79, 11008
    s_add_u32 m0, s80, 33792
    v_mfma_f32_16x16x32_bf16 v[76:79], a[108:111], v[140:143], v[76:79]
    ds_read_b128 v[140:143], v221 offset:2048
    v_add_u32 v25, v25, v26
    v_add_u32 v25, s67, v25
    s_waitcnt lgkmcnt(6)
    v_mfma_f32_16x16x32_bf16 v[80:83], a[28:31], v[144:147], v[80:83]
    buffer_load_dwordx4 v173, s[8:11], s20 offen lds
    s_add_u32 s20, s79, 21248
    v_mfma_f32_16x16x32_bf16 v[84:87], a[108:111], v[144:147], v[84:87]
    ds_read_b128 v[144:147], v221 offset:4096
    s_add_u32 m0, s80, 34816
    v_mfma_f32_16x16x32_bf16 v[88:91], a[28:31], v[148:151], v[88:91]
    v_cmp_gt_u32 vcc, 16, v0
    s_nop 1
    v_cndmask_b32 v40, v25, v24, vcc
    v_cmp_gt_u32 vcc, 20, v0
    s_nop 1
    v_cndmask_b32 v40, v31, v40, vcc
    v_mfma_f32_16x16x32_bf16 v[92:95], a[108:111], v[148:151], v[92:95]
    ds_read_b128 v[148:151], v221 offset:6144
    buffer_load_dwordx4 v173, s[8:11], s20 offen lds
    s_waitcnt lgkmcnt(6)
    v_mfma_f32_16x16x32_bf16 v[96:99], a[28:31], v[152:155], v[96:99]
    s_add_u32 s20, s79, 31488
    s_add_u32 m0, s80, 35840
    v_mfma_f32_16x16x32_bf16 v[100:103], a[108:111], v[152:155], v[100:103]
    ds_read_b128 v[152:155], v221 offset:8192
    v_lshrrev_b32 v24, 2, v0
    v_lshlrev_b32 v24, 10, v24
    v_mfma_f32_16x16x32_bf16 v[104:107], a[28:31], v[156:159], v[104:107]
    buffer_load_dwordx4 v173, s[8:11], s20 offen lds
    s_add_u32 s22, s81, 13312
    v_mfma_f32_16x16x32_bf16 v[108:111], a[108:111], v[156:159], v[108:111]
    ds_read_b128 v[156:159], v221 offset:10240
    v_bfe_u32 v25, v0, 1, 1
    v_lshlrev_b32 v25, 9, v25
    s_waitcnt lgkmcnt(6)
    v_mfma_f32_16x16x32_bf16 v[112:115], a[28:31], v[160:163], v[112:115]
    v_add_u32 v24, v24, v25
    v_and_b32 v25, 1, v0
    v_mfma_f32_16x16x32_bf16 v[116:119], a[108:111], v[160:163], v[116:119]
    ds_read_b128 v[160:163], v221 offset:12288
    buffer_load_dwordx4 a[52:55], v1, s[4:7], s22 offen
    v_mfma_f32_16x16x32_bf16 v[120:123], a[28:31], v[164:167], v[120:123]
    v_lshlrev_b32 v25, 7, v25
    v_add_u32 v24, v24, v25
    v_mfma_f32_16x16x32_bf16 v[124:127], a[108:111], v[164:167], v[124:127]
    ds_read_b128 v[164:167], v221 offset:14336
    v_add_u32 v24, s69, v24
    v_add_u32 v25, 327680, v24
    v_mfma_f32_16x16x32_bf16 v[12:15], a[32:35], v[168:171], v[12:15]
    v_mfma_f32_16x16x32_bf16 v[16:19], a[112:115], v[168:171], v[16:19]
    s_waitcnt lgkmcnt(6)
    v_mfma_f32_16x16x32_bf16 v[64:67], a[32:35], v[136:139], v[64:67]
    buffer_load_dwordx4 a[132:135], v174, s[4:7], s22 offen
    s_add_u32 s22, s81, 14336
    v_mfma_f32_16x16x32_bf16 v[68:71], a[112:115], v[136:139], v[68:71]
    ds_read_b128 v[136:139], v222 offset:0
    s_add_u32 s88, s70, 1540096
    v_mov_b32 v26, s88
    v_mfma_f32_16x16x32_bf16 v[72:75], a[32:35], v[140:143], v[72:75]
    v_cmp_gt_u32 vcc, 20, v0
    s_nop 1
    v_cndmask_b32 v41, v26, v25, vcc
    v_cmp_gt_u32 vcc, 21, v0
    s_nop 1
    v_cndmask_b32 v41, v31, v41, vcc
    v_mfma_f32_16x16x32_bf16 v[76:79], a[112:115], v[140:143], v[76:79]
    ds_read_b128 v[140:143], v222 offset:2048
    buffer_load_dwordx4 a[56:59], v1, s[4:7], s22 offen
    s_waitcnt lgkmcnt(6)
    v_mfma_f32_16x16x32_bf16 v[80:83], a[32:35], v[144:147], v[80:83]
    v_add_u32 v25, 3112960, v24
    s_add_u32 s88, s70, 3440640
    v_mfma_f32_16x16x32_bf16 v[84:87], a[112:115], v[144:147], v[84:87]
    ds_read_b128 v[144:147], v222 offset:4096
    v_mov_b32 v26, s88
    v_cmp_gt_u32 vcc, 20, v0
    s_nop 1
    v_cndmask_b32 v43, v26, v25, vcc
    v_mfma_f32_16x16x32_bf16 v[88:91], a[32:35], v[148:151], v[88:91]
    buffer_load_dwordx4 a[136:139], v174, s[4:7], s22 offen
    v_cmp_gt_u32 vcc, 21, v0
    s_nop 1
    v_cndmask_b32 v43, v31, v43, vcc
    v_mfma_f32_16x16x32_bf16 v[92:95], a[112:115], v[148:151], v[92:95]
    ds_read_b128 v[148:151], v222 offset:6144
    v_lshrrev_b32 v24, 3, v0
    v_add_u32 v24, s64, v24
    s_waitcnt lgkmcnt(6)
    v_mfma_f32_16x16x32_bf16 v[96:99], a[32:35], v[152:155], v[96:99]
    v_lshrrev_b32 v25, 1, v24
    v_lshlrev_b32 v25, 10, v25
    v_mfma_f32_16x16x32_bf16 v[100:103], a[112:115], v[152:155], v[100:103]
    ds_read_b128 v[152:155], v222 offset:8192
    v_and_b32 v24, 1, v24
    v_lshlrev_b32 v24, 9, v24
    v_mfma_f32_16x16x32_bf16 v[104:107], a[32:35], v[156:159], v[104:107]
    v_add_u32 v24, v24, v25
    v_bfe_u32 v25, v0, 2, 1
    v_mfma_f32_16x16x32_bf16 v[108:111], a[112:115], v[156:159], v[108:111]
    ds_read_b128 v[156:159], v222 offset:10240
    v_mul_u32_u24 v25, 55296, v25
    v_add_u32 v24, v24, v25
    s_waitcnt lgkmcnt(6)
    v_mfma_f32_16x16x32_bf16 v[112:115], a[32:35], v[160:163], v[112:115]
    v_and_b32 v25, 3, v0
    v_lshlrev_b32 v25, 7, v25
    v_mfma_f32_16x16x32_bf16 v[116:119], a[112:115], v[160:163], v[116:119]
    ds_read_b128 v[160:163], v222 offset:12288
    v_add_u32 v24, v24, v25
    v_add_u32 v24, s73, v24
    v_mfma_f32_16x16x32_bf16 v[120:123], a[32:35], v[164:167], v[120:123]
    v_cmp_gt_u32 vcc, 56, v0
    s_nop 1
    v_cndmask_b32 v42, v31, v24, vcc
    s_lshl_b32 s88, s30, 10
    v_mfma_f32_16x16x32_bf16 v[124:127], a[112:115], v[164:167], v[124:127]
    ds_read_b128 v[164:167], v222 offset:14336
    s_add_u32 s88, s88, 156672
    v_add_u32 v24, s88, v1
    s_waitcnt vmcnt(12)
    s_barrier
    v_mfma_f32_16x16x32_bf16 v[12:15], a[36:39], v[168:171], v[12:15]
    v_mfma_f32_16x16x32_bf16 v[16:19], a[116:119], v[168:171], v[16:19]
    s_waitcnt lgkmcnt(6)
    v_mfma_f32_16x16x32_bf16 v[64:67], a[36:39], v[136:139], v[64:67]
    s_add_u32 s20, s79, 896
    s_add_u32 m0, s80, 49152
    v_mfma_f32_16x16x32_bf16 v[68:71], a[116:119], v[136:139], v[68:71]
    ds_read_b128 v[136:139], v221 offset:16384
    buffer_load_dwordx4 v173, s[8:11], s20 offen lds
    v_mfma_f32_16x16x32_bf16 v[72:75], a[36:39], v[140:143], v[72:75]
    s_add_u32 s20, s79, 11136
    s_add_u32 m0, s80, 50176
    v_mfma_f32_16x16x32_bf16 v[76:79], a[116:119], v[140:143], v[76:79]
    ds_read_b128 v[140:143], v221 offset:18432
    ds_write_b128 v24, v[40:43]
    v_and_b32 v24, 15, v0
    s_waitcnt lgkmcnt(6)
    v_mfma_f32_16x16x32_bf16 v[80:83], a[36:39], v[144:147], v[80:83]
    buffer_load_dwordx4 v173, s[8:11], s20 offen lds
    s_add_u32 s20, s79, 21376
    v_mfma_f32_16x16x32_bf16 v[84:87], a[116:119], v[144:147], v[84:87]
    ds_read_b128 v[144:147], v221 offset:20480
    s_add_u32 m0, s80, 51200
    v_mfma_f32_16x16x32_bf16 v[88:91], a[36:39], v[148:151], v[88:91]
    s_lshr_b32 s88, s33, 1
    s_lshl_b32 s88, s88, 8
    v_mfma_f32_16x16x32_bf16 v[92:95], a[116:119], v[148:151], v[92:95]
    ds_read_b128 v[148:151], v221 offset:22528
    buffer_load_dwordx4 v173, s[8:11], s20 offen lds
    s_waitcnt lgkmcnt(6)
    v_mfma_f32_16x16x32_bf16 v[96:99], a[36:39], v[152:155], v[96:99]
    s_add_u32 s20, s79, 31616
    s_add_u32 m0, s80, 52224
    v_mfma_f32_16x16x32_bf16 v[100:103], a[116:119], v[152:155], v[100:103]
    ds_read_b128 v[152:155], v221 offset:24576
    v_lshlrev_b32 v40, 4, v24
    v_add_u32 v40, s88, v40
    v_mfma_f32_16x16x32_bf16 v[104:107], a[36:39], v[156:159], v[104:107]
    buffer_load_dwordx4 v173, s[8:11], s20 offen lds
    s_add_u32 s22, s81, 15360
    v_mfma_f32_16x16x32_bf16 v[108:111], a[116:119], v[156:159], v[108:111]
    ds_read_b128 v[156:159], v221 offset:26624
    v_mov_b32 v42, v40
    s_and_b32 s88, s33, 1
    s_waitcnt lgkmcnt(6)
    v_mfma_f32_16x16x32_bf16 v[112:115], a[36:39], v[160:163], v[112:115]
    s_lshl_b32 s88, s88, 2
    s_add_u32 s88, s88, s30
    v_mfma_f32_16x16x32_bf16 v[116:119], a[116:119], v[160:163], v[116:119]
    ds_read_b128 v[160:163], v221 offset:28672
    buffer_load_dwordx4 a[60:63], v1, s[4:7], s22 offen
    v_mfma_f32_16x16x32_bf16 v[120:123], a[36:39], v[164:167], v[120:123]
    s_lshr_b32 s88, s88, 1
    s_lshl_b32 s88, s88, 2
    v_mfma_f32_16x16x32_bf16 v[124:127], a[116:119], v[164:167], v[124:127]
    ds_read_b128 v[164:167], v221 offset:30720
    v_add_u32 v40, s88, v40
    v_add_u32 v42, s88, v42
    v_mfma_f32_16x16x32_bf16 v[12:15], a[40:43], v[168:171], v[12:15]
    v_mfma_f32_16x16x32_bf16 v[16:19], a[120:123], v[168:171], v[16:19]
    s_waitcnt lgkmcnt(6)
    v_mfma_f32_16x16x32_bf16 v[64:67], a[40:43], v[136:139], v[64:67]
    buffer_load_dwordx4 a[140:143], v174, s[4:7], s22 offen
    s_add_u32 s22, s81, 16384
    v_mfma_f32_16x16x32_bf16 v[68:71], a[120:123], v[136:139], v[68:71]
    ds_read_b128 v[136:139], v222 offset:16384
    s_lshl_b32 s88, s31, 1
    s_add_u32 s88, s88, s100
    v_mfma_f32_16x16x32_bf16 v[72:75], a[40:43], v[140:143], v[72:75]
    s_lshl_b32 s88, s88, 7
    v_and_b32 v25, 7, v24
    v_mfma_f32_16x16x32_bf16 v[76:79], a[120:123], v[140:143], v[76:79]
    ds_read_b128 v[140:143], v222 offset:18432
    buffer_load_dwordx4 a[64:67], v1, s[4:7], s22 offen
    s_waitcnt lgkmcnt(6)
    v_mfma_f32_16x16x32_bf16 v[80:83], a[40:43], v[144:147], v[80:83]
    v_lshlrev_b32 v25, 4, v25
    v_add_u32 v41, s88, v25
    v_mfma_f32_16x16x32_bf16 v[84:87], a[120:123], v[144:147], v[84:87]
    ds_read_b128 v[144:147], v222 offset:20480
    v_lshrrev_b32 v25, 3, v24
    v_lshlrev_b32 v25, 2, v25
    v_mfma_f32_16x16x32_bf16 v[88:91], a[40:43], v[148:151], v[88:91]
    buffer_load_dwordx4 a[144:147], v174, s[4:7], s22 offen
    v_add_u32 v41, v41, v25
    v_mfma_f32_16x16x32_bf16 v[92:95], a[120:123], v[148:151], v[92:95]
    ds_read_b128 v[148:151], v222 offset:22528
    s_and_b32 s88, s30, 1
    s_lshl_b32 s88, s88, 3
    s_waitcnt lgkmcnt(6)
    v_mfma_f32_16x16x32_bf16 v[96:99], a[40:43], v[152:155], v[96:99]
    v_add_u32 v41, s88, v41
    v_mov_b32 v43, 0
    v_mfma_f32_16x16x32_bf16 v[100:103], a[120:123], v[152:155], v[100:103]
    ds_read_b128 v[152:155], v222 offset:24576
    buffer_load_dwordx4 v[196:199], v178, s[4:7], s90 offen sc1
    v_mfma_f32_16x16x32_bf16 v[104:107], a[40:43], v[156:159], v[104:107]
    s_lshl_b32 s88, s30, 8
    s_add_u32 s88, s88, 160832
    v_mfma_f32_16x16x32_bf16 v[108:111], a[120:123], v[156:159], v[108:111]
    ds_read_b128 v[156:159], v222 offset:26624
    v_lshlrev_b32 v25, 4, v24
    v_add_u32 v25, s88, v25
    s_waitcnt lgkmcnt(6)
    v_mfma_f32_16x16x32_bf16 v[112:115], a[40:43], v[160:163], v[112:115]
    ds_write_b128 v25, v[40:43]
    v_mfma_f32_16x16x32_bf16 v[116:119], a[120:123], v[160:163], v[116:119]
    ds_read_b128 v[160:163], v222 offset:28672
    v_mfma_f32_16x16x32_bf16 v[120:123], a[40:43], v[164:167], v[120:123]
    v_mfma_f32_16x16x32_bf16 v[124:127], a[120:123], v[164:167], v[124:127]
    ds_read_b128 v[164:167], v222 offset:30720
    s_waitcnt vmcnt(13)
    s_barrier
    v_mfma_f32_16x16x32_bf16 v[12:15], a[44:47], v[168:171], v[12:15]
    v_mfma_f32_16x16x32_bf16 v[16:19], a[124:127], v[168:171], v[16:19]
    s_waitcnt lgkmcnt(6)
    v_mfma_f32_16x16x32_bf16 v[64:67], a[44:47], v[136:139], v[64:67]
    s_add_u32 s20, s79, 1024
    s_add_u32 m0, s80, 0
    v_mfma_f32_16x16x32_bf16 v[68:71], a[124:127], v[136:139], v[68:71]
    ds_read_b128 v[136:139], v221 offset:32768
    buffer_load_dwordx4 v173, s[8:11], s20 offen lds
    v_mfma_f32_16x16x32_bf16 v[72:75], a[44:47], v[140:143], v[72:75]
    s_add_u32 s20, s79, 11264
    s_add_u32 m0, s80, 1024
    v_mfma_f32_16x16x32_bf16 v[76:79], a[124:127], v[140:143], v[76:79]
    ds_read_b128 v[140:143], v221 offset:34816
    s_waitcnt lgkmcnt(6)
    v_mfma_f32_16x16x32_bf16 v[80:83], a[44:47], v[144:147], v[80:83]
    buffer_load_dwordx4 v173, s[8:11], s20 offen lds
    s_add_u32 s20, s79, 21504
    v_mfma_f32_16x16x32_bf16 v[84:87], a[124:127], v[144:147], v[84:87]
    ds_read_b128 v[144:147], v221 offset:36864
    s_add_u32 m0, s80, 2048
    v_mfma_f32_16x16x32_bf16 v[88:91], a[44:47], v[148:151], v[88:91]
    v_mfma_f32_16x16x32_bf16 v[92:95], a[124:127], v[148:151], v[92:95]
    ds_read_b128 v[148:151], v221 offset:38912
    buffer_load_dwordx4 v173, s[8:11], s20 offen lds
    s_waitcnt lgkmcnt(6)
    v_mfma_f32_16x16x32_bf16 v[96:99], a[44:47], v[152:155], v[96:99]
    s_add_u32 s20, s79, 31744
    s_add_u32 m0, s80, 3072
    v_mfma_f32_16x16x32_bf16 v[100:103], a[124:127], v[152:155], v[100:103]
    ds_read_b128 v[152:155], v221 offset:40960
    v_mfma_f32_16x16x32_bf16 v[104:107], a[44:47], v[156:159], v[104:107]
    buffer_load_dwordx4 v173, s[8:11], s20 offen lds
    s_add_u32 s22, s81, 17408
    v_mfma_f32_16x16x32_bf16 v[108:111], a[124:127], v[156:159], v[108:111]
    ds_read_b128 v[156:159], v221 offset:43008
    s_waitcnt lgkmcnt(6)
    v_mfma_f32_16x16x32_bf16 v[112:115], a[44:47], v[160:163], v[112:115]
    v_mfma_f32_16x16x32_bf16 v[116:119], a[124:127], v[160:163], v[116:119]
    ds_read_b128 v[160:163], v221 offset:45056
    buffer_load_dwordx4 a[68:71], v1, s[4:7], s22 offen
    v_mfma_f32_16x16x32_bf16 v[120:123], a[44:47], v[164:167], v[120:123]
    v_mfma_f32_16x16x32_bf16 v[124:127], a[124:127], v[164:167], v[124:127]
    ds_read_b128 v[164:167], v221 offset:47104
    v_mfma_f32_16x16x32_bf16 v[12:15], a[48:51], v[168:171], v[12:15]
    v_mfma_f32_16x16x32_bf16 v[16:19], a[128:131], v[168:171], v[16:19]
    s_waitcnt lgkmcnt(6)
    v_mfma_f32_16x16x32_bf16 v[64:67], a[48:51], v[136:139], v[64:67]
    buffer_load_dwordx4 a[148:151], v174, s[4:7], s22 offen
    s_add_u32 s22, s81, 18432
    v_mfma_f32_16x16x32_bf16 v[68:71], a[128:131], v[136:139], v[68:71]
    ds_read_b128 v[136:139], v222 offset:32768
    v_mfma_f32_16x16x32_bf16 v[72:75], a[48:51], v[140:143], v[72:75]
    v_mfma_f32_16x16x32_bf16 v[76:79], a[128:131], v[140:143], v[76:79]
    ds_read_b128 v[140:143], v222 offset:34816
    buffer_load_dwordx4 a[72:75], v1, s[4:7], s22 offen
    s_waitcnt lgkmcnt(6)
    v_mfma_f32_16x16x32_bf16 v[80:83], a[48:51], v[144:147], v[80:83]
    v_mfma_f32_16x16x32_bf16 v[84:87], a[128:131], v[144:147], v[84:87]
    ds_read_b128 v[144:147], v222 offset:36864
    v_mfma_f32_16x16x32_bf16 v[88:91], a[48:51], v[148:151], v[88:91]
    buffer_load_dwordx4 a[152:155], v174, s[4:7], s22 offen
    s_mul_i32 s20, s30, 320
    v_mfma_f32_16x16x32_bf16 v[92:95], a[128:131], v[148:151], v[92:95]
    ds_read_b128 v[148:151], v222 offset:38912
    s_add_u32 s20, s20, s82
    s_waitcnt lgkmcnt(6)
    v_mfma_f32_16x16x32_bf16 v[96:99], a[48:51], v[152:155], v[96:99]
    s_mul_i32 s21, s30, 5120
    s_add_u32 m0, s21, 0
    v_mfma_f32_16x16x32_bf16 v[100:103], a[128:131], v[152:155], v[100:103]
    ds_read_b128 v[152:155], v222 offset:40960
    buffer_load_dwordx4 v172, s[8:11], s20 offen lds
    v_mfma_f32_16x16x32_bf16 v[104:107], a[48:51], v[156:159], v[104:107]
    s_add_u32 s20, s20, 64
    s_add_u32 m0, s21, 1024
    v_mfma_f32_16x16x32_bf16 v[108:111], a[128:131], v[156:159], v[108:111]
    ds_read_b128 v[156:159], v222 offset:43008
    s_waitcnt lgkmcnt(6)
    v_mfma_f32_16x16x32_bf16 v[112:115], a[48:51], v[160:163], v[112:115]
    buffer_load_dwordx4 v172, s[8:11], s20 offen lds
    s_add_u32 s20, s20, 64
    v_mfma_f32_16x16x32_bf16 v[116:119], a[128:131], v[160:163], v[116:119]
    ds_read_b128 v[160:163], v222 offset:45056
    s_add_u32 m0, s21, 2048
    v_mfma_f32_16x16x32_bf16 v[120:123], a[48:51], v[164:167], v[120:123]
    v_mfma_f32_16x16x32_bf16 v[124:127], a[128:131], v[164:167], v[124:127]
    ds_read_b128 v[164:167], v222 offset:47104
    buffer_load_dwordx4 v172, s[8:11], s20 offen lds
    s_waitcnt vmcnt(16)
    s_barrier
    v_mfma_f32_16x16x32_bf16 v[12:15], a[52:55], v[168:171], v[12:15]
    v_mfma_f32_16x16x32_bf16 v[16:19], a[132:135], v[168:171], v[16:19]
    s_waitcnt lgkmcnt(6)
    v_mfma_f32_16x16x32_bf16 v[64:67], a[52:55], v[136:139], v[64:67]
    s_add_u32 s20, s20, 64
    s_add_u32 m0, s21, 3072
    v_mfma_f32_16x16x32_bf16 v[68:71], a[132:135], v[136:139], v[68:71]
    ds_read_b128 v[136:139], v221 offset:49152
    v_mfma_f32_16x16x32_bf16 v[72:75], a[52:55], v[140:143], v[72:75]
    buffer_load_dwordx4 v172, s[8:11], s20 offen lds
    s_add_u32 s20, s20, 64
    v_mfma_f32_16x16x32_bf16 v[76:79], a[132:135], v[140:143], v[76:79]
    ds_read_b128 v[140:143], v221 offset:51200
    s_add_u32 m0, s21, 4096
    s_waitcnt lgkmcnt(6)
    v_mfma_f32_16x16x32_bf16 v[80:83], a[52:55], v[144:147], v[80:83]
    v_mfma_f32_16x16x32_bf16 v[84:87], a[132:135], v[144:147], v[84:87]
    ds_read_b128 v[144:147], v221 offset:53248
    buffer_load_dwordx4 v172, s[8:11], s20 offen lds
    v_mfma_f32_16x16x32_bf16 v[88:91], a[52:55], v[148:151], v[88:91]
    s_add_u32 s20, s79, 1152
    s_add_u32 m0, s80, 16384
    v_mfma_f32_16x16x32_bf16 v[92:95], a[132:135], v[148:151], v[92:95]
    ds_read_b128 v[148:151], v221 offset:55296
    s_waitcnt lgkmcnt(6)
    v_mfma_f32_16x16x32_bf16 v[96:99], a[52:55], v[152:155], v[96:99]
    buffer_load_dwordx4 v173, s[8:11], s20 offen lds
    s_add_u32 s20, s79, 11392
    v_mfma_f32_16x16x32_bf16 v[100:103], a[132:135], v[152:155], v[100:103]
    ds_read_b128 v[152:155], v221 offset:57344
    s_add_u32 m0, s80, 17408
    v_mfma_f32_16x16x32_bf16 v[104:107], a[52:55], v[156:159], v[104:107]
    v_mfma_f32_16x16x32_bf16 v[108:111], a[132:135], v[156:159], v[108:111]
    ds_read_b128 v[156:159], v221 offset:59392
    buffer_load_dwordx4 v173, s[8:11], s20 offen lds
    s_waitcnt lgkmcnt(6)
    v_mfma_f32_16x16x32_bf16 v[112:115], a[52:55], v[160:163], v[112:115]
    s_add_u32 s20, s79, 21632
    s_add_u32 m0, s80, 18432
    v_mfma_f32_16x16x32_bf16 v[116:119], a[132:135], v[160:163], v[116:119]
    ds_read_b128 v[160:163], v221 offset:61440
    v_mfma_f32_16x16x32_bf16 v[120:123], a[52:55], v[164:167], v[120:123]
    buffer_load_dwordx4 v173, s[8:11], s20 offen lds
    s_add_u32 s20, s79, 31872
    v_mfma_f32_16x16x32_bf16 v[124:127], a[132:135], v[164:167], v[124:127]
    ds_read_b128 v[164:167], v221 offset:63488
    s_add_u32 m0, s80, 19456
    s_nop 0
    buffer_load_dwordx4 v173, s[8:11], s20 offen lds
    s_add_u32 s22, s81, 19456
    buffer_load_dwordx4 a[76:79], v1, s[4:7], s22 offen
    buffer_load_dwordx4 a[156:159], v174, s[4:7], s22 offen
    s_waitcnt vmcnt(19)
    v_subrev_u32 v196, s91, v196
    v_subrev_u32 v197, s91, v197
    v_subrev_u32 v198, s91, v198
    v_subrev_u32 v199, s91, v199
    v_max_u32 v24, v196, v197
    v_max_u32 v25, v198, v199
    v_max_u32 v24, v24, v25
    v_cmp_le_u32 s[84:85], 8, v24
    s_nop 1
    s_cmp_eq_u64 s[84:85], 0
    s_cbranch_scc1 SK_17
    s_mov_b32 s83, 0
SL_18:
    s_add_u32 s83, s83, 1
    s_cmp_gt_u32 s83, 200000
    s_cbranch_scc1 L_END
    s_sleep 4
    buffer_load_dwordx4 v[196:199], v178, s[4:7], s90 offen sc1
    s_waitcnt vmcnt(0)
    v_subrev_u32 v196, s91, v196
    v_subrev_u32 v197, s91, v197
    v_subrev_u32 v198, s91, v198
    v_subrev_u32 v199, s91, v199
    v_max_u32 v24, v196, v197
    v_max_u32 v25, v198, v199
    v_max_u32 v24, v24, v25
    v_cmp_le_u32 s[84:85], 8, v24
    s_nop 1
    s_cmp_eq_u64 s[84:85], 0
    s_cbranch_scc0 SL_18
SK_17:
    v_xor_b32 v196, s38, v196
    v_xor_b32 v197, s38, v197
    v_xor_b32 v198, s38, v198
    v_xor_b32 v199, s38, v199
    v_or_b32 v24, v196, v197
    v_or_b32 v25, v198, v199
    v_or_b32 v24, v24, v25
    v_cmp_ne_u32 s[84:85], 0, v24
    s_lshl_b32 s20, s28, 3
    s_nop 0
    s_lshr_b64 s[84:85], s[84:85], s20
    s_and_b32 s20, s84, 0xff
    s_cmp_lg_u32 s20, 0
    s_cselect_b32 s36, 1, 0
    v_mfma_f32_16x16x32_bf16 v[12:15], a[56:59], v[168:171], v[12:15]
    v_mfma_f32_16x16x32_bf16 v[16:19], a[136:139], v[168:171], v[16:19]
    s_waitcnt lgkmcnt(6)
    v_mfma_f32_16x16x32_bf16 v[64:67], a[56:59], v[136:139], v[64:67]
    v_mfma_f32_16x16x32_bf16 v[68:71], a[136:139], v[136:139], v[68:71]
    ds_read_b128 v[136:139], v222 offset:49152
    v_mfma_f32_16x16x32_bf16 v[72:75], a[56:59], v[140:143], v[72:75]
    v_mfma_f32_16x16x32_bf16 v[76:79], a[136:139], v[140:143], v[76:79]
    ds_read_b128 v[140:143], v222 offset:51200
    s_waitcnt lgkmcnt(6)
    v_mfma_f32_16x16x32_bf16 v[80:83], a[56:59], v[144:147], v[80:83]
    v_mfma_f32_16x16x32_bf16 v[84:87], a[136:139], v[144:147], v[84:87]
    ds_read_b128 v[144:147], v222 offset:53248
    v_mfma_f32_16x16x32_bf16 v[88:91], a[56:59], v[148:151], v[88:91]
    v_mfma_f32_16x16x32_bf16 v[92:95], a[136:139], v[148:151], v[92:95]
    ds_read_b128 v[148:151], v222 offset:55296
    s_waitcnt lgkmcnt(6)
    v_mfma_f32_16x16x32_bf16 v[96:99], a[56:59], v[152:155], v[96:99]
    v_mfma_f32_16x16x32_bf16 v[100:103], a[136:139], v[152:155], v[100:103]
    ds_read_b128 v[152:155], v222 offset:57344
    v_mfma_f32_16x16x32_bf16 v[104:107], a[56:59], v[156:159], v[104:107]
    v_mfma_f32_16x16x32_bf16 v[108:111], a[136:139], v[156:159], v[108:111]
    ds_read_b128 v[156:159], v222 offset:59392
    s_waitcnt lgkmcnt(6)
    v_mfma_f32_16x16x32_bf16 v[112:115], a[56:59], v[160:163], v[112:115]
    v_mfma_f32_16x16x32_bf16 v[116:119], a[136:139], v[160:163], v[116:119]
    ds_read_b128 v[160:163], v222 offset:61440
    v_mfma_f32_16x16x32_bf16 v[120:123], a[56:59], v[164:167], v[120:123]
    v_mfma_f32_16x16x32_bf16 v[124:127], a[136:139], v[164:167], v[124:127]
    ds_read_b128 v[164:167], v222 offset:63488
    s_waitcnt vmcnt(15)
    s_barrier
    s_mul_i32 s20, s30, 36
    v_add_u32 v24, s20, v0
    v_lshlrev_b32 v25, 3, v24
    s_lshl_b32 s20, s31, 10
    s_sub_u32 s20, s20, 128
    s_add_u32 s20, s20, s37
    s_add_u32 s20, s20, 6914048
    s_sub_u32 s21, s37, 6955008
    s_add_u32 s21, s21, 6915968
    s_cmp_eq_u32 s28, 0
    s_cselect_b32 s21, 0x40000000, s21
    s_cmp_eq_u32 s31, 0
    s_cselect_b32 s22, 1, 0
    v_add_u32 v26, s20, v25
    v_add_u32 v27, s21, v25
    v_cmp_gt_u32 vcc, 16, v24
    s_cmp_eq_u32 s31, 0
    s_nop 0
    s_cselect_b64 s[84:85], vcc, 0
    v_cndmask_b32 v177, v26, v27, s[84:85]
    v_mov_b32 v27, 0x40000000
    v_cmp_le_u32 vcc, 36, v0
    s_nop 1
    v_cndmask_b32 v177, v177, v27, vcc
    s_mov_b32 s20, 0
    buffer_load_dwordx2 v[180:181], v177, s[4:7], s20 offen sc1
    s_mov_b32 s20, 2048
    buffer_load_dwordx2 v[182:183], v177, s[4:7], s20 offen sc1
    s_mov_b32 s20, 4096
    buffer_load_dwordx2 v[184:185], v177, s[4:7], s20 offen sc1
    s_mov_b32 s20, 6144
    buffer_load_dwordx2 v[186:187], v177, s[4:7], s20 offen sc1
    s_mov_b32 s20, 8192
    buffer_load_dwordx2 v[188:189], v177, s[4:7], s20 offen sc1
    s_mov_b32 s20, 10240
    buffer_load_dwordx2 v[190:191], v177, s[4:7], s20 offen sc1
    s_mov_b32 s20, 12288
    buffer_load_dwordx2 v[192:193], v177, s[4:7], s20 offen sc1
    s_mov_b32 s20, 14336
    buffer_load_dwordx2 v[194:195], v177, s[4:7], s20 offen sc1
    s_mov_b32 s55, s37
    s_mul_i32 s54, s35, 1556480
    s_add_u32 s54, s54, 3457024
    s_mul_i32 s54, s54, s36
    s_add_u32 s54, s54, s37
    v_lshrrev_b32 v24, 5, v0
    s_lshl_b32 s75, s30, 1
    v_add_u32 v24, s75, v24
    v_add_u32 v25, s64, v24
    v_mul_u32_u24 v25, 2560, v25
    v_and_b32 v26, 31, v0
    v_lshlrev_b32 v26, 2, v26
    v_add_u32 v25, v25, v26
    s_cmp_lt_u32 s32, 12
    s_cselect_b32 s75, 7, 6
    v_mov_b32 v26, 0x40000000
    v_cmp_gt_u32 vcc, s75, v24
    s_nop 1
    v_cndmask_b32 v29, v26, v25, vcc
    v_mfma_f32_16x16x32_bf16 v[12:15], a[60:63], v[168:171], v[12:15]
    v_mfma_f32_16x16x32_bf16 v[16:19], a[140:143], v[168:171], v[16:19]
    s_waitcnt lgkmcnt(6)
    v_mfma_f32_16x16x32_bf16 v[64:67], a[60:63], v[136:139], v[64:67]
    s_mov_b32 s75, 10076160
    buffer_load_dword v196, v29, s[4:7], s75 offen offset:0
    v_mfma_f32_16x16x32_bf16 v[68:71], a[140:143], v[136:139], v[68:71]
    ds_read_b128 v[136:139], v221 offset:0
    v_mfma_f32_16x16x32_bf16 v[72:75], a[60:63], v[140:143], v[72:75]
    v_mfma_f32_16x16x32_bf16 v[76:79], a[140:143], v[140:143], v[76:79]
    ds_read_b128 v[140:143], v221 offset:2048
    buffer_load_dword v197, v29, s[4:7], s75 offen offset:128
    s_waitcnt lgkmcnt(6)
    v_mfma_f32_16x16x32_bf16 v[80:83], a[60:63], v[144:147], v[80:83]
    v_mfma_f32_16x16x32_bf16 v[84:87], a[140:143], v[144:147], v[84:87]
    ds_read_b128 v[144:147], v221 offset:4096
    v_mfma_f32_16x16x32_bf16 v[88:91], a[60:63], v[148:151], v[88:91]
    buffer_load_dword v198, v29, s[4:7], s75 offen offset:256
    v_mfma_f32_16x16x32_bf16 v[92:95], a[140:143], v[148:151], v[92:95]
    ds_read_b128 v[148:151], v221 offset:6144
    s_waitcnt lgkmcnt(6)
    v_mfma_f32_16x16x32_bf16 v[96:99], a[60:63], v[152:155], v[96:99]
    v_mfma_f32_16x16x32_bf16 v[100:103], a[140:143], v[152:155], v[100:103]
    ds_read_b128 v[152:155], v221 offset:8192
    buffer_load_dword v199, v29, s[4:7], s75 offen offset:384
    v_mfma_f32_16x16x32_bf16 v[104:107], a[60:63], v[156:159], v[104:107]
    v_mfma_f32_16x16x32_bf16 v[108:111], a[140:143], v[156:159], v[108:111]
    ds_read_b128 v[156:159], v221 offset:10240
    s_waitcnt lgkmcnt(6)
    v_mfma_f32_16x16x32_bf16 v[112:115], a[60:63], v[160:163], v[112:115]
    buffer_load_dword v200, v29, s[4:7], s75 offen offset:512
    v_mfma_f32_16x16x32_bf16 v[116:119], a[140:143], v[160:163], v[116:119]
    ds_read_b128 v[160:163], v221 offset:12288
    v_mfma_f32_16x16x32_bf16 v[120:123], a[60:63], v[164:167], v[120:123]
    v_mfma_f32_16x16x32_bf16 v[124:127], a[140:143], v[164:167], v[124:127]
    ds_read_b128 v[164:167], v221 offset:14336
    buffer_load_dword v201, v29, s[4:7], s75 offen offset:640
    v_mfma_f32_16x16x32_bf16 v[12:15], a[64:67], v[168:171], v[12:15]
    v_mfma_f32_16x16x32_bf16 v[16:19], a[144:147], v[168:171], v[16:19]
    s_waitcnt lgkmcnt(6)
    v_mfma_f32_16x16x32_bf16 v[64:67], a[64:67], v[136:139], v[64:67]
    v_mfma_f32_16x16x32_bf16 v[68:71], a[144:147], v[136:139], v[68:71]
    ds_read_b128 v[136:139], v222 offset:0
    v_mfma_f32_16x16x32_bf16 v[72:75], a[64:67], v[140:143], v[72:75]
    buffer_load_dword v202, v29, s[4:7], s75 offen offset:768
    v_mfma_f32_16x16x32_bf16 v[76:79], a[144:147], v[140:143], v[76:79]
    ds_read_b128 v[140:143], v222 offset:2048
    s_waitcnt lgkmcnt(6)
    v_mfma_f32_16x16x32_bf16 v[80:83], a[64:67], v[144:147], v[80:83]
    v_mfma_f32_16x16x32_bf16 v[84:87], a[144:147], v[144:147], v[84:87]
    ds_read_b128 v[144:147], v222 offset:4096
    buffer_load_dword v203, v29, s[4:7], s75 offen offset:896
    v_mfma_f32_16x16x32_bf16 v[88:91], a[64:67], v[148:151], v[88:91]
    v_mfma_f32_16x16x32_bf16 v[92:95], a[144:147], v[148:151], v[92:95]
    ds_read_b128 v[148:151], v222 offset:6144
    s_waitcnt lgkmcnt(6)
    v_mfma_f32_16x16x32_bf16 v[96:99], a[64:67], v[152:155], v[96:99]
    buffer_load_dword v204, v29, s[4:7], s75 offen offset:1024
    v_mfma_f32_16x16x32_bf16 v[100:103], a[144:147], v[152:155], v[100:103]
    ds_read_b128 v[152:155], v222 offset:8192
    v_mfma_f32_16x16x32_bf16 v[104:107], a[64:67], v[156:159], v[104:107]
    v_mfma_f32_16x16x32_bf16 v[108:111], a[144:147], v[156:159], v[108:111]
    ds_read_b128 v[156:159], v222 offset:10240
    buffer_load_dword v205, v29, s[4:7], s75 offen offset:1152
    s_waitcnt lgkmcnt(6)
    v_mfma_f32_16x16x32_bf16 v[112:115], a[64:67], v[160:163], v[112:115]
    v_mfma_f32_16x16x32_bf16 v[116:119], a[144:147], v[160:163], v[116:119]
    ds_read_b128 v[160:163], v222 offset:12288
    v_mfma_f32_16x16x32_bf16 v[120:123], a[64:67], v[164:167], v[120:123]
    buffer_load_dword v206, v29, s[4:7], s75 offen offset:1280
    v_mfma_f32_16x16x32_bf16 v[124:127], a[144:147], v[164:167], v[124:127]
    ds_read_b128 v[164:167], v222 offset:14336
    s_waitcnt vmcnt(21)
    s_barrier
    v_mfma_f32_16x16x32_bf16 v[12:15], a[68:71], v[168:171], v[12:15]
    v_mfma_f32_16x16x32_bf16 v[16:19], a[148:151], v[168:171], v[16:19]
    s_waitcnt lgkmcnt(6)
    v_mfma_f32_16x16x32_bf16 v[64:67], a[68:71], v[136:139], v[64:67]
    v_mfma_f32_16x16x32_bf16 v[68:71], a[148:151], v[136:139], v[68:71]
    ds_read_b128 v[136:139], v221 offset:16384
    buffer_load_dword v207, v29, s[4:7], s75 offen offset:1408
    v_mfma_f32_16x16x32_bf16 v[72:75], a[68:71], v[140:143], v[72:75]
    v_mfma_f32_16x16x32_bf16 v[76:79], a[148:151], v[140:143], v[76:79]
    ds_read_b128 v[140:143], v221 offset:18432
    s_waitcnt lgkmcnt(6)
    v_mfma_f32_16x16x32_bf16 v[80:83], a[68:71], v[144:147], v[80:83]
    buffer_load_dword v208, v29, s[4:7], s75 offen offset:1536
    v_mfma_f32_16x16x32_bf16 v[84:87], a[148:151], v[144:147], v[84:87]
    ds_read_b128 v[144:147], v221 offset:20480
    v_mfma_f32_16x16x32_bf16 v[88:91], a[68:71], v[148:151], v[88:91]
    v_mfma_f32_16x16x32_bf16 v[92:95], a[148:151], v[148:151], v[92:95]
    ds_read_b128 v[148:151], v221 offset:22528
    buffer_load_dword v209, v29, s[4:7], s75 offen offset:1664
    s_waitcnt lgkmcnt(6)
    v_mfma_f32_16x16x32_bf16 v[96:99], a[68:71], v[152:155], v[96:99]
    v_mfma_f32_16x16x32_bf16 v[100:103], a[148:151], v[152:155], v[100:103]
    ds_read_b128 v[152:155], v221 offset:24576
    v_mfma_f32_16x16x32_bf16 v[104:107], a[68:71], v[156:159], v[104:107]
    buffer_load_dword v210, v29, s[4:7], s75 offen offset:1792
    v_mfma_f32_16x16x32_bf16 v[108:111], a[148:151], v[156:159], v[108:111]
    ds_read_b128 v[156:159], v221 offset:26624
    s_waitcnt lgkmcnt(6)
    v_mfma_f32_16x16x32_bf16 v[112:115], a[68:71], v[160:163], v[112:115]
    v_mfma_f32_16x16x32_bf16 v[116:119], a[148:151], v[160:163], v[116:119]
    ds_read_b128 v[160:163], v221 offset:28672
    buffer_load_dword v211, v29, s[4:7], s75 offen offset:1920
    v_mfma_f32_16x16x32_bf16 v[120:123], a[68:71], v[164:167], v[120:123]
    v_mfma_f32_16x16x32_bf16 v[124:127], a[148:151], v[164:167], v[124:127]
    ds_read_b128 v[164:167], v221 offset:30720
    s_waitcnt vmcnt(16)
    v_mfma_f32_16x16x32_bf16 v[12:15], a[72:75], v[168:171], v[12:15]
    v_mfma_f32_16x16x32_bf16 v[16:19], a[152:155], v[168:171], v[16:19]
    s_waitcnt lgkmcnt(6)
    v_mfma_f32_16x16x32_bf16 v[64:67], a[72:75], v[136:139], v[64:67]
    buffer_load_dword v212, v29, s[4:7], s75 offen offset:2048
    v_mfma_f32_16x16x32_bf16 v[68:71], a[152:155], v[136:139], v[68:71]
    ds_read_b128 v[136:139], v222 offset:16384
    v_mfma_f32_16x16x32_bf16 v[72:75], a[72:75], v[140:143], v[72:75]
    v_mfma_f32_16x16x32_bf16 v[76:79], a[152:155], v[140:143], v[76:79]
    ds_read_b128 v[140:143], v222 offset:18432
    buffer_load_dword v213, v29, s[4:7], s75 offen offset:2176
    s_waitcnt lgkmcnt(6)
    v_mfma_f32_16x16x32_bf16 v[80:83], a[72:75], v[144:147], v[80:83]
    v_mfma_f32_16x16x32_bf16 v[84:87], a[152:155], v[144:147], v[84:87]
    ds_read_b128 v[144:147], v222 offset:20480
    v_mfma_f32_16x16x32_bf16 v[88:91], a[72:75], v[148:151], v[88:91]
    buffer_load_dword v214, v29, s[4:7], s75 offen offset:2304
    v_mfma_f32_16x16x32_bf16 v[92:95], a[152:155], v[148:151], v[92:95]
    ds_read_b128 v[148:151], v222 offset:22528
    s_waitcnt lgkmcnt(6)
    v_mfma_f32_16x16x32_bf16 v[96:99], a[72:75], v[152:155], v[96:99]
    v_mfma_f32_16x16x32_bf16 v[100:103], a[152:155], v[152:155], v[100:103]
    ds_read_b128 v[152:155], v222 offset:24576
    buffer_load_dword v215, v29, s[4:7], s75 offen offset:2432
    v_mfma_f32_16x16x32_bf16 v[104:107], a[72:75], v[156:159], v[104:107]
    s_lshl_b32 s25, s30, 10
    s_add_u32 s25, s25, 156672
    v_mfma_f32_16x16x32_bf16 v[108:111], a[152:155], v[156:159], v[108:111]
    ds_read_b128 v[156:159], v222 offset:26624
    v_add_u32 v220, s25, v1
    s_waitcnt lgkmcnt(6)
    v_mfma_f32_16x16x32_bf16 v[112:115], a[72:75], v[160:163], v[112:115]
    ds_read_b128 v[216:219], v220
    s_add_u32 s75, s61, 20480
    v_mfma_f32_16x16x32_bf16 v[116:119], a[152:155], v[160:163], v[116:119]
    ds_read_b128 v[160:163], v222 offset:28672
    s_add_u32 m0, s60, 20480
    v_mfma_f32_16x16x32_bf16 v[120:123], a[72:75], v[164:167], v[120:123]
    buffer_load_dwordx4 v1, s[4:7], s75 offen offset:0 lds
    v_mfma_f32_16x16x32_bf16 v[124:127], a[152:155], v[164:167], v[124:127]
    ds_read_b128 v[164:167], v222 offset:30720
    buffer_load_dwordx4 v1, s[4:7], s75 offen offset:1024 lds
    buffer_load_dwordx4 v1, s[4:7], s75 offen offset:2048 lds
    buffer_load_dwordx4 v1, s[4:7], s75 offen offset:3072 lds
    s_add_u32 m0, s60, 24576
    s_add_u32 s75, s75, 4096
    buffer_load_dwordx4 v1, s[4:7], s75 offen lds
    s_add_u32 s75, s61, 40960
    s_add_u32 m0, s60, 40960
    s_nop 0
    buffer_load_dwordx4 v1, s[4:7], s75 offen offset:0 lds
    buffer_load_dwordx4 v1, s[4:7], s75 offen offset:1024 lds
    buffer_load_dwordx4 v1, s[4:7], s75 offen offset:2048 lds
    buffer_load_dwordx4 v1, s[4:7], s75 offen offset:3072 lds
    s_add_u32 m0, s60, 45056
    s_add_u32 s75, s75, 4096
    buffer_load_dwordx4 v1, s[4:7], s75 offen lds
    v_add_f32 v180, v180, v182
    v_add_f32 v181, v181, v183
    v_add_f32 v180, v180, v184
    v_add_f32 v181, v181, v185
    v_add_f32 v180, v180, v186
    v_add_f32 v181, v181, v187
    v_add_f32 v188, v188, v190
    v_add_f32 v189, v189, v191
    v_add_f32 v188, v188, v192
    v_add_f32 v189, v189, v193
    v_add_f32 v188, v188, v194
    v_add_f32 v189, v189, v195
    v_add_f32 v180, v180, v188
    v_add_f32 v181, v181, v189
    v_mul_f32 v180, 0x3acccccd, v180
    v_mul_f32 v181, 0x3acccccd, v181
    v_fma_f32 v181, -v180, v180, v181
    v_max_f32 v181, 0, v181
    v_cvt_pk_bf16_f32 v182, v180, v181
    v_lshlrev_b32 v180, 16, v182
    v_and_b32 v181, 0xffff0000, v182
    v_add_f32 v181, 0x3727c5ac, v181
    v_cvt_pk_bf16_f32 v182, v181, v181
    v_and_b32 v181, 0xffff0000, v182
    v_sqrt_f32 v181, v181
    s_nop 0
    v_cvt_pk_bf16_f32 v182, v181, v181
    v_and_b32 v181, 0xffff0000, v182
    v_rcp_f32 v181, v181
    v_xor_b32 v180, 0x80000000, v180
    s_mul_i32 s23, s30, 288
    s_add_u32 s23, s23, 151552
    v_lshlrev_b32 v183, 3, v0
    v_add_u32 v183, s23, v183
    s_mov_b32 exec_lo, 0xffffffff
    s_mov_b32 exec_hi, 0xf
    ds_write_b64 v183, v[180:181]
    s_mov_b64 exec, -1
    s_waitcnt lgkmcnt(0)
    buffer_load_dword v255, v216, s[4:7], s37 offen
    buffer_load_dword v255, v217, s[4:7], s37 offen
    buffer_load_dword v255, v218, s[4:7], s37 offen
    v_lshlrev_b32 v219, 3, v0
    buffer_load_dword v255, v219, s[4:7], s65 offen offset:0
    s_waitcnt vmcnt(14)
    v_add_f32 v196, v196, v197
    v_add_f32 v196, v196, v198
    v_add_f32 v196, v196, v199
    v_add_f32 v196, v196, v200
    v_add_f32 v196, v196, v201
    v_add_f32 v196, v196, v202
    v_add_f32 v196, v196, v203
    v_add_f32 v196, v196, v204
    v_add_f32 v196, v196, v205
    v_add_f32 v196, v196, v206
    v_add_f32 v196, v196, v207
    v_add_f32 v196, v196, v208
    v_add_f32 v196, v196, v209
    v_add_f32 v196, v196, v210
    v_add_f32 v196, v196, v211
    v_add_f32 v196, v196, v212
    v_add_f32 v196, v196, v213
    v_add_f32 v196, v196, v214
    v_add_f32 v196, v196, v215
    v_cvt_pk_bf16_f32 v197, v196, v196
    v_and_b32 v198, 0xffff0000, v197
    v_sub_f32 v199, v196, v198
    v_cvt_pk_bf16_f32 v200, v199, v199
    v_and_b32 v201, 0xffff0000, v200
    v_sub_f32 v202, v199, v201
    v_cvt_pk_bf16_f32 v203, v202, v202
    v_lshrrev_b32 v204, 16, v198
    v_or_b32 v204, v204, v201
    v_and_b32 v205, 0xffff, v203
    v_mov_b32 v206, 0
    v_mov_b32 v207, 0
    v_mov_b32 v208, 0
    v_mov_b32 v209, 0
    v_mov_b32 v210, 0
    v_mov_b32 v211, 0
    v_lshrrev_b32 v24, 5, v0
    v_lshlrev_b32 v24, 10, v24
    v_and_b32 v25, 31, v0
    v_lshlrev_b32 v25, 4, v25
    v_add_u32 v24, v24, v25
    s_lshl_b32 s75, s30, 11
    s_add_u32 s75, s75, 143360
    v_add_u32 v24, s75, v24
    ds_write_b128 v24, v[204:207]
    ds_write_b128 v24, v[208:211] offset:512
    v_mfma_f32_16x16x32_bf16 v[12:15], a[76:79], v[168:171], v[12:15]
    v_mfma_f32_16x16x32_bf16 v[16:19], a[156:159], v[168:171], v[16:19]
    s_waitcnt lgkmcnt(6)
    v_mfma_f32_16x16x32_bf16 v[64:67], a[76:79], v[136:139], v[64:67]
    v_mfma_f32_16x16x32_bf16 v[68:71], a[156:159], v[136:139], v[68:71]
    v_mfma_f32_16x16x32_bf16 v[72:75], a[76:79], v[140:143], v[72:75]
    v_mfma_f32_16x16x32_bf16 v[76:79], a[156:159], v[140:143], v[76:79]
    s_waitcnt lgkmcnt(4)
    v_mfma_f32_16x16x32_bf16 v[80:83], a[76:79], v[144:147], v[80:83]
    v_mfma_f32_16x16x32_bf16 v[84:87], a[156:159], v[144:147], v[84:87]
    v_mfma_f32_16x16x32_bf16 v[88:91], a[76:79], v[148:151], v[88:91]
    v_mfma_f32_16x16x32_bf16 v[92:95], a[156:159], v[148:151], v[92:95]
    s_waitcnt lgkmcnt(2)
    v_mfma_f32_16x16x32_bf16 v[96:99], a[76:79], v[152:155], v[96:99]
    v_mfma_f32_16x16x32_bf16 v[100:103], a[156:159], v[152:155], v[100:103]
    v_mfma_f32_16x16x32_bf16 v[104:107], a[76:79], v[156:159], v[104:107]
    v_mfma_f32_16x16x32_bf16 v[108:111], a[156:159], v[156:159], v[108:111]
    s_waitcnt lgkmcnt(0)
    v_mfma_f32_16x16x32_bf16 v[112:115], a[76:79], v[160:163], v[112:115]
    v_mfma_f32_16x16x32_bf16 v[116:119], a[156:159], v[160:163], v[116:119]
    v_mfma_f32_16x16x32_bf16 v[120:123], a[76:79], v[164:167], v[120:123]
    v_mfma_f32_16x16x32_bf16 v[124:127], a[156:159], v[164:167], v[124:127]
    s_branch L_COMMON
L_P1_L1:
    s_add_u32 s20, s79, 0
    s_add_u32 m0, s80, 0
    s_nop 0
    buffer_load_dwordx4 v172, s[4:7], s20 offen sc1 lds
    s_add_u32 s21, s79, 2048
    s_add_u32 m0, s80, 8192
    s_nop 0
    buffer_load_dwordx4 v172, s[4:7], s21 offen sc1 lds
    s_add_u32 m0, s80, 1024
    s_nop 0
    buffer_load_dwordx4 v173, s[4:7], s20 offen sc1 lds
    s_add_u32 m0, s80, 9216
    s_nop 0
    buffer_load_dwordx4 v173, s[4:7], s21 offen sc1 lds
    s_add_u32 s20, s79, 4096
    s_add_u32 m0, s80, 16384
    s_nop 0
    buffer_load_dwordx4 v172, s[4:7], s20 offen sc1 lds
    s_add_u32 s21, s79, 6144
    s_add_u32 m0, s80, 24576
    s_nop 0
    buffer_load_dwordx4 v172, s[4:7], s21 offen sc1 lds
    s_add_u32 m0, s80, 17408
    s_nop 0
    buffer_load_dwordx4 v173, s[4:7], s20 offen sc1 lds
    s_add_u32 m0, s80, 25600
    s_nop 0
    buffer_load_dwordx4 v173, s[4:7], s21 offen sc1 lds
    s_add_u32 s20, s79, 8192
    s_add_u32 m0, s80, 32768
    s_nop 0
    buffer_load_dwordx4 v172, s[4:7], s20 offen sc1 lds
    s_add_u32 s21, s79, 10240
    s_add_u32 m0, s80, 40960
    s_nop 0
    buffer_load_dwordx4 v172, s[4:7], s21 offen sc1 lds
    s_add_u32 m0, s80, 33792
    s_nop 0
    buffer_load_dwordx4 v173, s[4:7], s20 offen sc1 lds
    s_add_u32 m0, s80, 41984
    s_nop 0
    buffer_load_dwordx4 v173, s[4:7], s21 offen sc1 lds
    s_sub_u32 s90, s28, 1
    s_lshl_b32 s90, s90, 7
    s_add_u32 s90, s90, 65997824
    s_cmp_eq_u32 s28, 0
    s_cselect_b32 s90, 65997824, s90
    s_mov_b32 s88, 0xff
    s_mov_b32 s89, 0
    s_cmp_eq_u32 s28, 0
    s_cselect_b32 s88, 0, s88
    s_add_u32 s91, s86, 2
    v_lshlrev_b32 v178, 2, v0
    s_add_u32 s20, s65, 140
    s_add_u32 s21, s86, s39
    s_add_u32 s21, s21, 0x20
    s_cmp_eq_u32 s31, 1
    s_cselect_b32 s90, s20, s90
    s_cselect_b32 s91, s21, s91
    s_cselect_b32 s88, 0xff, s88
    s_cselect_b32 s20, 4, 2
    v_lshlrev_b32 v178, s20, v0
    s_waitcnt vmcnt(8)
    s_barrier
    ds_read_b128 v[136:139], v22 offset:0
    ds_read_b128 v[140:143], v22 offset:1024
    ds_read_b128 v[144:147], v22 offset:2048
    ds_read_b128 v[148:151], v22 offset:3072
    ds_read_b128 v[152:155], v22 offset:4096
    ds_read_b128 v[156:159], v22 offset:5120
    ds_read_b128 v[160:163], v22 offset:6144
    ds_read_b128 v[164:167], v22 offset:7168
    s_waitcnt lgkmcnt(6)
    v_mfma_f32_16x16x32_bf16 v[64:67], a[0:3], v[136:139], 0
    v_mfma_f32_16x16x32_bf16 v[68:71], a[80:83], v[136:139], 0
    ds_read_b128 v[136:139], v22 offset:8192
    v_mfma_f32_16x16x32_bf16 v[72:75], a[0:3], v[140:143], 0
    v_mfma_f32_16x16x32_bf16 v[76:79], a[80:83], v[140:143], 0
    ds_read_b128 v[140:143], v22 offset:9216
    s_waitcnt lgkmcnt(6)
    v_mfma_f32_16x16x32_bf16 v[80:83], a[0:3], v[144:147], 0
    v_mfma_f32_16x16x32_bf16 v[84:87], a[80:83], v[144:147], 0
    ds_read_b128 v[144:147], v22 offset:10240
    v_mfma_f32_16x16x32_bf16 v[88:91], a[0:3], v[148:151], 0
    v_mfma_f32_16x16x32_bf16 v[92:95], a[80:83], v[148:151], 0
    ds_read_b128 v[148:151], v22 offset:11264
    s_waitcnt lgkmcnt(6)
    v_mfma_f32_16x16x32_bf16 v[96:99], a[0:3], v[152:155], 0
    v_mfma_f32_16x16x32_bf16 v[100:103], a[80:83], v[152:155], 0
    ds_read_b128 v[152:155], v22 offset:12288
    v_mfma_f32_16x16x32_bf16 v[104:107], a[0:3], v[156:159], 0
    v_mfma_f32_16x16x32_bf16 v[108:111], a[80:83], v[156:159], 0
    ds_read_b128 v[156:159], v22 offset:13312
    s_waitcnt lgkmcnt(6)
    v_mfma_f32_16x16x32_bf16 v[112:115], a[0:3], v[160:163], 0
    v_mfma_f32_16x16x32_bf16 v[116:119], a[80:83], v[160:163], 0
    ds_read_b128 v[160:163], v22 offset:14336
    v_mfma_f32_16x16x32_bf16 v[120:123], a[0:3], v[164:167], 0
    v_mfma_f32_16x16x32_bf16 v[124:127], a[80:83], v[164:167], 0
    ds_read_b128 v[164:167], v22 offset:15360
    s_waitcnt vmcnt(4)
    s_barrier
    s_waitcnt lgkmcnt(6)
    v_mfma_f32_16x16x32_bf16 v[64:67], a[4:7], v[136:139], v[64:67]
    s_add_u32 s20, s79, 12288
    s_add_u32 m0, s80, 49152
    v_mfma_f32_16x16x32_bf16 v[68:71], a[84:87], v[136:139], v[68:71]
    ds_read_b128 v[136:139], v22 offset:16384
    buffer_load_dwordx4 v172, s[4:7], s20 offen sc1 lds
    v_mfma_f32_16x16x32_bf16 v[72:75], a[4:7], v[140:143], v[72:75]
    s_add_u32 s21, s79, 14336
    s_add_u32 m0, s80, 57344
    v_mfma_f32_16x16x32_bf16 v[76:79], a[84:87], v[140:143], v[76:79]
    ds_read_b128 v[140:143], v22 offset:17408
    s_waitcnt lgkmcnt(6)
    v_mfma_f32_16x16x32_bf16 v[80:83], a[4:7], v[144:147], v[80:83]
    buffer_load_dwordx4 v172, s[4:7], s21 offen sc1 lds
    s_add_u32 m0, s80, 50176
    v_mfma_f32_16x16x32_bf16 v[84:87], a[84:87], v[144:147], v[84:87]
    ds_read_b128 v[144:147], v22 offset:18432
    v_mfma_f32_16x16x32_bf16 v[88:91], a[4:7], v[148:151], v[88:91]
    v_mfma_f32_16x16x32_bf16 v[92:95], a[84:87], v[148:151], v[92:95]
    ds_read_b128 v[148:151], v22 offset:19456
    buffer_load_dwordx4 v173, s[4:7], s20 offen sc1 lds
    s_waitcnt lgkmcnt(6)
    v_mfma_f32_16x16x32_bf16 v[96:99], a[4:7], v[152:155], v[96:99]
    s_add_u32 m0, s80, 58368
    v_mfma_f32_16x16x32_bf16 v[100:103], a[84:87], v[152:155], v[100:103]
    ds_read_b128 v[152:155], v22 offset:20480
    v_mfma_f32_16x16x32_bf16 v[104:107], a[4:7], v[156:159], v[104:107]
    buffer_load_dwordx4 v173, s[4:7], s21 offen sc1 lds
    v_mfma_f32_16x16x32_bf16 v[108:111], a[84:87], v[156:159], v[108:111]
    ds_read_b128 v[156:159], v22 offset:21504
    s_waitcnt lgkmcnt(6)
    v_mfma_f32_16x16x32_bf16 v[112:115], a[4:7], v[160:163], v[112:115]
    v_mfma_f32_16x16x32_bf16 v[116:119], a[84:87], v[160:163], v[116:119]
    ds_read_b128 v[160:163], v22 offset:22528
    v_mfma_f32_16x16x32_bf16 v[120:123], a[4:7], v[164:167], v[120:123]
    v_mfma_f32_16x16x32_bf16 v[124:127], a[84:87], v[164:167], v[124:127]
    ds_read_b128 v[164:167], v22 offset:23552
    s_waitcnt lgkmcnt(6)
    v_mfma_f32_16x16x32_bf16 v[64:67], a[8:11], v[136:139], v[64:67]
    v_mfma_f32_16x16x32_bf16 v[68:71], a[88:91], v[136:139], v[68:71]
    ds_read_b128 v[136:139], v22 offset:24576
    v_mfma_f32_16x16x32_bf16 v[72:75], a[8:11], v[140:143], v[72:75]
    v_mfma_f32_16x16x32_bf16 v[76:79], a[88:91], v[140:143], v[76:79]
    ds_read_b128 v[140:143], v22 offset:25600
    s_waitcnt lgkmcnt(6)
    v_mfma_f32_16x16x32_bf16 v[80:83], a[8:11], v[144:147], v[80:83]
    v_mfma_f32_16x16x32_bf16 v[84:87], a[88:91], v[144:147], v[84:87]
    ds_read_b128 v[144:147], v22 offset:26624
    v_mfma_f32_16x16x32_bf16 v[88:91], a[8:11], v[148:151], v[88:91]
    v_mfma_f32_16x16x32_bf16 v[92:95], a[88:91], v[148:151], v[92:95]
    ds_read_b128 v[148:151], v22 offset:27648
    s_waitcnt lgkmcnt(6)
    v_mfma_f32_16x16x32_bf16 v[96:99], a[8:11], v[152:155], v[96:99]
    v_mfma_f32_16x16x32_bf16 v[100:103], a[88:91], v[152:155], v[100:103]
    ds_read_b128 v[152:155], v22 offset:28672
    v_mfma_f32_16x16x32_bf16 v[104:107], a[8:11], v[156:159], v[104:107]
    v_mfma_f32_16x16x32_bf16 v[108:111], a[88:91], v[156:159], v[108:111]
    ds_read_b128 v[156:159], v22 offset:29696
    s_waitcnt lgkmcnt(6)
    v_mfma_f32_16x16x32_bf16 v[112:115], a[8:11], v[160:163], v[112:115]
    v_mfma_f32_16x16x32_bf16 v[116:119], a[88:91], v[160:163], v[116:119]
    ds_read_b128 v[160:163], v22 offset:30720
    v_mfma_f32_16x16x32_bf16 v[120:123], a[8:11], v[164:167], v[120:123]
    v_mfma_f32_16x16x32_bf16 v[124:127], a[88:91], v[164:167], v[124:127]
    ds_read_b128 v[164:167], v22 offset:31744
    s_waitcnt vmcnt(4)
    s_barrier
    s_waitcnt lgkmcnt(6)
    v_mfma_f32_16x16x32_bf16 v[64:67], a[12:15], v[136:139], v[64:67]
    s_add_u32 s20, s79, 16384
    s_add_u32 m0, s80, 0
    v_mfma_f32_16x16x32_bf16 v[68:71], a[92:95], v[136:139], v[68:71]
    ds_read_b128 v[136:139], v22 offset:32768
    buffer_load_dwordx4 v172, s[4:7], s20 offen sc1 lds
    v_mfma_f32_16x16x32_bf16 v[72:75], a[12:15], v[140:143], v[72:75]
    s_add_u32 s21, s79, 18432
    s_add_u32 m0, s80, 8192
    v_mfma_f32_16x16x32_bf16 v[76:79], a[92:95], v[140:143], v[76:79]
    ds_read_b128 v[140:143], v22 offset:33792
    s_waitcnt lgkmcnt(6)
    v_mfma_f32_16x16x32_bf16 v[80:83], a[12:15], v[144:147], v[80:83]
    buffer_load_dwordx4 v172, s[4:7], s21 offen sc1 lds
    s_add_u32 m0, s80, 1024
    v_mfma_f32_16x16x32_bf16 v[84:87], a[92:95], v[144:147], v[84:87]
    ds_read_b128 v[144:147], v22 offset:34816
    v_mfma_f32_16x16x32_bf16 v[88:91], a[12:15], v[148:151], v[88:91]
    v_mfma_f32_16x16x32_bf16 v[92:95], a[92:95], v[148:151], v[92:95]
    ds_read_b128 v[148:151], v22 offset:35840
    buffer_load_dwordx4 v173, s[4:7], s20 offen sc1 lds
    s_waitcnt lgkmcnt(6)
    v_mfma_f32_16x16x32_bf16 v[96:99], a[12:15], v[152:155], v[96:99]
    s_add_u32 m0, s80, 9216
    v_mfma_f32_16x16x32_bf16 v[100:103], a[92:95], v[152:155], v[100:103]
    ds_read_b128 v[152:155], v22 offset:36864
    v_mfma_f32_16x16x32_bf16 v[104:107], a[12:15], v[156:159], v[104:107]
    buffer_load_dwordx4 v173, s[4:7], s21 offen sc1 lds
    v_mfma_f32_16x16x32_bf16 v[108:111], a[92:95], v[156:159], v[108:111]
    ds_read_b128 v[156:159], v22 offset:37888
    s_waitcnt lgkmcnt(6)
    v_mfma_f32_16x16x32_bf16 v[112:115], a[12:15], v[160:163], v[112:115]
    v_mfma_f32_16x16x32_bf16 v[116:119], a[92:95], v[160:163], v[116:119]
    ds_read_b128 v[160:163], v22 offset:38912
    v_mfma_f32_16x16x32_bf16 v[120:123], a[12:15], v[164:167], v[120:123]
    v_mfma_f32_16x16x32_bf16 v[124:127], a[92:95], v[164:167], v[124:127]
    ds_read_b128 v[164:167], v22 offset:39936
    s_waitcnt lgkmcnt(6)
    v_mfma_f32_16x16x32_bf16 v[64:67], a[16:19], v[136:139], v[64:67]
    v_mfma_f32_16x16x32_bf16 v[68:71], a[96:99], v[136:139], v[68:71]
    ds_read_b128 v[136:139], v22 offset:40960
    v_mfma_f32_16x16x32_bf16 v[72:75], a[16:19], v[140:143], v[72:75]
    v_mfma_f32_16x16x32_bf16 v[76:79], a[96:99], v[140:143], v[76:79]
    ds_read_b128 v[140:143], v22 offset:41984
    s_waitcnt lgkmcnt(6)
    v_mfma_f32_16x16x32_bf16 v[80:83], a[16:19], v[144:147], v[80:83]
    v_mfma_f32_16x16x32_bf16 v[84:87], a[96:99], v[144:147], v[84:87]
    ds_read_b128 v[144:147], v22 offset:43008
    v_mfma_f32_16x16x32_bf16 v[88:91], a[16:19], v[148:151], v[88:91]
    v_mfma_f32_16x16x32_bf16 v[92:95], a[96:99], v[148:151], v[92:95]
    ds_read_b128 v[148:151], v22 offset:44032
    s_waitcnt lgkmcnt(6)
    v_mfma_f32_16x16x32_bf16 v[96:99], a[16:19], v[152:155], v[96:99]
    v_mfma_f32_16x16x32_bf16 v[100:103], a[96:99], v[152:155], v[100:103]
    ds_read_b128 v[152:155], v22 offset:45056
    v_mfma_f32_16x16x32_bf16 v[104:107], a[16:19], v[156:159], v[104:107]
    v_mfma_f32_16x16x32_bf16 v[108:111], a[96:99], v[156:159], v[108:111]
    ds_read_b128 v[156:159], v22 offset:46080
    s_waitcnt lgkmcnt(6)
    v_mfma_f32_16x16x32_bf16 v[112:115], a[16:19], v[160:163], v[112:115]
    v_mfma_f32_16x16x32_bf16 v[116:119], a[96:99], v[160:163], v[116:119]
    ds_read_b128 v[160:163], v22 offset:47104
    v_mfma_f32_16x16x32_bf16 v[120:123], a[16:19], v[164:167], v[120:123]
    v_mfma_f32_16x16x32_bf16 v[124:127], a[96:99], v[164:167], v[124:127]
    ds_read_b128 v[164:167], v22 offset:48128
    s_waitcnt vmcnt(4)
    s_barrier
    s_waitcnt lgkmcnt(6)
    v_mfma_f32_16x16x32_bf16 v[64:67], a[20:23], v[136:139], v[64:67]
    s_add_u32 s20, s79, 20480
    s_add_u32 m0, s80, 16384
    v_mfma_f32_16x16x32_bf16 v[68:71], a[100:103], v[136:139], v[68:71]
    ds_read_b128 v[136:139], v22 offset:49152
    buffer_load_dwordx4 v172, s[4:7], s20 offen sc1 lds
    v_mfma_f32_16x16x32_bf16 v[72:75], a[20:23], v[140:143], v[72:75]
    s_add_u32 s21, s79, 22528
    s_add_u32 m0, s80, 24576
    v_mfma_f32_16x16x32_bf16 v[76:79], a[100:103], v[140:143], v[76:79]
    ds_read_b128 v[140:143], v22 offset:50176
    s_waitcnt lgkmcnt(6)
    v_mfma_f32_16x16x32_bf16 v[80:83], a[20:23], v[144:147], v[80:83]
    buffer_load_dwordx4 v172, s[4:7], s21 offen sc1 lds
    s_add_u32 m0, s80, 17408
    v_mfma_f32_16x16x32_bf16 v[84:87], a[100:103], v[144:147], v[84:87]
    ds_read_b128 v[144:147], v22 offset:51200
    v_mfma_f32_16x16x32_bf16 v[88:91], a[20:23], v[148:151], v[88:91]
    v_mfma_f32_16x16x32_bf16 v[92:95], a[100:103], v[148:151], v[92:95]
    ds_read_b128 v[148:151], v22 offset:52224
    buffer_load_dwordx4 v173, s[4:7], s20 offen sc1 lds
    s_waitcnt lgkmcnt(6)
    v_mfma_f32_16x16x32_bf16 v[96:99], a[20:23], v[152:155], v[96:99]
    s_add_u32 m0, s80, 25600
    v_mfma_f32_16x16x32_bf16 v[100:103], a[100:103], v[152:155], v[100:103]
    ds_read_b128 v[152:155], v22 offset:53248
    v_mfma_f32_16x16x32_bf16 v[104:107], a[20:23], v[156:159], v[104:107]
    buffer_load_dwordx4 v173, s[4:7], s21 offen sc1 lds
    v_mfma_f32_16x16x32_bf16 v[108:111], a[100:103], v[156:159], v[108:111]
    ds_read_b128 v[156:159], v22 offset:54272
    s_waitcnt lgkmcnt(6)
    v_mfma_f32_16x16x32_bf16 v[112:115], a[20:23], v[160:163], v[112:115]
    v_mfma_f32_16x16x32_bf16 v[116:119], a[100:103], v[160:163], v[116:119]
    ds_read_b128 v[160:163], v22 offset:55296
    v_mfma_f32_16x16x32_bf16 v[120:123], a[20:23], v[164:167], v[120:123]
    v_mfma_f32_16x16x32_bf16 v[124:127], a[100:103], v[164:167], v[124:127]
    ds_read_b128 v[164:167], v22 offset:56320
    s_waitcnt lgkmcnt(6)
    v_mfma_f32_16x16x32_bf16 v[64:67], a[24:27], v[136:139], v[64:67]
    v_mfma_f32_16x16x32_bf16 v[68:71], a[104:107], v[136:139], v[68:71]
    ds_read_b128 v[136:139], v22 offset:57344
    v_mfma_f32_16x16x32_bf16 v[72:75], a[24:27], v[140:143], v[72:75]
    v_mfma_f32_16x16x32_bf16 v[76:79], a[104:107], v[140:143], v[76:79]
    ds_read_b128 v[140:143], v22 offset:58368
    s_waitcnt lgkmcnt(6)
    v_mfma_f32_16x16x32_bf16 v[80:83], a[24:27], v[144:147], v[80:83]
    v_mfma_f32_16x16x32_bf16 v[84:87], a[104:107], v[144:147], v[84:87]
    ds_read_b128 v[144:147], v22 offset:59392
    v_mfma_f32_16x16x32_bf16 v[88:91], a[24:27], v[148:151], v[88:91]
    v_mfma_f32_16x16x32_bf16 v[92:95], a[104:107], v[148:151], v[92:95]
    ds_read_b128 v[148:151], v22 offset:60416
    s_waitcnt lgkmcnt(6)
    v_mfma_f32_16x16x32_bf16 v[96:99], a[24:27], v[152:155], v[96:99]
    v_mfma_f32_16x16x32_bf16 v[100:103], a[104:107], v[152:155], v[100:103]
    ds_read_b128 v[152:155], v22 offset:61440
    v_mfma_f32_16x16x32_bf16 v[104:107], a[24:27], v[156:159], v[104:107]
    v_mfma_f32_16x16x32_bf16 v[108:111], a[104:107], v[156:159], v[108:111]
    ds_read_b128 v[156:159], v22 offset:62464
    s_waitcnt lgkmcnt(6)
    v_mfma_f32_16x16x32_bf16 v[112:115], a[24:27], v[160:163], v[112:115]
    v_mfma_f32_16x16x32_bf16 v[116:119], a[104:107], v[160:163], v[116:119]
    ds_read_b128 v[160:163], v22 offset:63488
    v_mfma_f32_16x16x32_bf16 v[120:123], a[24:27], v[164:167], v[120:123]
    v_mfma_f32_16x16x32_bf16 v[124:127], a[104:107], v[164:167], v[124:127]
    ds_read_b128 v[164:167], v22 offset:64512
    s_waitcnt vmcnt(4)
    s_barrier
    s_waitcnt lgkmcnt(6)
    v_mfma_f32_16x16x32_bf16 v[64:67], a[28:31], v[136:139], v[64:67]
    s_add_u32 s20, s79, 24576
    s_add_u32 m0, s80, 32768
    v_mfma_f32_16x16x32_bf16 v[68:71], a[108:111], v[136:139], v[68:71]
    ds_read_b128 v[136:139], v22 offset:0
    buffer_load_dwordx4 v172, s[4:7], s20 offen sc1 lds
    v_mfma_f32_16x16x32_bf16 v[72:75], a[28:31], v[140:143], v[72:75]
    s_add_u32 s21, s79, 26624
    s_add_u32 m0, s80, 40960
    v_mfma_f32_16x16x32_bf16 v[76:79], a[108:111], v[140:143], v[76:79]
    ds_read_b128 v[140:143], v22 offset:1024
    s_waitcnt lgkmcnt(6)
    v_mfma_f32_16x16x32_bf16 v[80:83], a[28:31], v[144:147], v[80:83]
    buffer_load_dwordx4 v172, s[4:7], s21 offen sc1 lds
    s_add_u32 m0, s80, 33792
    v_mfma_f32_16x16x32_bf16 v[84:87], a[108:111], v[144:147], v[84:87]
    ds_read_b128 v[144:147], v22 offset:2048
    v_mfma_f32_16x16x32_bf16 v[88:91], a[28:31], v[148:151], v[88:91]
    v_mfma_f32_16x16x32_bf16 v[92:95], a[108:111], v[148:151], v[92:95]
    ds_read_b128 v[148:151], v22 offset:3072
    buffer_load_dwordx4 v173, s[4:7], s20 offen sc1 lds
    s_waitcnt lgkmcnt(6)
    v_mfma_f32_16x16x32_bf16 v[96:99], a[28:31], v[152:155], v[96:99]
    s_add_u32 m0, s80, 41984
    v_mfma_f32_16x16x32_bf16 v[100:103], a[108:111], v[152:155], v[100:103]
    ds_read_b128 v[152:155], v22 offset:4096
    v_mfma_f32_16x16x32_bf16 v[104:107], a[28:31], v[156:159], v[104:107]
    buffer_load_dwordx4 v173, s[4:7], s21 offen sc1 lds
    v_mfma_f32_16x16x32_bf16 v[108:111], a[108:111], v[156:159], v[108:111]
    ds_read_b128 v[156:159], v22 offset:5120
    s_waitcnt lgkmcnt(6)
    v_mfma_f32_16x16x32_bf16 v[112:115], a[28:31], v[160:163], v[112:115]
    v_mfma_f32_16x16x32_bf16 v[116:119], a[108:111], v[160:163], v[116:119]
    ds_read_b128 v[160:163], v22 offset:6144
    v_mfma_f32_16x16x32_bf16 v[120:123], a[28:31], v[164:167], v[120:123]
    v_mfma_f32_16x16x32_bf16 v[124:127], a[108:111], v[164:167], v[124:127]
    ds_read_b128 v[164:167], v22 offset:7168
    s_waitcnt lgkmcnt(6)
    v_mfma_f32_16x16x32_bf16 v[64:67], a[32:35], v[136:139], v[64:67]
    buffer_load_dword v175, v178, s[4:7], s90 offen sc1
    v_mfma_f32_16x16x32_bf16 v[68:71], a[112:115], v[136:139], v[68:71]
    ds_read_b128 v[136:139], v22 offset:8192
    v_mfma_f32_16x16x32_bf16 v[72:75], a[32:35], v[140:143], v[72:75]
    v_mfma_f32_16x16x32_bf16 v[76:79], a[112:115], v[140:143], v[76:79]
    ds_read_b128 v[140:143], v22 offset:9216
    s_waitcnt lgkmcnt(6)
    v_mfma_f32_16x16x32_bf16 v[80:83], a[32:35], v[144:147], v[80:83]
    v_mfma_f32_16x16x32_bf16 v[84:87], a[112:115], v[144:147], v[84:87]
    ds_read_b128 v[144:147], v22 offset:10240
    v_mfma_f32_16x16x32_bf16 v[88:91], a[32:35], v[148:151], v[88:91]
    v_mfma_f32_16x16x32_bf16 v[92:95], a[112:115], v[148:151], v[92:95]
    ds_read_b128 v[148:151], v22 offset:11264
    s_waitcnt lgkmcnt(6)
    v_mfma_f32_16x16x32_bf16 v[96:99], a[32:35], v[152:155], v[96:99]
    v_mfma_f32_16x16x32_bf16 v[100:103], a[112:115], v[152:155], v[100:103]
    ds_read_b128 v[152:155], v22 offset:12288
    v_mfma_f32_16x16x32_bf16 v[104:107], a[32:35], v[156:159], v[104:107]
    v_mfma_f32_16x16x32_bf16 v[108:111], a[112:115], v[156:159], v[108:111]
    ds_read_b128 v[156:159], v22 offset:13312
    s_waitcnt lgkmcnt(6)
    v_mfma_f32_16x16x32_bf16 v[112:115], a[32:35], v[160:163], v[112:115]
    v_mfma_f32_16x16x32_bf16 v[116:119], a[112:115], v[160:163], v[116:119]
    ds_read_b128 v[160:163], v22 offset:14336
    v_mfma_f32_16x16x32_bf16 v[120:123], a[32:35], v[164:167], v[120:123]
    v_mfma_f32_16x16x32_bf16 v[124:127], a[112:115], v[164:167], v[124:127]
    ds_read_b128 v[164:167], v22 offset:15360
    s_waitcnt vmcnt(5)
    s_barrier
    s_waitcnt lgkmcnt(6)
    v_mfma_f32_16x16x32_bf16 v[64:67], a[36:39], v[136:139], v[64:67]
    s_add_u32 s20, s79, 28672
    s_add_u32 m0, s80, 49152
    v_mfma_f32_16x16x32_bf16 v[68:71], a[116:119], v[136:139], v[68:71]
    ds_read_b128 v[136:139], v22 offset:16384
    buffer_load_dwordx4 v172, s[4:7], s20 offen sc1 lds
    v_mfma_f32_16x16x32_bf16 v[72:75], a[36:39], v[140:143], v[72:75]
    s_add_u32 s21, s79, 30720
    s_add_u32 m0, s80, 57344
    v_mfma_f32_16x16x32_bf16 v[76:79], a[116:119], v[140:143], v[76:79]
    ds_read_b128 v[140:143], v22 offset:17408
    s_waitcnt lgkmcnt(6)
    v_mfma_f32_16x16x32_bf16 v[80:83], a[36:39], v[144:147], v[80:83]
    buffer_load_dwordx4 v172, s[4:7], s21 offen sc1 lds
    s_add_u32 m0, s80, 50176
    v_mfma_f32_16x16x32_bf16 v[84:87], a[116:119], v[144:147], v[84:87]
    ds_read_b128 v[144:147], v22 offset:18432
    v_mfma_f32_16x16x32_bf16 v[88:91], a[36:39], v[148:151], v[88:91]
    v_mfma_f32_16x16x32_bf16 v[92:95], a[116:119], v[148:151], v[92:95]
    ds_read_b128 v[148:151], v22 offset:19456
    buffer_load_dwordx4 v173, s[4:7], s20 offen sc1 lds
    s_waitcnt lgkmcnt(6)
    v_mfma_f32_16x16x32_bf16 v[96:99], a[36:39], v[152:155], v[96:99]
    s_add_u32 m0, s80, 58368
    v_mfma_f32_16x16x32_bf16 v[100:103], a[116:119], v[152:155], v[100:103]
    ds_read_b128 v[152:155], v22 offset:20480
    v_mfma_f32_16x16x32_bf16 v[104:107], a[36:39], v[156:159], v[104:107]
    buffer_load_dwordx4 v173, s[4:7], s21 offen sc1 lds
    v_mfma_f32_16x16x32_bf16 v[108:111], a[116:119], v[156:159], v[108:111]
    ds_read_b128 v[156:159], v22 offset:21504
    s_waitcnt lgkmcnt(6)
    v_mfma_f32_16x16x32_bf16 v[112:115], a[36:39], v[160:163], v[112:115]
    v_mfma_f32_16x16x32_bf16 v[116:119], a[116:119], v[160:163], v[116:119]
    ds_read_b128 v[160:163], v22 offset:22528
    v_mfma_f32_16x16x32_bf16 v[120:123], a[36:39], v[164:167], v[120:123]
    v_mfma_f32_16x16x32_bf16 v[124:127], a[116:119], v[164:167], v[124:127]
    ds_read_b128 v[164:167], v22 offset:23552
    s_waitcnt lgkmcnt(6)
    v_mfma_f32_16x16x32_bf16 v[64:67], a[40:43], v[136:139], v[64:67]
    v_mfma_f32_16x16x32_bf16 v[68:71], a[120:123], v[136:139], v[68:71]
    ds_read_b128 v[136:139], v22 offset:24576
    v_mfma_f32_16x16x32_bf16 v[72:75], a[40:43], v[140:143], v[72:75]
    v_mfma_f32_16x16x32_bf16 v[76:79], a[120:123], v[140:143], v[76:79]
    ds_read_b128 v[140:143], v22 offset:25600
    s_waitcnt lgkmcnt(6)
    v_mfma_f32_16x16x32_bf16 v[80:83], a[40:43], v[144:147], v[80:83]
    v_mfma_f32_16x16x32_bf16 v[84:87], a[120:123], v[144:147], v[84:87]
    ds_read_b128 v[144:147], v22 offset:26624
    v_mfma_f32_16x16x32_bf16 v[88:91], a[40:43], v[148:151], v[88:91]
    v_mfma_f32_16x16x32_bf16 v[92:95], a[120:123], v[148:151], v[92:95]
    ds_read_b128 v[148:151], v22 offset:27648
    s_waitcnt lgkmcnt(6)
    v_mfma_f32_16x16x32_bf16 v[96:99], a[40:43], v[152:155], v[96:99]
    v_mfma_f32_16x16x32_bf16 v[100:103], a[120:123], v[152:155], v[100:103]
    ds_read_b128 v[152:155], v22 offset:28672
    v_mfma_f32_16x16x32_bf16 v[104:107], a[40:43], v[156:159], v[104:107]
    v_mfma_f32_16x16x32_bf16 v[108:111], a[120:123], v[156:159], v[108:111]
    ds_read_b128 v[156:159], v22 offset:29696
    s_waitcnt lgkmcnt(6)
    v_mfma_f32_16x16x32_bf16 v[112:115], a[40:43], v[160:163], v[112:115]
    v_mfma_f32_16x16x32_bf16 v[116:119], a[120:123], v[160:163], v[116:119]
    ds_read_b128 v[160:163], v22 offset:30720
    v_mfma_f32_16x16x32_bf16 v[120:123], a[40:43], v[164:167], v[120:123]
    v_mfma_f32_16x16x32_bf16 v[124:127], a[120:123], v[164:167], v[124:127]
    ds_read_b128 v[164:167], v22 offset:31744
    s_waitcnt vmcnt(5)
    s_barrier
    s_waitcnt lgkmcnt(6)
    v_mfma_f32_16x16x32_bf16 v[64:67], a[44:47], v[136:139], v[64:67]
    s_add_u32 s20, s79, 32768
    s_add_u32 m0, s80, 0
    v_mfma_f32_16x16x32_bf16 v[68:71], a[124:127], v[136:139], v[68:71]
    ds_read_b128 v[136:139], v22 offset:32768
    buffer_load_dwordx4 v172, s[4:7], s20 offen sc1 lds
    v_mfma_f32_16x16x32_bf16 v[72:75], a[44:47], v[140:143], v[72:75]
    s_add_u32 s21, s79, 34816
    s_add_u32 m0, s80, 8192
    v_mfma_f32_16x16x32_bf16 v[76:79], a[124:127], v[140:143], v[76:79]
    ds_read_b128 v[140:143], v22 offset:33792
    s_waitcnt lgkmcnt(6)
    v_mfma_f32_16x16x32_bf16 v[80:83], a[44:47], v[144:147], v[80:83]
    buffer_load_dwordx4 v172, s[4:7], s21 offen sc1 lds
    s_add_u32 m0, s80, 1024
    v_mfma_f32_16x16x32_bf16 v[84:87], a[124:127], v[144:147], v[84:87]
    ds_read_b128 v[144:147], v22 offset:34816
    v_mfma_f32_16x16x32_bf16 v[88:91], a[44:47], v[148:151], v[88:91]
    v_mfma_f32_16x16x32_bf16 v[92:95], a[124:127], v[148:151], v[92:95]
    ds_read_b128 v[148:151], v22 offset:35840
    buffer_load_dwordx4 v173, s[4:7], s20 offen sc1 lds
    s_waitcnt lgkmcnt(6)
    v_mfma_f32_16x16x32_bf16 v[96:99], a[44:47], v[152:155], v[96:99]
    s_add_u32 m0, s80, 9216
    v_mfma_f32_16x16x32_bf16 v[100:103], a[124:127], v[152:155], v[100:103]
    ds_read_b128 v[152:155], v22 offset:36864
    v_mfma_f32_16x16x32_bf16 v[104:107], a[44:47], v[156:159], v[104:107]
    buffer_load_dwordx4 v173, s[4:7], s21 offen sc1 lds
    v_mfma_f32_16x16x32_bf16 v[108:111], a[124:127], v[156:159], v[108:111]
    ds_read_b128 v[156:159], v22 offset:37888
    s_waitcnt lgkmcnt(6)
    v_mfma_f32_16x16x32_bf16 v[112:115], a[44:47], v[160:163], v[112:115]
    v_mfma_f32_16x16x32_bf16 v[116:119], a[124:127], v[160:163], v[116:119]
    ds_read_b128 v[160:163], v22 offset:38912
    v_mfma_f32_16x16x32_bf16 v[120:123], a[44:47], v[164:167], v[120:123]
    v_mfma_f32_16x16x32_bf16 v[124:127], a[124:127], v[164:167], v[124:127]
    ds_read_b128 v[164:167], v22 offset:39936
    s_waitcnt vmcnt(8)
    v_subrev_u32 v24, s91, v175
    v_cmp_le_u32 vcc, 8, v24
    s_nop 1
    s_and_b64 s[84:85], vcc, s[88:89]
    s_cmp_eq_u64 s[84:85], 0
    s_cbranch_scc1 PK_19
    s_mov_b32 s83, 0
PL_20:
    s_add_u32 s83, s83, 1
    s_cmp_gt_u32 s83, 200000
    s_cbranch_scc1 L_END
    buffer_load_dword v175, v178, s[4:7], s90 offen sc1
    s_waitcnt vmcnt(0)
    v_subrev_u32 v24, s91, v175
    v_cmp_le_u32 vcc, 8, v24
    s_nop 1
    s_and_b64 s[84:85], vcc, s[88:89]
    s_cmp_eq_u64 s[84:85], 0
    s_cbranch_scc0 PL_20
PK_19:
    s_waitcnt lgkmcnt(6)
    v_mfma_f32_16x16x32_bf16 v[64:67], a[48:51], v[136:139], v[64:67]
    s_mul_i32 s20, s36, 3457024
    s_add_u32 s20, s20, s37
    v_mfma_f32_16x16x32_bf16 v[68:71], a[128:131], v[136:139], v[68:71]
    ds_read_b128 v[136:139], v22 offset:40960
    s_add_u32 s20, s20, 3235840
    v_mfma_f32_16x16x32_bf16 v[72:75], a[48:51], v[140:143], v[72:75]
    s_sub_u32 s21, s37, 6955008
    s_add_u32 s21, s21, 6930432
    v_mfma_f32_16x16x32_bf16 v[76:79], a[128:131], v[140:143], v[76:79]
    ds_read_b128 v[140:143], v22 offset:41984
    s_cmp_eq_u32 s28, 0
    s_waitcnt lgkmcnt(6)
    v_mfma_f32_16x16x32_bf16 v[80:83], a[48:51], v[144:147], v[80:83]
    s_cselect_b32 s21, 0x40000000, s21
    s_cmp_eq_u32 s31, 0
    v_mfma_f32_16x16x32_bf16 v[84:87], a[128:131], v[144:147], v[84:87]
    ds_read_b128 v[144:147], v22 offset:43008
    s_cselect_b32 s20, s21, s20
    v_mfma_f32_16x16x32_bf16 v[88:91], a[48:51], v[148:151], v[88:91]
    s_cselect_b32 s23, 1024, 0
    s_cselect_b64 vcc, -1, 0
    v_mfma_f32_16x16x32_bf16 v[92:95], a[128:131], v[148:151], v[92:95]
    ds_read_b128 v[148:151], v22 offset:44032
    v_cndmask_b32 v26, v173, v1, vcc
    s_waitcnt lgkmcnt(6)
    v_mfma_f32_16x16x32_bf16 v[96:99], a[48:51], v[152:155], v[96:99]
    s_cmp_eq_u32 s23, 0
    s_cselect_b32 s23, 2048, s23
    v_mfma_f32_16x16x32_bf16 v[100:103], a[128:131], v[152:155], v[100:103]
    ds_read_b128 v[152:155], v22 offset:45056
    s_mul_i32 s21, s30, 5
    v_mfma_f32_16x16x32_bf16 v[104:107], a[48:51], v[156:159], v[104:107]
    s_mul_i32 s21, s21, s23
    s_add_u32 s20, s20, s21
    v_mfma_f32_16x16x32_bf16 v[108:111], a[128:131], v[156:159], v[108:111]
    ds_read_b128 v[156:159], v22 offset:46080
    s_mul_i32 s21, s30, 5120
    s_waitcnt lgkmcnt(6)
    v_mfma_f32_16x16x32_bf16 v[112:115], a[48:51], v[160:163], v[112:115]
    s_add_u32 m0, s21, 0
    s_nop 0
    buffer_load_dwordx4 v26, s[4:7], s20 offen sc1 lds
    v_mfma_f32_16x16x32_bf16 v[116:119], a[128:131], v[160:163], v[116:119]
    ds_read_b128 v[160:163], v22 offset:47104
    s_add_u32 s20, s20, s23
    v_mfma_f32_16x16x32_bf16 v[120:123], a[48:51], v[164:167], v[120:123]
    s_add_u32 m0, s21, 1024
    v_mfma_f32_16x16x32_bf16 v[124:127], a[128:131], v[164:167], v[124:127]
    ds_read_b128 v[164:167], v22 offset:48128
    buffer_load_dwordx4 v26, s[4:7], s20 offen sc1 lds
    s_waitcnt vmcnt(6)
    s_barrier
    s_waitcnt lgkmcnt(6)
    v_mfma_f32_16x16x32_bf16 v[64:67], a[52:55], v[136:139], v[64:67]
    s_add_u32 s20, s20, s23
    s_add_u32 m0, s21, 2048
    v_mfma_f32_16x16x32_bf16 v[68:71], a[132:135], v[136:139], v[68:71]
    ds_read_b128 v[136:139], v22 offset:49152
    v_mfma_f32_16x16x32_bf16 v[72:75], a[52:55], v[140:143], v[72:75]
    buffer_load_dwordx4 v26, s[4:7], s20 offen sc1 lds
    s_add_u32 s20, s20, s23
    v_mfma_f32_16x16x32_bf16 v[76:79], a[132:135], v[140:143], v[76:79]
    ds_read_b128 v[140:143], v22 offset:50176
    s_add_u32 m0, s21, 3072
    s_waitcnt lgkmcnt(6)
    v_mfma_f32_16x16x32_bf16 v[80:83], a[52:55], v[144:147], v[80:83]
    v_mfma_f32_16x16x32_bf16 v[84:87], a[132:135], v[144:147], v[84:87]
    ds_read_b128 v[144:147], v22 offset:51200
    buffer_load_dwordx4 v26, s[4:7], s20 offen sc1 lds
    v_mfma_f32_16x16x32_bf16 v[88:91], a[52:55], v[148:151], v[88:91]
    s_add_u32 s20, s20, s23
    s_add_u32 m0, s21, 4096
    v_mfma_f32_16x16x32_bf16 v[92:95], a[132:135], v[148:151], v[92:95]
    ds_read_b128 v[148:151], v22 offset:52224
    s_waitcnt lgkmcnt(6)
    v_mfma_f32_16x16x32_bf16 v[96:99], a[52:55], v[152:155], v[96:99]
    buffer_load_dwordx4 v26, s[4:7], s20 offen sc1 lds
    s_add_u32 s20, s79, 36864
    v_mfma_f32_16x16x32_bf16 v[100:103], a[132:135], v[152:155], v[100:103]
    ds_read_b128 v[152:155], v22 offset:53248
    s_add_u32 m0, s80, 16384
    v_mfma_f32_16x16x32_bf16 v[104:107], a[52:55], v[156:159], v[104:107]
    v_mfma_f32_16x16x32_bf16 v[108:111], a[132:135], v[156:159], v[108:111]
    ds_read_b128 v[156:159], v22 offset:54272
    buffer_load_dwordx4 v172, s[4:7], s20 offen sc1 lds
    s_waitcnt lgkmcnt(6)
    v_mfma_f32_16x16x32_bf16 v[112:115], a[52:55], v[160:163], v[112:115]
    s_add_u32 s21, s79, 38912
    s_add_u32 m0, s80, 24576
    v_mfma_f32_16x16x32_bf16 v[116:119], a[132:135], v[160:163], v[116:119]
    ds_read_b128 v[160:163], v22 offset:55296
    v_mfma_f32_16x16x32_bf16 v[120:123], a[52:55], v[164:167], v[120:123]
    buffer_load_dwordx4 v172, s[4:7], s21 offen sc1 lds
    s_add_u32 m0, s80, 17408
    v_mfma_f32_16x16x32_bf16 v[124:127], a[132:135], v[164:167], v[124:127]
    ds_read_b128 v[164:167], v22 offset:56320
    buffer_load_dwordx4 v173, s[4:7], s20 offen sc1 lds
    s_add_u32 m0, s80, 25600
    s_nop 0
    buffer_load_dwordx4 v173, s[4:7], s21 offen sc1 lds
    s_mul_i32 s20, s30, 36
    v_add_u32 v24, s20, v0
    v_lshlrev_b32 v25, 3, v24
    s_lshl_b32 s20, s31, 10
    s_sub_u32 s20, s20, 128
    s_add_u32 s20, s20, s37
    s_mul_i32 s21, s36, 3457024
    s_add_u32 s20, s20, s21
    s_add_u32 s20, s20, 3440640
    s_sub_u32 s21, s37, 6955008
    s_add_u32 s21, s21, 6950912
    s_cmp_eq_u32 s28, 0
    s_cselect_b32 s21, 0x40000000, s21
    s_cmp_eq_u32 s31, 0
    s_cselect_b32 s22, 1, 0
    v_add_u32 v26, s20, v25
    v_add_u32 v27, s21, v25
    v_cmp_gt_u32 vcc, 16, v24
    s_cmp_eq_u32 s31, 0
    s_nop 0
    s_cselect_b64 s[84:85], vcc, 0
    v_cndmask_b32 v177, v26, v27, s[84:85]
    v_mov_b32 v27, 0x40000000
    v_cmp_le_u32 vcc, 36, v0
    s_nop 1
    v_cndmask_b32 v177, v177, v27, vcc
    v_mov_b32 v26, 2048
    v_mov_b32 v27, 128
    v_cndmask_b32 v26, v26, v27, s[84:85]
    buffer_load_dwordx2 v[180:181], v177, s[4:7], 0 offen sc1
    v_add_u32 v177, v177, v26
    buffer_load_dwordx2 v[182:183], v177, s[4:7], 0 offen sc1
    v_add_u32 v177, v177, v26
    buffer_load_dwordx2 v[184:185], v177, s[4:7], 0 offen sc1
    v_add_u32 v177, v177, v26
    buffer_load_dwordx2 v[186:187], v177, s[4:7], 0 offen sc1
    v_add_u32 v177, v177, v26
    buffer_load_dwordx2 v[188:189], v177, s[4:7], 0 offen sc1
    v_add_u32 v177, v177, v26
    buffer_load_dwordx2 v[190:191], v177, s[4:7], 0 offen sc1
    v_add_u32 v177, v177, v26
    buffer_load_dwordx2 v[192:193], v177, s[4:7], 0 offen sc1
    v_add_u32 v177, v177, v26
    buffer_load_dwordx2 v[194:195], v177, s[4:7], 0 offen sc1
    s_waitcnt lgkmcnt(6)
    v_mfma_f32_16x16x32_bf16 v[64:67], a[56:59], v[136:139], v[64:67]
    v_mfma_f32_16x16x32_bf16 v[68:71], a[136:139], v[136:139], v[68:71]
    ds_read_b128 v[136:139], v22 offset:57344
    v_mfma_f32_16x16x32_bf16 v[72:75], a[56:59], v[140:143], v[72:75]
    v_mfma_f32_16x16x32_bf16 v[76:79], a[136:139], v[140:143], v[76:79]
    ds_read_b128 v[140:143], v22 offset:58368
    s_waitcnt lgkmcnt(6)
    v_mfma_f32_16x16x32_bf16 v[80:83], a[56:59], v[144:147], v[80:83]
    v_mfma_f32_16x16x32_bf16 v[84:87], a[136:139], v[144:147], v[84:87]
    ds_read_b128 v[144:147], v22 offset:59392
    v_mfma_f32_16x16x32_bf16 v[88:91], a[56:59], v[148:151], v[88:91]
    v_mfma_f32_16x16x32_bf16 v[92:95], a[136:139], v[148:151], v[92:95]
    ds_read_b128 v[148:151], v22 offset:60416
    s_waitcnt lgkmcnt(6)
    v_mfma_f32_16x16x32_bf16 v[96:99], a[56:59], v[152:155], v[96:99]
    v_mfma_f32_16x16x32_bf16 v[100:103], a[136:139], v[152:155], v[100:103]
    ds_read_b128 v[152:155], v22 offset:61440
    v_mfma_f32_16x16x32_bf16 v[104:107], a[56:59], v[156:159], v[104:107]
    v_mfma_f32_16x16x32_bf16 v[108:111], a[136:139], v[156:159], v[108:111]
    ds_read_b128 v[156:159], v22 offset:62464
    s_waitcnt lgkmcnt(6)
    v_mfma_f32_16x16x32_bf16 v[112:115], a[56:59], v[160:163], v[112:115]
    v_mfma_f32_16x16x32_bf16 v[116:119], a[136:139], v[160:163], v[116:119]
    ds_read_b128 v[160:163], v22 offset:63488
    v_mfma_f32_16x16x32_bf16 v[120:123], a[56:59], v[164:167], v[120:123]
    v_mfma_f32_16x16x32_bf16 v[124:127], a[136:139], v[164:167], v[124:127]
    ds_read_b128 v[164:167], v22 offset:64512
    s_waitcnt vmcnt(17)
    s_barrier
    s_waitcnt lgkmcnt(6)
    v_mfma_f32_16x16x32_bf16 v[64:67], a[60:63], v[136:139], v[64:67]
    v_mfma_f32_16x16x32_bf16 v[68:71], a[140:143], v[136:139], v[68:71]
    ds_read_b128 v[136:139], v22 offset:0
    v_mfma_f32_16x16x32_bf16 v[72:75], a[60:63], v[140:143], v[72:75]
    v_mfma_f32_16x16x32_bf16 v[76:79], a[140:143], v[140:143], v[76:79]
    ds_read_b128 v[140:143], v22 offset:1024
    s_waitcnt lgkmcnt(6)
    v_mfma_f32_16x16x32_bf16 v[80:83], a[60:63], v[144:147], v[80:83]
    v_mfma_f32_16x16x32_bf16 v[84:87], a[140:143], v[144:147], v[84:87]
    ds_read_b128 v[144:147], v22 offset:2048
    v_mfma_f32_16x16x32_bf16 v[88:91], a[60:63], v[148:151], v[88:91]
    v_mfma_f32_16x16x32_bf16 v[92:95], a[140:143], v[148:151], v[92:95]
    ds_read_b128 v[148:151], v22 offset:3072
    s_waitcnt lgkmcnt(6)
    v_mfma_f32_16x16x32_bf16 v[96:99], a[60:63], v[152:155], v[96:99]
    v_mfma_f32_16x16x32_bf16 v[100:103], a[140:143], v[152:155], v[100:103]
    ds_read_b128 v[152:155], v22 offset:4096
    v_mfma_f32_16x16x32_bf16 v[104:107], a[60:63], v[156:159], v[104:107]
    v_mfma_f32_16x16x32_bf16 v[108:111], a[140:143], v[156:159], v[108:111]
    ds_read_b128 v[156:159], v22 offset:5120
    s_waitcnt lgkmcnt(6)
    v_mfma_f32_16x16x32_bf16 v[112:115], a[60:63], v[160:163], v[112:115]
    v_mfma_f32_16x16x32_bf16 v[116:119], a[140:143], v[160:163], v[116:119]
    ds_read_b128 v[160:163], v22 offset:6144
    v_mfma_f32_16x16x32_bf16 v[120:123], a[60:63], v[164:167], v[120:123]
    v_mfma_f32_16x16x32_bf16 v[124:127], a[140:143], v[164:167], v[124:127]
    ds_read_b128 v[164:167], v22 offset:7168
    s_waitcnt lgkmcnt(6)
    v_mfma_f32_16x16x32_bf16 v[64:67], a[64:67], v[136:139], v[64:67]
    s_lshl_b32 s25, s30, 10
    s_add_u32 s25, s25, 156672
    v_mfma_f32_16x16x32_bf16 v[68:71], a[144:147], v[136:139], v[68:71]
    ds_read_b128 v[136:139], v22 offset:8192
    v_add_u32 v220, s25, v1
    v_mfma_f32_16x16x32_bf16 v[72:75], a[64:67], v[140:143], v[72:75]
    ds_read_b128 v[216:219], v220
    s_add_u32 s75, s61, 20480
    v_mfma_f32_16x16x32_bf16 v[76:79], a[144:147], v[140:143], v[76:79]
    ds_read_b128 v[140:143], v22 offset:9216
    s_add_u32 m0, s60, 20480
    s_waitcnt lgkmcnt(6)
    v_mfma_f32_16x16x32_bf16 v[80:83], a[64:67], v[144:147], v[80:83]
    buffer_load_dwordx4 v1, s[4:7], s75 offen offset:0 lds
    v_mfma_f32_16x16x32_bf16 v[84:87], a[144:147], v[144:147], v[84:87]
    ds_read_b128 v[144:147], v22 offset:10240
    v_mfma_f32_16x16x32_bf16 v[88:91], a[64:67], v[148:151], v[88:91]
    v_mfma_f32_16x16x32_bf16 v[92:95], a[144:147], v[148:151], v[92:95]
    ds_read_b128 v[148:151], v22 offset:11264
    buffer_load_dwordx4 v1, s[4:7], s75 offen offset:1024 lds
    s_waitcnt lgkmcnt(6)
    v_mfma_f32_16x16x32_bf16 v[96:99], a[64:67], v[152:155], v[96:99]
    v_mfma_f32_16x16x32_bf16 v[100:103], a[144:147], v[152:155], v[100:103]
    ds_read_b128 v[152:155], v22 offset:12288
    v_mfma_f32_16x16x32_bf16 v[104:107], a[64:67], v[156:159], v[104:107]
    buffer_load_dwordx4 v1, s[4:7], s75 offen offset:2048 lds
    v_mfma_f32_16x16x32_bf16 v[108:111], a[144:147], v[156:159], v[108:111]
    ds_read_b128 v[156:159], v22 offset:13312
    s_waitcnt lgkmcnt(6)
    v_mfma_f32_16x16x32_bf16 v[112:115], a[64:67], v[160:163], v[112:115]
    v_mfma_f32_16x16x32_bf16 v[116:119], a[144:147], v[160:163], v[116:119]
    ds_read_b128 v[160:163], v22 offset:14336
    buffer_load_dwordx4 v1, s[4:7], s75 offen offset:3072 lds
    v_mfma_f32_16x16x32_bf16 v[120:123], a[64:67], v[164:167], v[120:123]
    s_add_u32 m0, s60, 24576
    s_add_u32 s75, s75, 4096
    v_mfma_f32_16x16x32_bf16 v[124:127], a[144:147], v[164:167], v[124:127]
    ds_read_b128 v[164:167], v22 offset:15360
    s_waitcnt vmcnt(12)
    s_barrier
    s_waitcnt vmcnt(4)
    s_waitcnt lgkmcnt(6)
    v_mfma_f32_16x16x32_bf16 v[64:67], a[68:71], v[136:139], v[64:67]
    buffer_load_dwordx4 v1, s[4:7], s75 offen lds
    s_add_u32 s75, s61, 40960
    v_mfma_f32_16x16x32_bf16 v[68:71], a[148:151], v[136:139], v[68:71]
    ds_read_b128 v[136:139], v22 offset:16384
    s_add_u32 m0, s60, 40960
    v_mfma_f32_16x16x32_bf16 v[72:75], a[68:71], v[140:143], v[72:75]
    v_mfma_f32_16x16x32_bf16 v[76:79], a[148:151], v[140:143], v[76:79]
    ds_read_b128 v[140:143], v22 offset:17408
    buffer_load_dwordx4 v1, s[4:7], s75 offen offset:0 lds
    s_waitcnt lgkmcnt(6)
    v_mfma_f32_16x16x32_bf16 v[80:83], a[68:71], v[144:147], v[80:83]
    v_mfma_f32_16x16x32_bf16 v[84:87], a[148:151], v[144:147], v[84:87]
    ds_read_b128 v[144:147], v22 offset:18432
    v_mfma_f32_16x16x32_bf16 v[88:91], a[68:71], v[148:151], v[88:91]
    buffer_load_dwordx4 v1, s[4:7], s75 offen offset:1024 lds
    v_mfma_f32_16x16x32_bf16 v[92:95], a[148:151], v[148:151], v[92:95]
    ds_read_b128 v[148:151], v22 offset:19456
    s_waitcnt lgkmcnt(6)
    v_mfma_f32_16x16x32_bf16 v[96:99], a[68:71], v[152:155], v[96:99]
    v_mfma_f32_16x16x32_bf16 v[100:103], a[148:151], v[152:155], v[100:103]
    ds_read_b128 v[152:155], v22 offset:20480
    buffer_load_dwordx4 v1, s[4:7], s75 offen offset:2048 lds
    v_mfma_f32_16x16x32_bf16 v[104:107], a[68:71], v[156:159], v[104:107]
    v_mfma_f32_16x16x32_bf16 v[108:111], a[148:151], v[156:159], v[108:111]
    ds_read_b128 v[156:159], v22 offset:21504
    s_waitcnt lgkmcnt(6)
    v_mfma_f32_16x16x32_bf16 v[112:115], a[68:71], v[160:163], v[112:115]
    buffer_load_dwordx4 v1, s[4:7], s75 offen offset:3072 lds
    s_add_u32 m0, s60, 45056
    v_mfma_f32_16x16x32_bf16 v[116:119], a[148:151], v[160:163], v[116:119]
    ds_read_b128 v[160:163], v22 offset:22528
    s_add_u32 s75, s75, 4096
    v_mfma_f32_16x16x32_bf16 v[120:123], a[68:71], v[164:167], v[120:123]
    v_mfma_f32_16x16x32_bf16 v[124:127], a[148:151], v[164:167], v[124:127]
    ds_read_b128 v[164:167], v22 offset:23552
    buffer_load_dwordx4 v1, s[4:7], s75 offen lds
    s_waitcnt lgkmcnt(6)
    v_mfma_f32_16x16x32_bf16 v[64:67], a[72:75], v[136:139], v[64:67]
    v_add_f32 v180, v180, v182
    v_add_f32 v181, v181, v183
    v_mfma_f32_16x16x32_bf16 v[68:71], a[152:155], v[136:139], v[68:71]
    ds_read_b128 v[136:139], v22 offset:24576
    v_add_f32 v180, v180, v184
    v_mfma_f32_16x16x32_bf16 v[72:75], a[72:75], v[140:143], v[72:75]
    v_add_f32 v181, v181, v185
    v_add_f32 v180, v180, v186
    v_mfma_f32_16x16x32_bf16 v[76:79], a[152:155], v[140:143], v[76:79]
    ds_read_b128 v[140:143], v22 offset:25600
    v_add_f32 v181, v181, v187
    s_waitcnt lgkmcnt(6)
    v_mfma_f32_16x16x32_bf16 v[80:83], a[72:75], v[144:147], v[80:83]
    v_add_f32 v188, v188, v190
    v_add_f32 v189, v189, v191
    v_mfma_f32_16x16x32_bf16 v[84:87], a[152:155], v[144:147], v[84:87]
    ds_read_b128 v[144:147], v22 offset:26624
    v_add_f32 v188, v188, v192
    v_mfma_f32_16x16x32_bf16 v[88:91], a[72:75], v[148:151], v[88:91]
    v_add_f32 v189, v189, v193
    v_add_f32 v188, v188, v194
    v_mfma_f32_16x16x32_bf16 v[92:95], a[152:155], v[148:151], v[92:95]
    ds_read_b128 v[148:151], v22 offset:27648
    v_add_f32 v189, v189, v195
    s_waitcnt lgkmcnt(6)
    v_mfma_f32_16x16x32_bf16 v[96:99], a[72:75], v[152:155], v[96:99]
    v_add_f32 v180, v180, v188
    v_add_f32 v181, v181, v189
    v_mfma_f32_16x16x32_bf16 v[100:103], a[152:155], v[152:155], v[100:103]
    ds_read_b128 v[152:155], v22 offset:28672
    v_mul_f32 v180, 0x3acccccd, v180
    v_mfma_f32_16x16x32_bf16 v[104:107], a[72:75], v[156:159], v[104:107]
    v_mul_f32 v181, 0x3acccccd, v181
    v_fma_f32 v181, -v180, v180, v181
    v_mfma_f32_16x16x32_bf16 v[108:111], a[152:155], v[156:159], v[108:111]
    ds_read_b128 v[156:159], v22 offset:29696
    v_max_f32 v181, 0, v181
    s_waitcnt lgkmcnt(6)
    v_mfma_f32_16x16x32_bf16 v[112:115], a[72:75], v[160:163], v[112:115]
    v_cvt_pk_bf16_f32 v182, v180, v181
    v_lshlrev_b32 v180, 16, v182
    v_mfma_f32_16x16x32_bf16 v[116:119], a[152:155], v[160:163], v[116:119]
    ds_read_b128 v[160:163], v22 offset:30720
    v_and_b32 v181, 0xffff0000, v182
    v_mfma_f32_16x16x32_bf16 v[120:123], a[72:75], v[164:167], v[120:123]
    v_add_f32 v181, 0x3727c5ac, v181
    v_cvt_pk_bf16_f32 v182, v181, v181
    v_mfma_f32_16x16x32_bf16 v[124:127], a[152:155], v[164:167], v[124:127]
    ds_read_b128 v[164:167], v22 offset:31744
    v_and_b32 v181, 0xffff0000, v182
    s_waitcnt lgkmcnt(6)
    v_mfma_f32_16x16x32_bf16 v[64:67], a[76:79], v[136:139], v[64:67]
    v_sqrt_f32 v181, v181
    s_nop 0
    v_cvt_pk_bf16_f32 v182, v181, v181
    v_mfma_f32_16x16x32_bf16 v[68:71], a[156:159], v[136:139], v[68:71]
    v_and_b32 v181, 0xffff0000, v182
    v_mfma_f32_16x16x32_bf16 v[72:75], a[76:79], v[140:143], v[72:75]
    v_rcp_f32 v181, v181
    v_xor_b32 v180, 0x80000000, v180
    v_mfma_f32_16x16x32_bf16 v[76:79], a[156:159], v[140:143], v[76:79]
    s_mul_i32 s23, s30, 288
    s_waitcnt lgkmcnt(4)
    v_mfma_f32_16x16x32_bf16 v[80:83], a[76:79], v[144:147], v[80:83]
    s_add_u32 s23, s23, 151552
    v_lshlrev_b32 v183, 3, v0
    v_mfma_f32_16x16x32_bf16 v[84:87], a[156:159], v[144:147], v[84:87]
    v_add_u32 v183, s23, v183
    v_mfma_f32_16x16x32_bf16 v[88:91], a[76:79], v[148:151], v[88:91]
    s_mov_b32 exec_lo, 0xffffffff
    s_mov_b32 exec_hi, 0xf
    ds_write_b64 v183, v[180:181]
    s_mov_b64 exec, -1
    s_waitcnt lgkmcnt(0)
    v_mfma_f32_16x16x32_bf16 v[92:95], a[156:159], v[148:151], v[92:95]
    buffer_load_dword v255, v216, s[4:7], s37 offen
    s_waitcnt lgkmcnt(2)
    v_mfma_f32_16x16x32_bf16 v[96:99], a[76:79], v[152:155], v[96:99]
    v_mfma_f32_16x16x32_bf16 v[100:103], a[156:159], v[152:155], v[100:103]
    v_mfma_f32_16x16x32_bf16 v[104:107], a[76:79], v[156:159], v[104:107]
    buffer_load_dword v255, v217, s[4:7], s37 offen
    v_mfma_f32_16x16x32_bf16 v[108:111], a[156:159], v[156:159], v[108:111]
    s_waitcnt lgkmcnt(0)
    v_mfma_f32_16x16x32_bf16 v[112:115], a[76:79], v[160:163], v[112:115]
    v_mfma_f32_16x16x32_bf16 v[116:119], a[156:159], v[160:163], v[116:119]
    buffer_load_dword v255, v218, s[4:7], s37 offen
    v_mfma_f32_16x16x32_bf16 v[120:123], a[76:79], v[164:167], v[120:123]
    v_lshlrev_b32 v219, 3, v0
    v_mfma_f32_16x16x32_bf16 v[124:127], a[156:159], v[164:167], v[124:127]
    buffer_load_dword v255, v219, s[4:7], s65 offen offset:0
L_COMMON:
    s_waitcnt lgkmcnt(0)
    s_barrier
    ds_read_b128 v[136:139], v1 offset:0
    ds_read_b128 v[140:143], v1 offset:1024
    ds_read_b128 v[144:147], v1 offset:2048
    ds_read_b128 v[148:151], v1 offset:3072
    ds_read_b128 v[152:155], v1 offset:4096
    ds_read_b128 v[156:159], v1 offset:5120
    s_waitcnt lgkmcnt(5)
    v_mfma_f32_16x16x32_bf16 v[128:131], a[0:3], v[136:139], 0
    v_and_b32 v30, 15, v0
    v_mfma_f32_16x16x32_bf16 v[132:135], a[80:83], v[136:139], 0
    ds_read_b128 v[160:163], v1 offset:6144
    s_waitcnt lgkmcnt(5)
    v_mfma_f32_16x16x32_bf16 v[128:131], a[4:7], v[140:143], v[128:131]
    v_lshlrev_b32 v30, 3, v30
    v_mfma_f32_16x16x32_bf16 v[132:135], a[84:87], v[140:143], v[132:135]
    ds_read_b128 v[164:167], v1 offset:7168
    s_waitcnt lgkmcnt(5)
    v_mfma_f32_16x16x32_bf16 v[128:131], a[8:11], v[144:147], v[128:131]
    v_add_u32 v30, 151552, v30
    v_mfma_f32_16x16x32_bf16 v[132:135], a[88:91], v[144:147], v[132:135]
    ds_read_b128 v[136:139], v1 offset:8192
    s_waitcnt lgkmcnt(5)
    v_mfma_f32_16x16x32_bf16 v[128:131], a[12:15], v[148:151], v[128:131]
    ds_read_b64 v[40:41], v30 offset:128
    v_mfma_f32_16x16x32_bf16 v[132:135], a[92:95], v[148:151], v[132:135]
    ds_read_b128 v[140:143], v1 offset:9216
    s_waitcnt lgkmcnt(5)
    v_mfma_f32_16x16x32_bf16 v[128:131], a[16:19], v[152:155], v[128:131]
    ds_read_b64 v[42:43], v30 offset:256
    v_mfma_f32_16x16x32_bf16 v[132:135], a[96:99], v[152:155], v[132:135]
    ds_read_b128 v[144:147], v1 offset:10240
    s_waitcnt lgkmcnt(5)
    v_mfma_f32_16x16x32_bf16 v[128:131], a[20:23], v[156:159], v[128:131]
    ds_read_b64 v[44:45], v30 offset:384
    v_mfma_f32_16x16x32_bf16 v[132:135], a[100:103], v[156:159], v[132:135]
    ds_read_b128 v[148:151], v1 offset:11264
    s_waitcnt lgkmcnt(5)
    v_mfma_f32_16x16x32_bf16 v[128:131], a[24:27], v[160:163], v[128:131]
    ds_read_b64 v[46:47], v30 offset:512
    v_mfma_f32_16x16x32_bf16 v[132:135], a[104:107], v[160:163], v[132:135]
    ds_read_b128 v[152:155], v1 offset:12288
    s_waitcnt lgkmcnt(5)
    v_mfma_f32_16x16x32_bf16 v[128:131], a[28:31], v[164:167], v[128:131]
    ds_read_b64 v[48:49], v30 offset:640
    v_mfma_f32_16x16x32_bf16 v[132:135], a[108:111], v[164:167], v[132:135]
    ds_read_b128 v[156:159], v1 offset:13312
    s_waitcnt lgkmcnt(5)
    v_mfma_f32_16x16x32_bf16 v[128:131], a[32:35], v[136:139], v[128:131]
    ds_read_b64 v[50:51], v30 offset:768
    v_mfma_f32_16x16x32_bf16 v[132:135], a[112:115], v[136:139], v[132:135]
    ds_read_b128 v[160:163], v1 offset:14336
    s_waitcnt lgkmcnt(5)
    v_mfma_f32_16x16x32_bf16 v[128:131], a[36:39], v[140:143], v[128:131]
    ds_read_b64 v[52:53], v30 offset:896
    v_mfma_f32_16x16x32_bf16 v[132:135], a[116:119], v[140:143], v[132:135]
    ds_read_b128 v[164:167], v1 offset:15360
    s_waitcnt lgkmcnt(5)
    v_mfma_f32_16x16x32_bf16 v[128:131], a[40:43], v[144:147], v[128:131]
    ds_read_b64 v[54:55], v30 offset:1024
    v_mfma_f32_16x16x32_bf16 v[132:135], a[120:123], v[144:147], v[132:135]
    ds_read_b128 v[136:139], v1 offset:16384
    s_waitcnt lgkmcnt(5)
    v_mfma_f32_16x16x32_bf16 v[128:131], a[44:47], v[148:151], v[128:131]
    ds_read_b64 v[56:57], v30 offset:0
    v_mfma_f32_16x16x32_bf16 v[132:135], a[124:127], v[148:151], v[132:135]
    ds_read_b128 v[140:143], v1 offset:17408
    s_waitcnt lgkmcnt(5)
    v_mfma_f32_16x16x32_bf16 v[128:131], a[48:51], v[152:155], v[128:131]
    s_mul_i32 s20, s30, 10656
    v_mfma_f32_16x16x32_bf16 v[132:135], a[128:131], v[152:155], v[132:135]
    ds_read_b128 v[144:147], v1 offset:18432
    s_waitcnt lgkmcnt(5)
    v_mfma_f32_16x16x32_bf16 v[128:131], a[52:55], v[156:159], v[128:131]
    s_add_u32 s20, s20, 65536
    v_mfma_f32_16x16x32_bf16 v[132:135], a[132:135], v[156:159], v[132:135]
    ds_read_b128 v[148:151], v1 offset:19456
    s_waitcnt lgkmcnt(5)
    v_mfma_f32_16x16x32_bf16 v[128:131], a[56:59], v[160:163], v[128:131]
    v_mul_u32_u24 v24, 296, v0
    v_mfma_f32_16x16x32_bf16 v[132:135], a[136:139], v[160:163], v[132:135]
    s_waitcnt lgkmcnt(4)
    v_mfma_f32_16x16x32_bf16 v[128:131], a[60:63], v[164:167], v[128:131]
    v_add_u32 v24, s20, v24
    v_mfma_f32_16x16x32_bf16 v[132:135], a[140:143], v[164:167], v[132:135]
    s_waitcnt lgkmcnt(3)
    v_mfma_f32_16x16x32_bf16 v[128:131], a[64:67], v[136:139], v[128:131]
    v_mov_b32 v26, 0
    v_mfma_f32_16x16x32_bf16 v[132:135], a[144:147], v[136:139], v[132:135]
    s_waitcnt lgkmcnt(2)
    v_mfma_f32_16x16x32_bf16 v[128:131], a[68:71], v[140:143], v[128:131]
    v_mov_b32 v27, 0
    v_mfma_f32_16x16x32_bf16 v[132:135], a[148:151], v[140:143], v[132:135]
    s_waitcnt lgkmcnt(1)
    v_mfma_f32_16x16x32_bf16 v[128:131], a[72:75], v[144:147], v[128:131]
    s_mov_b32 exec_lo, 0xffffffff
    s_mov_b32 exec_hi, 0xf
    ds_write_b64 v24, v[26:27] offset:152
    ds_write_b64 v24, v[26:27] offset:200
    ds_write_b64 v24, v[26:27] offset:96
    ds_write_b64 v24, v[26:27] offset:104
    s_mov_b64 exec, -1
    v_mfma_f32_16x16x32_bf16 v[132:135], a[152:155], v[144:147], v[132:135]
    s_waitcnt lgkmcnt(0)
    v_mfma_f32_16x16x32_bf16 v[128:131], a[76:79], v[148:151], v[128:131]
    v_add_u32 v62, 153600, v1
    v_mfma_f32_16x16x32_bf16 v[132:135], a[156:159], v[148:151], v[132:135]
    s_waitcnt lgkmcnt(0)
    v_pk_fma_f32 v[64:65], v[12:13], v[40:41], v[64:65] op_sel_hi:[1,0,1]
    v_pk_fma_f32 v[66:67], v[14:15], v[40:41], v[66:67] op_sel_hi:[1,0,1]
    v_pk_fma_f32 v[68:69], v[16:17], v[40:41], v[68:69] op_sel_hi:[1,0,1]
    v_pk_fma_f32 v[70:71], v[18:19], v[40:41], v[70:71] op_sel_hi:[1,0,1]
    v_pk_fma_f32 v[72:73], v[12:13], v[42:43], v[72:73] op_sel_hi:[1,0,1]
    v_pk_fma_f32 v[74:75], v[14:15], v[42:43], v[74:75] op_sel_hi:[1,0,1]
    v_pk_fma_f32 v[76:77], v[16:17], v[42:43], v[76:77] op_sel_hi:[1,0,1]
    v_pk_fma_f32 v[78:79], v[18:19], v[42:43], v[78:79] op_sel_hi:[1,0,1]
    v_pk_fma_f32 v[80:81], v[12:13], v[44:45], v[80:81] op_sel_hi:[1,0,1]
    v_pk_fma_f32 v[82:83], v[14:15], v[44:45], v[82:83] op_sel_hi:[1,0,1]
    v_pk_fma_f32 v[84:85], v[16:17], v[44:45], v[84:85] op_sel_hi:[1,0,1]
    v_pk_fma_f32 v[86:87], v[18:19], v[44:45], v[86:87] op_sel_hi:[1,0,1]
    v_pk_mul_f32 v[64:65], v[64:65], v[40:41] op_sel:[0,1] op_sel_hi:[1,1]
    v_pk_mul_f32 v[66:67], v[66:67], v[40:41] op_sel:[0,1] op_sel_hi:[1,1]
    v_pk_mul_f32 v[68:69], v[68:69], v[40:41] op_sel:[0,1] op_sel_hi:[1,1]
    v_pk_mul_f32 v[70:71], v[70:71], v[40:41] op_sel:[0,1] op_sel_hi:[1,1]
    v_pk_mul_f32 v[72:73], v[72:73], v[42:43] op_sel:[0,1] op_sel_hi:[1,1]
    v_pk_mul_f32 v[74:75], v[74:75], v[42:43] op_sel:[0,1] op_sel_hi:[1,1]
    v_pk_mul_f32 v[76:77], v[76:77], v[42:43] op_sel:[0,1] op_sel_hi:[1,1]
    v_pk_mul_f32 v[78:79], v[78:79], v[42:43] op_sel:[0,1] op_sel_hi:[1,1]
    v_pk_mul_f32 v[80:81], v[80:81], v[44:45] op_sel:[0,1] op_sel_hi:[1,1]
    v_pk_mul_f32 v[82:83], v[82:83], v[44:45] op_sel:[0,1] op_sel_hi:[1,1]
    v_pk_mul_f32 v[84:85], v[84:85], v[44:45] op_sel:[0,1] op_sel_hi:[1,1]
    v_pk_mul_f32 v[86:87], v[86:87], v[44:45] op_sel:[0,1] op_sel_hi:[1,1]
    v_cvt_pk_bf16_f32 v224, v64, v65
    v_cvt_pk_bf16_f32 v225, v66, v67
    v_cvt_pk_bf16_f32 v226, v68, v69
    v_cvt_pk_bf16_f32 v227, v70, v71
    v_cvt_pk_bf16_f32 v228, v72, v73
    v_cvt_pk_bf16_f32 v229, v74, v75
    v_cvt_pk_bf16_f32 v230, v76, v77
    v_cvt_pk_bf16_f32 v231, v78, v79
    v_cvt_pk_bf16_f32 v232, v80, v81
    v_cvt_pk_bf16_f32 v233, v82, v83
    v_cvt_pk_bf16_f32 v234, v84, v85
    v_cvt_pk_bf16_f32 v235, v86, v87
    ds_write_b64 v20, v[224:225] offset:4736
    ds_write_b64 v21, v[226:227] offset:4736
    ds_write_b64 v20, v[228:229] offset:9472
    ds_write_b64 v21, v[230:231] offset:9472
    ds_write_b64 v20, v[232:233] offset:14208
    ds_write_b64 v21, v[234:235] offset:14208
    v_pk_fma_f32 v[88:89], v[12:13], v[46:47], v[88:89] op_sel_hi:[1,0,1]
    v_pk_fma_f32 v[90:91], v[14:15], v[46:47], v[90:91] op_sel_hi:[1,0,1]
    v_pk_fma_f32 v[92:93], v[16:17], v[46:47], v[92:93] op_sel_hi:[1,0,1]
    v_pk_fma_f32 v[94:95], v[18:19], v[46:47], v[94:95] op_sel_hi:[1,0,1]
    v_pk_fma_f32 v[96:97], v[12:13], v[48:49], v[96:97] op_sel_hi:[1,0,1]
    v_pk_fma_f32 v[98:99], v[14:15], v[48:49], v[98:99] op_sel_hi:[1,0,1]
    v_pk_fma_f32 v[100:101], v[16:17], v[48:49], v[100:101] op_sel_hi:[1,0,1]
    v_pk_fma_f32 v[102:103], v[18:19], v[48:49], v[102:103] op_sel_hi:[1,0,1]
    v_pk_fma_f32 v[104:105], v[12:13], v[50:51], v[104:105] op_sel_hi:[1,0,1]
    v_pk_fma_f32 v[106:107], v[14:15], v[50:51], v[106:107] op_sel_hi:[1,0,1]
    v_pk_fma_f32 v[108:109], v[16:17], v[50:51], v[108:109] op_sel_hi:[1,0,1]
    v_pk_fma_f32 v[110:111], v[18:19], v[50:51], v[110:111] op_sel_hi:[1,0,1]
    v_pk_mul_f32 v[88:89], v[88:89], v[46:47] op_sel:[0,1] op_sel_hi:[1,1]
    v_pk_mul_f32 v[90:91], v[90:91], v[46:47] op_sel:[0,1] op_sel_hi:[1,1]
    v_pk_mul_f32 v[92:93], v[92:93], v[46:47] op_sel:[0,1] op_sel_hi:[1,1]
    v_pk_mul_f32 v[94:95], v[94:95], v[46:47] op_sel:[0,1] op_sel_hi:[1,1]
    v_pk_mul_f32 v[96:97], v[96:97], v[48:49] op_sel:[0,1] op_sel_hi:[1,1]
    v_pk_mul_f32 v[98:99], v[98:99], v[48:49] op_sel:[0,1] op_sel_hi:[1,1]
    v_pk_mul_f32 v[100:101], v[100:101], v[48:49] op_sel:[0,1] op_sel_hi:[1,1]
    v_pk_mul_f32 v[102:103], v[102:103], v[48:49] op_sel:[0,1] op_sel_hi:[1,1]
    v_pk_mul_f32 v[104:105], v[104:105], v[50:51] op_sel:[0,1] op_sel_hi:[1,1]
    v_pk_mul_f32 v[106:107], v[106:107], v[50:51] op_sel:[0,1] op_sel_hi:[1,1]
    v_pk_mul_f32 v[108:109], v[108:109], v[50:51] op_sel:[0,1] op_sel_hi:[1,1]
    v_pk_mul_f32 v[110:111], v[110:111], v[50:51] op_sel:[0,1] op_sel_hi:[1,1]
    v_cvt_pk_bf16_f32 v224, v88, v89
    v_cvt_pk_bf16_f32 v225, v90, v91
    v_cvt_pk_bf16_f32 v226, v92, v93
    v_cvt_pk_bf16_f32 v227, v94, v95
    v_cvt_pk_bf16_f32 v228, v96, v97
    v_cvt_pk_bf16_f32 v229, v98, v99
    v_cvt_pk_bf16_f32 v230, v100, v101
    v_cvt_pk_bf16_f32 v231, v102, v103
    v_cvt_pk_bf16_f32 v232, v104, v105
    v_cvt_pk_bf16_f32 v233, v106, v107
    v_cvt_pk_bf16_f32 v234, v108, v109
    v_cvt_pk_bf16_f32 v235, v110, v111
    ds_write_b64 v20, v[224:225] offset:18944
    ds_write_b64 v21, v[226:227] offset:18944
    ds_write_b64 v20, v[228:229] offset:23680
    ds_write_b64 v21, v[230:231] offset:23680
    ds_write_b64 v20, v[232:233] offset:28416
    ds_write_b64 v21, v[234:235] offset:28416
    v_pk_fma_f32 v[112:113], v[12:13], v[52:53], v[112:113] op_sel_hi:[1,0,1]
    v_pk_fma_f32 v[114:115], v[14:15], v[52:53], v[114:115] op_sel_hi:[1,0,1]
    v_pk_fma_f32 v[116:117], v[16:17], v[52:53], v[116:117] op_sel_hi:[1,0,1]
    v_pk_fma_f32 v[118:119], v[18:19], v[52:53], v[118:119] op_sel_hi:[1,0,1]
    v_pk_fma_f32 v[120:121], v[12:13], v[54:55], v[120:121] op_sel_hi:[1,0,1]
    v_pk_fma_f32 v[122:123], v[14:15], v[54:55], v[122:123] op_sel_hi:[1,0,1]
    v_pk_fma_f32 v[124:125], v[16:17], v[54:55], v[124:125] op_sel_hi:[1,0,1]
    v_pk_fma_f32 v[126:127], v[18:19], v[54:55], v[126:127] op_sel_hi:[1,0,1]
    v_pk_fma_f32 v[128:129], v[12:13], v[56:57], v[128:129] op_sel_hi:[1,0,1]
    v_pk_fma_f32 v[130:131], v[14:15], v[56:57], v[130:131] op_sel_hi:[1,0,1]
    v_pk_fma_f32 v[132:133], v[16:17], v[56:57], v[132:133] op_sel_hi:[1,0,1]
    v_pk_fma_f32 v[134:135], v[18:19], v[56:57], v[134:135] op_sel_hi:[1,0,1]
    v_pk_mul_f32 v[112:113], v[112:113], v[52:53] op_sel:[0,1] op_sel_hi:[1,1]
    v_pk_mul_f32 v[114:115], v[114:115], v[52:53] op_sel:[0,1] op_sel_hi:[1,1]
    v_pk_mul_f32 v[116:117], v[116:117], v[52:53] op_sel:[0,1] op_sel_hi:[1,1]
    v_pk_mul_f32 v[118:119], v[118:119], v[52:53] op_sel:[0,1] op_sel_hi:[1,1]
    v_pk_mul_f32 v[120:121], v[120:121], v[54:55] op_sel:[0,1] op_sel_hi:[1,1]
    v_pk_mul_f32 v[122:123], v[122:123], v[54:55] op_sel:[0,1] op_sel_hi:[1,1]
    v_pk_mul_f32 v[124:125], v[124:125], v[54:55] op_sel:[0,1] op_sel_hi:[1,1]
    v_pk_mul_f32 v[126:127], v[126:127], v[54:55] op_sel:[0,1] op_sel_hi:[1,1]
    v_pk_mul_f32 v[128:129], v[128:129], v[56:57] op_sel:[0,1] op_sel_hi:[1,1]
    v_pk_mul_f32 v[130:131], v[130:131], v[56:57] op_sel:[0,1] op_sel_hi:[1,1]
    v_pk_mul_f32 v[132:133], v[132:133], v[56:57] op_sel:[0,1] op_sel_hi:[1,1]
    v_pk_mul_f32 v[134:135], v[134:135], v[56:57] op_sel:[0,1] op_sel_hi:[1,1]
    v_cvt_pk_bf16_f32 v224, v112, v113
    v_cvt_pk_bf16_f32 v225, v114, v115
    v_cvt_pk_bf16_f32 v226, v116, v117
    v_cvt_pk_bf16_f32 v227, v118, v119
    v_cvt_pk_bf16_f32 v228, v120, v121
    v_cvt_pk_bf16_f32 v229, v122, v123
    v_cvt_pk_bf16_f32 v230, v124, v125
    v_cvt_pk_bf16_f32 v231, v126, v127
    v_cvt_pk_bf16_f32 v232, v128, v129
    v_cvt_pk_bf16_f32 v233, v130, v131
    v_cvt_pk_bf16_f32 v234, v132, v133
    v_cvt_pk_bf16_f32 v235, v134, v135
    ds_write_b64 v20, v[224:225] offset:33152
    ds_write_b64 v21, v[226:227] offset:33152
    ds_write_b64 v20, v[228:229] offset:37888
    ds_write_b64 v21, v[230:231] offset:37888
    ds_write_b64 v20, v[232:233] offset:0
    ds_write_b64 v21, v[234:235] offset:0
    v_add_u32 v62, 153600, v1
    ds_read_b128 v[24:27], v62
    ds_read_b128 v[28:31], v62 offset:1024
    ds_read_b128 v[32:35], v62 offset:2048
    s_waitcnt lgkmcnt(0)
    s_barrier
    s_mul_i32 s20, s30, 9472
    v_add_u32 v24, s20, v24
    v_add_u32 v25, s20, v25
    v_add_u32 v26, s20, v26
    v_add_u32 v27, s20, v27
    ds_read_b64 v[64:65], v24 offset:4736
    ds_read_b64 v[66:67], v24 offset:4744
    ds_read_b64 v[68:69], v26 offset:112
    ds_read_b64 v[70:71], v26 offset:120
    ds_read_b64 v[72:73], v26 offset:4848
    ds_read_b64 v[74:75], v26 offset:4856
    ds_read_b64 v[112:113], v25 offset:4736
    ds_read_b64 v[114:115], v25 offset:4744
    ds_read_b64 v[116:117], v26 offset:160
    ds_read_b64 v[118:119], v26 offset:168
    ds_read_b64 v[120:121], v26 offset:4896
    ds_read_b64 v[122:123], v26 offset:4904
    ds_read_b64 v[160:161], v24 offset:9472
    ds_read_b64 v[162:163], v24 offset:9480
    ds_read_b64 v[164:165], v26 offset:4848
    ds_read_b64 v[166:167], v26 offset:4856
    ds_read_b64 v[168:169], v26 offset:9584
    ds_read_b64 v[170:171], v26 offset:9592
    ds_read_b64 v[208:209], v25 offset:9472
    ds_read_b64 v[210:211], v25 offset:9480
    ds_read_b64 v[212:213], v26 offset:4896
    ds_read_b64 v[214:215], v26 offset:4904
    ds_read_b64 v[216:217], v26 offset:9632
    ds_read_b64 v[218:219], v26 offset:9640
    s_or_b32 s20, s28, s31
    s_or_b32 s20, s20, s30
    s_cmp_eq_u32 s20, 0
    s_cselect_b64 vcc, -1, 0
    v_mov_b32 v60, 0xf149f2ca
    v_cndmask_b32 v36, v28, v60, vcc
    v_cndmask_b32 v37, v29, v60, vcc
    v_cndmask_b32 v38, v30, v60, vcc
    v_cndmask_b32 v39, v31, v60, vcc
    v_mov_b32 v56, 0x3ea52b5c
    v_mov_b32 v52, 0x3f803f80
    v_mov_b32 v53, 0x3f803f80
    v_mov_b32 v54, 0x3f803f80
    v_mov_b32 v55, 0x3f803f80
    s_waitcnt lgkmcnt(15)
    v_mfma_f32_16x16x32_bf16 v[84:87], v[68:71], v[64:67], v[36:39]
    v_mfma_f32_16x16x32_bf16 v[88:91], v[72:75], v[64:67], v[32:35]
    s_waitcnt lgkmcnt(12)
    v_mfma_f32_16x16x32_bf16 v[132:135], v[116:119], v[112:115], v[36:39]
    v_mfma_f32_16x16x32_bf16 v[136:139], v[120:123], v[112:115], v[32:35]
    s_waitcnt lgkmcnt(6)
    v_mfma_f32_16x16x32_bf16 v[180:183], v[164:167], v[160:163], v[28:31]
    v_mfma_f32_16x16x32_bf16 v[184:187], v[168:171], v[160:163], v[32:35]
    s_waitcnt lgkmcnt(0)
    v_mfma_f32_16x16x32_bf16 v[228:231], v[212:215], v[208:211], v[28:31]
    v_mfma_f32_16x16x32_bf16 v[232:235], v[216:219], v[208:211], v[32:35]
    ds_read_b64_tr_b16 v[76:77], v27 offset:208
    ds_read_b64_tr_b16 v[78:79], v27 offset:4944
    ds_read_b64_tr_b16 v[80:81], v27 offset:240
    ds_read_b64_tr_b16 v[82:83], v27 offset:4976
    ds_read_b64_tr_b16 v[124:125], v27 offset:248
    ds_read_b64_tr_b16 v[126:127], v27 offset:4984
    ds_read_b64_tr_b16 v[128:129], v27 offset:280
    ds_read_b64_tr_b16 v[130:131], v27 offset:5016
    ds_read_b64_tr_b16 v[172:173], v27 offset:4944
    ds_read_b64_tr_b16 v[174:175], v27 offset:9680
    ds_read_b64_tr_b16 v[176:177], v27 offset:4976
    ds_read_b64_tr_b16 v[178:179], v27 offset:9712
    ds_read_b64_tr_b16 v[220:221], v27 offset:4984
    ds_read_b64_tr_b16 v[222:223], v27 offset:9720
    ds_read_b64_tr_b16 v[224:225], v27 offset:5016
    ds_read_b64_tr_b16 v[226:227], v27 offset:9752
    v_max3_f32 v108, v84, v85, v86
    v_max3_f32 v109, v88, v89, v90
    v_max3_f32 v156, v132, v133, v134
    v_max3_f32 v157, v136, v137, v138
    v_max3_f32 v204, v180, v181, v182
    v_max3_f32 v205, v184, v185, v186
    v_max3_f32 v252, v228, v229, v230
    v_max3_f32 v253, v232, v233, v234
    s_add_u32 s75, s61, 0
    s_add_u32 m0, s60, 0
    s_nop 0
    buffer_load_dwordx4 v1, s[4:7], s75 offen offset:0 lds
    v_max3_f32 v108, v108, v87, v91
    v_max3_f32 v156, v156, v135, v139
    v_max3_f32 v204, v204, v183, v187
    v_max3_f32 v252, v252, v231, v235
    v_max_f32 v108, v108, v109
    v_max_f32 v156, v156, v157
    v_max_f32 v204, v204, v205
    v_max_f32 v252, v252, v253
    buffer_load_dwordx4 v1, s[4:7], s75 offen offset:1024 lds
    v_mov_b32 v109, v108
    v_mov_b32 v157, v156
    v_mov_b32 v205, v204
    v_mov_b32 v253, v252
    v_permlane32_swap_b32 v108, v109
    v_permlane32_swap_b32 v156, v157
    v_permlane32_swap_b32 v204, v205
    v_permlane32_swap_b32 v252, v253
    buffer_load_dwordx4 v1, s[4:7], s75 offen offset:2048 lds
    v_max_f32 v108, v108, v109
    v_max_f32 v156, v156, v157
    v_max_f32 v204, v204, v205
    v_max_f32 v252, v252, v253
    v_mov_b32 v109, v108
    v_mov_b32 v157, v156
    v_mov_b32 v205, v204
    v_mov_b32 v253, v252
    buffer_load_dwordx4 v1, s[4:7], s75 offen offset:3072 lds
    v_permlane16_swap_b32 v108, v109
    v_permlane16_swap_b32 v156, v157
    v_permlane16_swap_b32 v204, v205
    v_permlane16_swap_b32 v252, v253
    v_max_f32 v108, v108, v109
    v_max_f32 v156, v156, v157
    v_max_f32 v204, v204, v205
    v_max_f32 v252, v252, v253
    s_add_u32 m0, s60, 4096
    s_add_u32 s75, s75, 4096
    buffer_load_dwordx4 v1, s[4:7], s75 offen lds
    s_waitcnt lgkmcnt(0)
    s_barrier
    v_mul_f32 v108, v56, v108
    v_mul_f32 v156, v56, v156
    v_mul_f32 v204, v56, v204
    v_mul_f32 v252, v56, v252
    v_pk_fma_f32 v[84:85], v[84:85], v[56:57], v[108:109] op_sel_hi:[1,0,0] neg_lo:[0,0,1] neg_hi:[0,0,1]
    v_pk_fma_f32 v[132:133], v[132:133], v[56:57], v[156:157] op_sel_hi:[1,0,0] neg_lo:[0,0,1] neg_hi:[0,0,1]
    v_pk_fma_f32 v[180:181], v[180:181], v[56:57], v[204:205] op_sel_hi:[1,0,0] neg_lo:[0,0,1] neg_hi:[0,0,1]
    v_pk_fma_f32 v[228:229], v[228:229], v[56:57], v[252:253] op_sel_hi:[1,0,0] neg_lo:[0,0,1] neg_hi:[0,0,1]
    s_add_u32 s75, s61, 61440
    s_add_u32 m0, s60, 61440
    s_nop 0
    buffer_load_dwordx4 v1, s[4:7], s75 offen offset:0 lds
    v_pk_fma_f32 v[86:87], v[86:87], v[56:57], v[108:109] op_sel_hi:[1,0,0] neg_lo:[0,0,1] neg_hi:[0,0,1]
    v_pk_fma_f32 v[134:135], v[134:135], v[56:57], v[156:157] op_sel_hi:[1,0,0] neg_lo:[0,0,1] neg_hi:[0,0,1]
    v_pk_fma_f32 v[182:183], v[182:183], v[56:57], v[204:205] op_sel_hi:[1,0,0] neg_lo:[0,0,1] neg_hi:[0,0,1]
    v_pk_fma_f32 v[230:231], v[230:231], v[56:57], v[252:253] op_sel_hi:[1,0,0] neg_lo:[0,0,1] neg_hi:[0,0,1]
    v_pk_fma_f32 v[88:89], v[88:89], v[56:57], v[108:109] op_sel_hi:[1,0,0] neg_lo:[0,0,1] neg_hi:[0,0,1]
    v_pk_fma_f32 v[136:137], v[136:137], v[56:57], v[156:157] op_sel_hi:[1,0,0] neg_lo:[0,0,1] neg_hi:[0,0,1]
    v_pk_fma_f32 v[184:185], v[184:185], v[56:57], v[204:205] op_sel_hi:[1,0,0] neg_lo:[0,0,1] neg_hi:[0,0,1]
    v_pk_fma_f32 v[232:233], v[232:233], v[56:57], v[252:253] op_sel_hi:[1,0,0] neg_lo:[0,0,1] neg_hi:[0,0,1]
    buffer_load_dwordx4 v1, s[4:7], s75 offen offset:1024 lds
    v_pk_fma_f32 v[90:91], v[90:91], v[56:57], v[108:109] op_sel_hi:[1,0,0] neg_lo:[0,0,1] neg_hi:[0,0,1]
    v_pk_fma_f32 v[138:139], v[138:139], v[56:57], v[156:157] op_sel_hi:[1,0,0] neg_lo:[0,0,1] neg_hi:[0,0,1]
    v_pk_fma_f32 v[186:187], v[186:187], v[56:57], v[204:205] op_sel_hi:[1,0,0] neg_lo:[0,0,1] neg_hi:[0,0,1]
    v_pk_fma_f32 v[234:235], v[234:235], v[56:57], v[252:253] op_sel_hi:[1,0,0] neg_lo:[0,0,1] neg_hi:[0,0,1]
    v_exp_f32 v84, v84
    v_exp_f32 v85, v85
    v_exp_f32 v86, v86
    v_exp_f32 v87, v87
    buffer_load_dwordx4 v1, s[4:7], s75 offen offset:2048 lds
    v_exp_f32 v88, v88
    v_exp_f32 v89, v89
    v_exp_f32 v90, v90
    v_exp_f32 v91, v91
    v_exp_f32 v132, v132
    v_exp_f32 v133, v133
    v_exp_f32 v134, v134
    v_exp_f32 v135, v135
    buffer_load_dwordx4 v1, s[4:7], s75 offen offset:3072 lds
    v_exp_f32 v136, v136
    v_exp_f32 v137, v137
    v_exp_f32 v138, v138
    v_exp_f32 v139, v139
    v_cvt_pk_bf16_f32 v92, v84, v85
    v_cvt_pk_bf16_f32 v93, v86, v87
    v_cvt_pk_bf16_f32 v94, v88, v89
    v_cvt_pk_bf16_f32 v95, v90, v91
    s_add_u32 m0, s60, 65536
    s_add_u32 s75, s75, 4096
    buffer_load_dwordx4 v1, s[4:7], s75 offen lds
    v_exp_f32 v180, v180
    v_exp_f32 v181, v181
    v_exp_f32 v182, v182
    v_exp_f32 v183, v183
    v_exp_f32 v184, v184
    v_exp_f32 v185, v185
    v_exp_f32 v186, v186
    v_exp_f32 v187, v187
    s_add_u32 s75, s61, 81920
    s_add_u32 m0, s60, 81920
    s_nop 0
    buffer_load_dwordx4 v1, s[4:7], s75 offen offset:0 lds
    v_cvt_pk_bf16_f32 v140, v132, v133
    v_cvt_pk_bf16_f32 v141, v134, v135
    v_cvt_pk_bf16_f32 v142, v136, v137
    v_cvt_pk_bf16_f32 v143, v138, v139
    v_exp_f32 v228, v228
    v_exp_f32 v229, v229
    v_exp_f32 v230, v230
    v_exp_f32 v231, v231
    buffer_load_dwordx4 v1, s[4:7], s75 offen offset:1024 lds
    v_exp_f32 v232, v232
    v_exp_f32 v233, v233
    v_exp_f32 v234, v234
    v_exp_f32 v235, v235
    v_cvt_pk_bf16_f32 v188, v180, v181
    v_cvt_pk_bf16_f32 v189, v182, v183
    v_cvt_pk_bf16_f32 v190, v184, v185
    v_cvt_pk_bf16_f32 v191, v186, v187
    buffer_load_dwordx4 v1, s[4:7], s75 offen offset:2048 lds
    v_cvt_pk_bf16_f32 v236, v228, v229
    v_cvt_pk_bf16_f32 v237, v230, v231
    v_cvt_pk_bf16_f32 v238, v232, v233
    v_cvt_pk_bf16_f32 v239, v234, v235
    s_waitcnt lgkmcnt(0)
    v_mfma_f32_16x16x32_bf16 v[104:107], v[52:55], v[92:95], 0
    v_mfma_f32_16x16x32_bf16 v[96:99], v[76:79], v[92:95], 0
    v_mfma_f32_16x16x32_bf16 v[100:103], v[80:83], v[92:95], 0
    v_mfma_f32_16x16x32_bf16 v[152:155], v[52:55], v[140:143], 0
    v_mfma_f32_16x16x32_bf16 v[144:147], v[124:127], v[140:143], 0
    v_mfma_f32_16x16x32_bf16 v[148:151], v[128:131], v[140:143], 0
    v_mfma_f32_16x16x32_bf16 v[200:203], v[52:55], v[188:191], 0
    v_mfma_f32_16x16x32_bf16 v[192:195], v[172:175], v[188:191], 0
    v_mfma_f32_16x16x32_bf16 v[196:199], v[176:179], v[188:191], 0
    v_mfma_f32_16x16x32_bf16 v[248:251], v[52:55], v[236:239], 0
    v_mfma_f32_16x16x32_bf16 v[240:243], v[220:223], v[236:239], 0
    v_mfma_f32_16x16x32_bf16 v[244:247], v[224:227], v[236:239], 0
    s_add_u32 s20, s54, s66
    s_add_u32 s21, s54, s67
    s_add_u32 s22, s20, 20480
    s_add_u32 s23, s21, 20480
    v_rcp_f32 v108, v104
    v_rcp_f32 v156, v152
    v_rcp_f32 v204, v200
    v_rcp_f32 v252, v248
    v_pk_mul_f32 v[96:97], v[96:97], v[108:109] op_sel_hi:[1,0]
    v_pk_mul_f32 v[98:99], v[98:99], v[108:109] op_sel_hi:[1,0]
    v_pk_mul_f32 v[100:101], v[100:101], v[108:109] op_sel_hi:[1,0]
    v_pk_mul_f32 v[102:103], v[102:103], v[108:109] op_sel_hi:[1,0]
    buffer_load_dwordx4 v1, s[4:7], s75 offen offset:3072 lds
    v_pk_mul_f32 v[144:145], v[144:145], v[156:157] op_sel_hi:[1,0]
    v_pk_mul_f32 v[146:147], v[146:147], v[156:157] op_sel_hi:[1,0]
    v_pk_mul_f32 v[148:149], v[148:149], v[156:157] op_sel_hi:[1,0]
    v_pk_mul_f32 v[150:151], v[150:151], v[156:157] op_sel_hi:[1,0]
    v_cvt_pk_bf16_f32 v40, v96, v97
    v_cvt_pk_bf16_f32 v41, v98, v99
    v_cvt_pk_bf16_f32 v42, v144, v145
    v_cvt_pk_bf16_f32 v43, v146, v147
    s_add_u32 m0, s60, 86016
    s_add_u32 s75, s75, 4096
    buffer_load_dwordx4 v1, s[4:7], s75 offen lds
    buffer_store_dwordx4 v[40:43], v1, s[4:7], s20 offen
    v_cvt_pk_bf16_f32 v48, v100, v101
    v_cvt_pk_bf16_f32 v49, v102, v103
    v_cvt_pk_bf16_f32 v50, v148, v149
    v_cvt_pk_bf16_f32 v51, v150, v151
    v_pk_mul_f32 v[192:193], v[192:193], v[204:205] op_sel_hi:[1,0]
    v_pk_mul_f32 v[194:195], v[194:195], v[204:205] op_sel_hi:[1,0]
    v_pk_mul_f32 v[196:197], v[196:197], v[204:205] op_sel_hi:[1,0]
    v_pk_mul_f32 v[198:199], v[198:199], v[204:205] op_sel_hi:[1,0]
    v_pk_mul_f32 v[240:241], v[240:241], v[252:253] op_sel_hi:[1,0]
    v_pk_mul_f32 v[242:243], v[242:243], v[252:253] op_sel_hi:[1,0]
    v_pk_mul_f32 v[244:245], v[244:245], v[252:253] op_sel_hi:[1,0]
    v_pk_mul_f32 v[246:247], v[246:247], v[252:253] op_sel_hi:[1,0]
    v_cvt_pk_bf16_f32 v44, v192, v193
    v_cvt_pk_bf16_f32 v45, v194, v195
    v_cvt_pk_bf16_f32 v46, v240, v241
    v_cvt_pk_bf16_f32 v47, v242, v243
    buffer_store_dwordx4 v[44:47], v1, s[4:7], s22 offen
    v_cvt_pk_bf16_f32 v60, v196, v197
    v_cvt_pk_bf16_f32 v61, v198, v199
    v_cvt_pk_bf16_f32 v62, v244, v245
    v_cvt_pk_bf16_f32 v63, v246, v247
    s_mov_b32 exec_lo, 0xffff
    s_mov_b32 exec_hi, 0x0
    buffer_store_dwordx4 v[48:51], v1, s[4:7], s21 offen
    buffer_store_dwordx4 v[60:63], v1, s[4:7], s23 offen
    s_mov_b64 exec, -1
    s_lshl_b32 s75, s30, 8
    s_add_u32 s75, s75, 160832
    v_and_b32 v25, 15, v0
    v_lshlrev_b32 v25, 4, v25
    v_add_u32 v25, s75, v25
    ds_read_b128 v[28:31], v25
    s_add_u32 s39, s39, 1
    s_add_u32 s76, s86, s39
    s_add_u32 s76, s76, 0x20
    s_lshl_b32 s75, s29, 4
    s_lshl_b32 s77, s30, 2
    s_add_u32 s75, s75, s77
    s_add_u32 s75, s75, s65
    v_mov_b32 v24, s76
    v_mov_b32 v26, 0
    s_waitcnt vmcnt(0)
    s_cmp_eq_u32 s36, 0
    s_cbranch_scc0 WS_21
    s_mov_b32 exec_lo, 0x1
    s_mov_b32 exec_hi, 0x0
    buffer_store_dword v24, v26, s[4:7], s75 offen
    s_mov_b64 exec, -1
WT_22:
    s_waitcnt lgkmcnt(0)
    buffer_load_dword v27, v28, s[4:7], s65 offen sc1
    s_waitcnt vmcnt(0)
    v_subrev_u32 v27, s76, v27
    v_cmp_le_u32 s[84:85], 8, v27
    s_nop 1
    s_cmp_eq_u64 s[84:85], 0
    s_cbranch_scc1 WK_23
    s_mov_b32 s83, 0
WP_24:
    buffer_load_dword v27, v28, s[4:7], s65 offen sc1
    s_add_u32 s83, s83, 1
    s_cmp_gt_u32 s83, 200000
    s_cbranch_scc1 L_END
    s_waitcnt vmcnt(0)
    v_subrev_u32 v27, s76, v27
    v_cmp_le_u32 s[84:85], 8, v27
    s_nop 1
    s_cmp_eq_u64 s[84:85], 0
    s_cbranch_scc0 WP_24
WK_23:
    s_add_u32 s77, s54, s68
    buffer_load_dwordx4 a[160:163], v1, s[4:7], s77 offen offset:0 sc1
    buffer_load_dwordx4 a[164:167], v1, s[4:7], s77 offen offset:1024 sc1
    buffer_load_dwordx4 a[168:171], v1, s[4:7], s77 offen offset:2048 sc1
    buffer_load_dwordx4 a[172:175], v1, s[4:7], s77 offen offset:3072 sc1
    s_add_u32 s77, s77, 4096
    buffer_load_dwordx4 a[176:179], v1, s[4:7], s77 offen offset:0 sc1
    buffer_load_dwordx4 a[180:183], v1, s[4:7], s77 offen offset:1024 sc1
    buffer_load_dwordx4 a[184:187], v1, s[4:7], s77 offen offset:2048 sc1
    buffer_load_dwordx4 a[188:191], v1, s[4:7], s77 offen offset:3072 sc1
    v_lshrrev_b32 v24, 4, v0
    v_and_b32 v25, 15, v0
    v_lshrrev_b32 v26, 1, v24
    v_lshlrev_b32 v26, 9, v26
    v_and_b32 v24, 1, v24
    v_lshlrev_b32 v24, 3, v24
    v_lshlrev_b32 v125, 4, v25
    v_add_u32 v125, v125, v26
    v_add_u32 v125, v125, v24
    s_barrier
    ds_read_b128 v[80:83], v1 offset:0
    ds_read_b128 v[84:87], v1 offset:1024
    ds_read_b128 v[88:91], v1 offset:2048
    ds_read_b128 v[92:95], v1 offset:3072
    ds_read_b128 v[96:99], v1 offset:4096
    ds_read_b128 v[100:103], v1 offset:5120
    ds_read_b128 v[104:107], v1 offset:6144
    ds_read_b128 v[108:111], v1 offset:7168
    s_waitcnt vmcnt(7)
    s_waitcnt lgkmcnt(6)
    v_mfma_f32_16x16x32_bf16 v[40:43], v[80:83], a[160:163], 0
    ds_read_b128 v[112:115], v1 offset:8192
    s_add_u32 s77, s77, 4096
    buffer_load_dwordx4 a[192:195], v1, s[4:7], s77 offen offset:0 sc1
    v_mfma_f32_16x16x32_bf16 v[44:47], v[84:87], a[160:163], 0
    ds_read_b128 v[116:119], v1 offset:9216
    s_waitcnt lgkmcnt(6)
    v_mfma_f32_16x16x32_bf16 v[48:51], v[88:91], a[160:163], 0
    ds_read_b128 v[80:83], v1 offset:10240
    buffer_load_dwordx4 a[196:199], v1, s[4:7], s77 offen offset:1024 sc1
    v_mfma_f32_16x16x32_bf16 v[52:55], v[92:95], a[160:163], 0
    ds_read_b128 v[84:87], v1 offset:11264
    s_waitcnt lgkmcnt(6)
    v_mfma_f32_16x16x32_bf16 v[56:59], v[96:99], a[160:163], 0
    ds_read_b128 v[88:91], v1 offset:12288
    buffer_load_dwordx4 a[200:203], v1, s[4:7], s77 offen offset:2048 sc1
    s_waitcnt vmcnt(9)
    v_mfma_f32_16x16x32_bf16 v[40:43], v[100:103], a[164:167], v[40:43]
    ds_read_b128 v[92:95], v1 offset:13312
    s_waitcnt lgkmcnt(6)
    v_mfma_f32_16x16x32_bf16 v[44:47], v[104:107], a[164:167], v[44:47]
    ds_read_b128 v[96:99], v1 offset:14336
    buffer_load_dwordx4 a[204:207], v1, s[4:7], s77 offen offset:3072 sc1
    s_add_u32 s77, s77, 4096
    v_mfma_f32_16x16x32_bf16 v[48:51], v[108:111], a[164:167], v[48:51]
    ds_read_b128 v[100:103], v1 offset:15360
    s_waitcnt lgkmcnt(6)
    v_mfma_f32_16x16x32_bf16 v[52:55], v[112:115], a[164:167], v[52:55]
    ds_read_b128 v[104:107], v1 offset:16384
    buffer_load_dwordx4 a[208:211], v1, s[4:7], s77 offen offset:0 sc1
    v_mfma_f32_16x16x32_bf16 v[56:59], v[116:119], a[164:167], v[56:59]
    ds_read_b128 v[108:111], v1 offset:17408
    s_waitcnt vmcnt(10)
    s_waitcnt lgkmcnt(6)
    v_mfma_f32_16x16x32_bf16 v[40:43], v[80:83], a[168:171], v[40:43]
    ds_read_b128 v[112:115], v1 offset:18432
    buffer_load_dwordx4 a[212:215], v1, s[4:7], s77 offen offset:1024 sc1
    v_mfma_f32_16x16x32_bf16 v[44:47], v[84:87], a[168:171], v[44:47]
    ds_read_b128 v[116:119], v1 offset:19456
    s_waitcnt lgkmcnt(6)
    v_mfma_f32_16x16x32_bf16 v[48:51], v[88:91], a[168:171], v[48:51]
    s_waitcnt lgkmcnt(0)
    s_barrier
    ds_read_b128 v[80:83], v1 offset:20480
    buffer_load_dwordx4 a[216:219], v1, s[4:7], s77 offen offset:2048 sc1
    v_mfma_f32_16x16x32_bf16 v[52:55], v[92:95], a[168:171], v[52:55]
    ds_read_b128 v[84:87], v1 offset:21504
    s_waitcnt lgkmcnt(6)
    v_mfma_f32_16x16x32_bf16 v[56:59], v[96:99], a[168:171], v[56:59]
    ds_read_b128 v[88:91], v1 offset:22528
    buffer_load_dwordx4 a[220:223], v1, s[4:7], s77 offen offset:3072 sc1
    s_add_u32 s77, s77, 4096
    s_waitcnt vmcnt(12)
    v_mfma_f32_16x16x32_bf16 v[40:43], v[100:103], a[172:175], v[40:43]
    ds_read_b128 v[92:95], v1 offset:23552
    s_waitcnt lgkmcnt(6)
    v_mfma_f32_16x16x32_bf16 v[44:47], v[104:107], a[172:175], v[44:47]
    ds_read_b128 v[96:99], v1 offset:24576
    buffer_load_dwordx4 a[224:227], v1, s[4:7], s77 offen offset:0 sc1
    v_mfma_f32_16x16x32_bf16 v[48:51], v[108:111], a[172:175], v[48:51]
    ds_read_b128 v[100:103], v1 offset:25600
    s_waitcnt lgkmcnt(6)
    v_mfma_f32_16x16x32_bf16 v[52:55], v[112:115], a[172:175], v[52:55]
    ds_read_b128 v[104:107], v1 offset:26624
    buffer_load_dwordx4 a[228:231], v1, s[4:7], s77 offen offset:1024 sc1
    v_mfma_f32_16x16x32_bf16 v[56:59], v[116:119], a[172:175], v[56:59]
    ds_read_b128 v[108:111], v1 offset:27648
    s_waitcnt vmcnt(13)
    s_waitcnt lgkmcnt(6)
    v_mfma_f32_16x16x32_bf16 v[40:43], v[80:83], a[176:179], v[40:43]
    ds_read_b128 v[112:115], v1 offset:28672
    buffer_load_dwordx4 a[232:235], v1, s[4:7], s77 offen offset:2048 sc1
    v_mfma_f32_16x16x32_bf16 v[44:47], v[84:87], a[176:179], v[44:47]
    ds_read_b128 v[116:119], v1 offset:29696
    s_waitcnt lgkmcnt(6)
    v_mfma_f32_16x16x32_bf16 v[48:51], v[88:91], a[176:179], v[48:51]
    ds_read_b128 v[80:83], v1 offset:30720
    buffer_load_dwordx4 a[236:239], v1, s[4:7], s77 offen offset:3072 sc1
    s_add_u32 s75, s40, 0
    v_mfma_f32_16x16x32_bf16 v[52:55], v[92:95], a[176:179], v[52:55]
    ds_read_b128 v[84:87], v1 offset:31744
    s_add_u32 m0, s60, 102400
    s_waitcnt lgkmcnt(6)
    v_mfma_f32_16x16x32_bf16 v[56:59], v[96:99], a[176:179], v[56:59]
    ds_read_b128 v[88:91], v1 offset:32768
    buffer_load_dwordx4 v1, s[4:7], s75 offen offset:0 lds
    s_waitcnt vmcnt(15)
    v_mfma_f32_16x16x32_bf16 v[40:43], v[100:103], a[180:183], v[40:43]
    ds_read_b128 v[92:95], v1 offset:33792
    s_waitcnt lgkmcnt(6)
    v_mfma_f32_16x16x32_bf16 v[44:47], v[104:107], a[180:183], v[44:47]
    ds_read_b128 v[96:99], v1 offset:34816
    buffer_load_dwordx4 v1, s[4:7], s75 offen offset:1024 lds
    v_mfma_f32_16x16x32_bf16 v[48:51], v[108:111], a[180:183], v[48:51]
    ds_read_b128 v[100:103], v1 offset:35840
    s_waitcnt lgkmcnt(6)
    v_mfma_f32_16x16x32_bf16 v[52:55], v[112:115], a[180:183], v[52:55]
    ds_read_b128 v[104:107], v1 offset:36864
    buffer_load_dwordx4 v1, s[4:7], s75 offen offset:2048 lds
    v_mfma_f32_16x16x32_bf16 v[56:59], v[116:119], a[180:183], v[56:59]
    ds_read_b128 v[108:111], v1 offset:37888
    s_waitcnt vmcnt(16)
    s_waitcnt lgkmcnt(6)
    v_mfma_f32_16x16x32_bf16 v[40:43], v[80:83], a[184:187], v[40:43]
    ds_read_b128 v[112:115], v1 offset:38912
    buffer_load_dwordx4 v1, s[4:7], s75 offen offset:3072 lds
    s_add_u32 m0, s60, 106496
    v_mfma_f32_16x16x32_bf16 v[44:47], v[84:87], a[184:187], v[44:47]
    ds_read_b128 v[116:119], v1 offset:39936
    s_add_u32 s75, s75, 4096
    s_waitcnt lgkmcnt(6)
    v_mfma_f32_16x16x32_bf16 v[48:51], v[88:91], a[184:187], v[48:51]
    s_waitcnt lgkmcnt(0)
    s_barrier
    ds_read_b128 v[80:83], v1 offset:40960
    buffer_load_dwordx4 v1, s[4:7], s75 offen lds
    s_add_u32 s75, s40, 20480
    v_mfma_f32_16x16x32_bf16 v[52:55], v[92:95], a[184:187], v[52:55]
    ds_read_b128 v[84:87], v1 offset:41984
    s_add_u32 m0, s60, 122880
    s_waitcnt lgkmcnt(6)
    v_mfma_f32_16x16x32_bf16 v[56:59], v[96:99], a[184:187], v[56:59]
    ds_read_b128 v[88:91], v1 offset:43008
    buffer_load_dwordx4 v1, s[4:7], s75 offen offset:0 lds
    s_waitcnt vmcnt(18)
    v_mfma_f32_16x16x32_bf16 v[40:43], v[100:103], a[188:191], v[40:43]
    ds_read_b128 v[92:95], v1 offset:44032
    s_waitcnt lgkmcnt(6)
    v_mfma_f32_16x16x32_bf16 v[44:47], v[104:107], a[188:191], v[44:47]
    ds_read_b128 v[96:99], v1 offset:45056
    buffer_load_dwordx4 v1, s[4:7], s75 offen offset:1024 lds
    v_mfma_f32_16x16x32_bf16 v[48:51], v[108:111], a[188:191], v[48:51]
    ds_read_b128 v[100:103], v1 offset:46080
    s_waitcnt lgkmcnt(6)
    v_mfma_f32_16x16x32_bf16 v[52:55], v[112:115], a[188:191], v[52:55]
    ds_read_b128 v[104:107], v1 offset:47104
    buffer_load_dwordx4 v1, s[4:7], s75 offen offset:2048 lds
    v_mfma_f32_16x16x32_bf16 v[56:59], v[116:119], a[188:191], v[56:59]
    ds_read_b128 v[108:111], v1 offset:48128
    s_waitcnt vmcnt(19)
    s_waitcnt lgkmcnt(6)
    v_mfma_f32_16x16x32_bf16 v[40:43], v[80:83], a[192:195], v[40:43]
    ds_read_b128 v[112:115], v1 offset:49152
    buffer_load_dwordx4 v1, s[4:7], s75 offen offset:3072 lds
    s_add_u32 m0, s60, 126976
    v_mfma_f32_16x16x32_bf16 v[44:47], v[84:87], a[192:195], v[44:47]
    ds_read_b128 v[116:119], v1 offset:50176
    s_add_u32 s75, s75, 4096
    s_waitcnt lgkmcnt(6)
    v_mfma_f32_16x16x32_bf16 v[48:51], v[88:91], a[192:195], v[48:51]
    ds_read_b128 v[80:83], v1 offset:51200
    buffer_load_dwordx4 v1, s[4:7], s75 offen lds
    s_add_u32 s75, s41, 0
    v_mfma_f32_16x16x32_bf16 v[52:55], v[92:95], a[192:195], v[52:55]
    ds_read_b128 v[84:87], v1 offset:52224
    s_add_u32 m0, s60, 0
    s_waitcnt lgkmcnt(6)
    v_mfma_f32_16x16x32_bf16 v[56:59], v[96:99], a[192:195], v[56:59]
    ds_read_b128 v[88:91], v1 offset:53248
    buffer_load_dwordx4 v1, s[4:7], s75 offen offset:0 lds
    s_waitcnt vmcnt(21)
    v_mfma_f32_16x16x32_bf16 v[40:43], v[100:103], a[196:199], v[40:43]
    ds_read_b128 v[92:95], v1 offset:54272
    s_waitcnt lgkmcnt(6)
    v_mfma_f32_16x16x32_bf16 v[44:47], v[104:107], a[196:199], v[44:47]
    ds_read_b128 v[96:99], v1 offset:55296
    buffer_load_dwordx4 v1, s[4:7], s75 offen offset:1024 lds
    v_mfma_f32_16x16x32_bf16 v[48:51], v[108:111], a[196:199], v[48:51]
    ds_read_b128 v[100:103], v1 offset:56320
    s_waitcnt lgkmcnt(6)
    v_mfma_f32_16x16x32_bf16 v[52:55], v[112:115], a[196:199], v[52:55]
    ds_read_b128 v[104:107], v1 offset:57344
    buffer_load_dwordx4 v1, s[4:7], s75 offen offset:2048 lds
    v_mfma_f32_16x16x32_bf16 v[56:59], v[116:119], a[196:199], v[56:59]
    ds_read_b128 v[108:111], v1 offset:58368
    s_waitcnt vmcnt(22)
    s_waitcnt lgkmcnt(6)
    v_mfma_f32_16x16x32_bf16 v[40:43], v[80:83], a[200:203], v[40:43]
    ds_read_b128 v[112:115], v1 offset:59392
    buffer_load_dwordx4 v1, s[4:7], s75 offen offset:3072 lds
    s_add_u32 m0, s60, 4096
    v_mfma_f32_16x16x32_bf16 v[44:47], v[84:87], a[200:203], v[44:47]
    ds_read_b128 v[116:119], v1 offset:60416
    s_add_u32 s75, s75, 4096
    s_waitcnt lgkmcnt(6)
    v_mfma_f32_16x16x32_bf16 v[48:51], v[88:91], a[200:203], v[48:51]
    s_waitcnt lgkmcnt(0)
    s_barrier
    ds_read_b128 v[80:83], v1 offset:61440
    buffer_load_dwordx4 v1, s[4:7], s75 offen lds
    s_add_u32 s75, s41, 20480
    v_mfma_f32_16x16x32_bf16 v[52:55], v[92:95], a[200:203], v[52:55]
    ds_read_b128 v[84:87], v1 offset:62464
    s_add_u32 m0, s60, 20480
    s_waitcnt lgkmcnt(6)
    v_mfma_f32_16x16x32_bf16 v[56:59], v[96:99], a[200:203], v[56:59]
    ds_read_b128 v[88:91], v1 offset:63488
    buffer_load_dwordx4 v1, s[4:7], s75 offen offset:0 lds
    s_waitcnt vmcnt(24)
    v_mfma_f32_16x16x32_bf16 v[40:43], v[100:103], a[204:207], v[40:43]
    ds_read_b128 v[92:95], v1 offset:64512
    s_waitcnt lgkmcnt(6)
    v_mfma_f32_16x16x32_bf16 v[44:47], v[104:107], a[204:207], v[44:47]
    ds_read_b128 v[96:99], v22 offset:0
    buffer_load_dwordx4 v1, s[4:7], s75 offen offset:1024 lds
    v_mfma_f32_16x16x32_bf16 v[48:51], v[108:111], a[204:207], v[48:51]
    ds_read_b128 v[100:103], v22 offset:1024
    s_waitcnt lgkmcnt(6)
    v_mfma_f32_16x16x32_bf16 v[52:55], v[112:115], a[204:207], v[52:55]
    ds_read_b128 v[104:107], v22 offset:2048
    buffer_load_dwordx4 v1, s[4:7], s75 offen offset:2048 lds
    v_mfma_f32_16x16x32_bf16 v[56:59], v[116:119], a[204:207], v[56:59]
    ds_read_b128 v[108:111], v22 offset:3072
    s_waitcnt vmcnt(25)
    s_waitcnt lgkmcnt(6)
    v_mfma_f32_16x16x32_bf16 v[40:43], v[80:83], a[208:211], v[40:43]
    ds_read_b128 v[112:115], v22 offset:4096
    buffer_load_dwordx4 v1, s[4:7], s75 offen offset:3072 lds
    s_add_u32 m0, s60, 24576
    v_mfma_f32_16x16x32_bf16 v[44:47], v[84:87], a[208:211], v[44:47]
    ds_read_b128 v[116:119], v22 offset:5120
    s_add_u32 s75, s75, 4096
    s_waitcnt lgkmcnt(6)
    v_mfma_f32_16x16x32_bf16 v[48:51], v[88:91], a[208:211], v[48:51]
    ds_read_b128 v[80:83], v22 offset:6144
    buffer_load_dwordx4 v1, s[4:7], s75 offen lds
    v_mfma_f32_16x16x32_bf16 v[52:55], v[92:95], a[208:211], v[52:55]
    ds_read_b128 v[84:87], v22 offset:7168
    s_waitcnt lgkmcnt(6)
    v_mfma_f32_16x16x32_bf16 v[56:59], v[96:99], a[208:211], v[56:59]
    ds_read_b128 v[88:91], v22 offset:8192
    s_waitcnt vmcnt(26)
    v_mfma_f32_16x16x32_bf16 v[40:43], v[100:103], a[212:215], v[40:43]
    ds_read_b128 v[92:95], v22 offset:9216
    s_waitcnt lgkmcnt(6)
    v_mfma_f32_16x16x32_bf16 v[44:47], v[104:107], a[212:215], v[44:47]
    ds_read_b128 v[96:99], v22 offset:10240
    v_mfma_f32_16x16x32_bf16 v[48:51], v[108:111], a[212:215], v[48:51]
    ds_read_b128 v[100:103], v22 offset:11264
    s_waitcnt lgkmcnt(6)
    v_mfma_f32_16x16x32_bf16 v[52:55], v[112:115], a[212:215], v[52:55]
    ds_read_b128 v[104:107], v22 offset:12288
    v_mfma_f32_16x16x32_bf16 v[56:59], v[116:119], a[212:215], v[56:59]
    ds_read_b128 v[108:111], v22 offset:13312
    s_waitcnt vmcnt(25)
    s_waitcnt lgkmcnt(6)
    v_mfma_f32_16x16x32_bf16 v[40:43], v[80:83], a[216:219], v[40:43]
    ds_read_b128 v[112:115], v22 offset:14336
    v_mfma_f32_16x16x32_bf16 v[44:47], v[84:87], a[216:219], v[44:47]
    ds_read_b128 v[116:119], v22 offset:15360
    s_waitcnt lgkmcnt(6)
    v_mfma_f32_16x16x32_bf16 v[48:51], v[88:91], a[216:219], v[48:51]
    s_waitcnt lgkmcnt(0)
    s_barrier
    ds_read_b128 v[80:83], v22 offset:16384
    v_mfma_f32_16x16x32_bf16 v[52:55], v[92:95], a[216:219], v[52:55]
    ds_read_b128 v[84:87], v22 offset:17408
    s_waitcnt lgkmcnt(6)
    v_mfma_f32_16x16x32_bf16 v[56:59], v[96:99], a[216:219], v[56:59]
    ds_read_b128 v[88:91], v22 offset:18432
    s_waitcnt vmcnt(24)
    v_mfma_f32_16x16x32_bf16 v[40:43], v[100:103], a[220:223], v[40:43]
    ds_read_b128 v[92:95], v22 offset:19456
    s_waitcnt lgkmcnt(6)
    v_mfma_f32_16x16x32_bf16 v[44:47], v[104:107], a[220:223], v[44:47]
    ds_read_b128 v[96:99], v22 offset:20480
    v_mfma_f32_16x16x32_bf16 v[48:51], v[108:111], a[220:223], v[48:51]
    ds_read_b128 v[100:103], v22 offset:21504
    s_waitcnt lgkmcnt(6)
    v_mfma_f32_16x16x32_bf16 v[52:55], v[112:115], a[220:223], v[52:55]
    ds_read_b128 v[104:107], v22 offset:22528
    v_mfma_f32_16x16x32_bf16 v[56:59], v[116:119], a[220:223], v[56:59]
    ds_read_b128 v[108:111], v22 offset:23552
    s_waitcnt vmcnt(23)
    s_waitcnt lgkmcnt(6)
    v_mfma_f32_16x16x32_bf16 v[40:43], v[80:83], a[224:227], v[40:43]
    ds_read_b128 v[112:115], v22 offset:24576
    v_mfma_f32_16x16x32_bf16 v[44:47], v[84:87], a[224:227], v[44:47]
    ds_read_b128 v[116:119], v22 offset:25600
    s_waitcnt lgkmcnt(6)
    v_mfma_f32_16x16x32_bf16 v[48:51], v[88:91], a[224:227], v[48:51]
    ds_read_b128 v[80:83], v22 offset:26624
    v_mfma_f32_16x16x32_bf16 v[52:55], v[92:95], a[224:227], v[52:55]
    ds_read_b128 v[84:87], v22 offset:27648
    s_waitcnt lgkmcnt(6)
    v_mfma_f32_16x16x32_bf16 v[56:59], v[96:99], a[224:227], v[56:59]
    ds_read_b128 v[88:91], v22 offset:28672
    s_waitcnt vmcnt(22)
    v_mfma_f32_16x16x32_bf16 v[40:43], v[100:103], a[228:231], v[40:43]
    ds_read_b128 v[92:95], v22 offset:29696
    s_waitcnt lgkmcnt(6)
    v_mfma_f32_16x16x32_bf16 v[44:47], v[104:107], a[228:231], v[44:47]
    ds_read_b128 v[96:99], v22 offset:30720
    v_mfma_f32_16x16x32_bf16 v[48:51], v[108:111], a[228:231], v[48:51]
    ds_read_b128 v[100:103], v22 offset:31744
    s_waitcnt lgkmcnt(6)
    v_mfma_f32_16x16x32_bf16 v[52:55], v[112:115], a[228:231], v[52:55]
    ds_read_b128 v[104:107], v22 offset:32768
    v_mfma_f32_16x16x32_bf16 v[56:59], v[116:119], a[228:231], v[56:59]
    ds_read_b128 v[108:111], v22 offset:33792
    s_waitcnt vmcnt(21)
    s_waitcnt lgkmcnt(6)
    v_mfma_f32_16x16x32_bf16 v[40:43], v[80:83], a[232:235], v[40:43]
    ds_read_b128 v[112:115], v22 offset:34816
    v_mfma_f32_16x16x32_bf16 v[44:47], v[84:87], a[232:235], v[44:47]
    ds_read_b128 v[116:119], v22 offset:35840
    s_waitcnt lgkmcnt(6)
    v_mfma_f32_16x16x32_bf16 v[48:51], v[88:91], a[232:235], v[48:51]
    v_mfma_f32_16x16x32_bf16 v[52:55], v[92:95], a[232:235], v[52:55]
    s_waitcnt lgkmcnt(4)
    v_mfma_f32_16x16x32_bf16 v[56:59], v[96:99], a[232:235], v[56:59]
    s_waitcnt vmcnt(20)
    v_mfma_f32_16x16x32_bf16 v[40:43], v[100:103], a[236:239], v[40:43]
    s_waitcnt lgkmcnt(2)
    v_mfma_f32_16x16x32_bf16 v[44:47], v[104:107], a[236:239], v[44:47]
    v_mfma_f32_16x16x32_bf16 v[48:51], v[108:111], a[236:239], v[48:51]
    s_waitcnt lgkmcnt(0)
    v_mfma_f32_16x16x32_bf16 v[52:55], v[112:115], a[236:239], v[52:55]
    s_waitcnt lgkmcnt(0)
    v_mfma_f32_16x16x32_bf16 v[56:59], v[116:119], a[236:239], v[56:59]
    s_barrier
    s_add_u32 s75, s54, s69
    s_add_u32 s75, s75, 327680
    s_add_u32 s76, s54, s70
    s_add_u32 s76, s76, 1540096
    v_lshlrev_b32 v24, 16, v2
    v_and_b32 v25, 0xffff0000, v2
    v_pk_add_f32 v[40:41], v[40:41], v[24:25]
    v_lshlrev_b32 v26, 16, v3
    v_and_b32 v27, 0xffff0000, v3
    v_pk_add_f32 v[42:43], v[42:43], v[26:27]
    v_lshlrev_b32 v28, 16, v4
    v_and_b32 v29, 0xffff0000, v4
    v_pk_add_f32 v[44:45], v[44:45], v[28:29]
    v_lshlrev_b32 v30, 16, v5
    v_and_b32 v31, 0xffff0000, v5
    v_pk_add_f32 v[46:47], v[46:47], v[30:31]
    v_lshlrev_b32 v24, 16, v6
    v_and_b32 v25, 0xffff0000, v6
    v_pk_add_f32 v[48:49], v[48:49], v[24:25]
    v_lshlrev_b32 v26, 16, v7
    v_and_b32 v27, 0xffff0000, v7
    v_pk_add_f32 v[50:51], v[50:51], v[26:27]
    v_lshlrev_b32 v28, 16, v8
    v_and_b32 v29, 0xffff0000, v8
    v_pk_add_f32 v[52:53], v[52:53], v[28:29]
    v_lshlrev_b32 v30, 16, v9
    v_and_b32 v31, 0xffff0000, v9
    v_pk_add_f32 v[54:55], v[54:55], v[30:31]
    v_lshlrev_b32 v24, 16, v10
    v_and_b32 v25, 0xffff0000, v10
    v_pk_add_f32 v[56:57], v[56:57], v[24:25]
    v_lshlrev_b32 v26, 16, v11
    v_and_b32 v27, 0xffff0000, v11
    v_pk_add_f32 v[58:59], v[58:59], v[26:27]
    v_cvt_pk_bf16_f32 v2, v40, v41
    v_cvt_pk_bf16_f32 v3, v42, v43
    v_cvt_pk_bf16_f32 v4, v44, v45
    v_cvt_pk_bf16_f32 v5, v46, v47
    v_cvt_pk_bf16_f32 v6, v48, v49
    v_cvt_pk_bf16_f32 v7, v50, v51
    v_cvt_pk_bf16_f32 v8, v52, v53
    v_cvt_pk_bf16_f32 v9, v54, v55
    v_cvt_pk_bf16_f32 v10, v56, v57
    v_cvt_pk_bf16_f32 v11, v58, v59
    buffer_store_dwordx2 v[2:3], v125, s[4:7], s75 offen offset:0
    buffer_store_dwordx2 v[4:5], v125, s[4:7], s75 offen offset:1024
    buffer_store_dwordx2 v[6:7], v125, s[4:7], s75 offen offset:2048
    buffer_store_dwordx2 v[8:9], v125, s[4:7], s75 offen offset:3072
    s_add_u32 s78, s75, 4096
    buffer_store_dwordx2 v[10:11], v125, s[4:7], s78 offen
    v_mov_b32 v34, 0x3f803f80
    v_mov_b32 v32, 0
    v_mov_b32 v33, 0
    v_mov_b32 v37, 0
    v_mov_b32 v38, 0
    v_dot2_f32_bf16 v32, v2, v34, v32
    v_dot2_f32_bf16 v33, v2, v2, v33
    v_dot2_f32_bf16 v37, v3, v34, v37
    v_dot2_f32_bf16 v38, v3, v3, v38
    v_dot2_f32_bf16 v32, v4, v34, v32
    v_dot2_f32_bf16 v33, v4, v4, v33
    v_dot2_f32_bf16 v37, v5, v34, v37
    v_dot2_f32_bf16 v38, v5, v5, v38
    v_dot2_f32_bf16 v32, v6, v34, v32
    v_dot2_f32_bf16 v33, v6, v6, v33
    v_dot2_f32_bf16 v37, v7, v34, v37
    v_dot2_f32_bf16 v38, v7, v7, v38
    v_dot2_f32_bf16 v32, v8, v34, v32
    v_dot2_f32_bf16 v33, v8, v8, v33
    v_dot2_f32_bf16 v37, v9, v34, v37
    v_dot2_f32_bf16 v38, v9, v9, v38
    v_dot2_f32_bf16 v32, v10, v34, v32
    v_dot2_f32_bf16 v33, v10, v10, v33
    v_dot2_f32_bf16 v37, v11, v34, v37
    v_dot2_f32_bf16 v38, v11, v11, v38
    s_nop 1
    v_add_f32 v32, v32, v37
    v_add_f32 v33, v33, v38
    v_mov_b32 v35, v32
    v_mov_b32 v36, v33
    s_nop 0
    v_permlane32_swap_b32 v32, v35
    v_permlane32_swap_b32 v33, v36
    v_add_f32 v32, v32, v35
    v_add_f32 v33, v33, v36
    v_mov_b32 v35, v32
    v_mov_b32 v36, v33
    s_nop 0
    v_permlane16_swap_b32 v32, v35
    v_permlane16_swap_b32 v33, v36
    v_add_f32 v32, v32, v35
    v_add_f32 v33, v33, v36
    v_and_b32 v24, 15, v0
    v_lshlrev_b32 v24, 3, v24
    s_mov_b32 exec_lo, 0xffff
    s_mov_b32 exec_hi, 0x0
    buffer_store_dwordx2 v[32:33], v24, s[4:7], s76 offen
    s_mov_b64 exec, -1
    s_lshl_b32 s75, s30, 8
    s_add_u32 s75, s75, 160832
    v_and_b32 v25, 15, v0
    v_lshlrev_b32 v25, 4, v25
    v_add_u32 v25, s75, v25
    ds_read_b128 v[28:31], v25
    s_add_u32 s39, s39, 1
    s_add_u32 s76, s86, s39
    s_add_u32 s76, s76, 0x20
    s_lshl_b32 s75, s29, 4
    s_lshl_b32 s77, s30, 2
    s_add_u32 s75, s75, s77
    s_add_u32 s75, s75, s65
    v_mov_b32 v24, s76
    v_mov_b32 v26, 0
    s_waitcnt vmcnt(0)
    s_cmp_eq_u32 s36, 0
    s_cbranch_scc0 WS_25
    s_mov_b32 exec_lo, 0x1
    s_mov_b32 exec_hi, 0x0
    buffer_store_dword v24, v26, s[4:7], s75 offen
    s_mov_b64 exec, -1
WT_26:
    s_waitcnt lgkmcnt(0)
    buffer_load_dword v27, v29, s[4:7], s65 offen sc1
    s_add_u32 s75, s42, 0
    s_add_u32 m0, s60, 40960
    s_nop 0
    buffer_load_dwordx4 v1, s[4:7], s75 offen offset:0 lds
    buffer_load_dwordx4 v1, s[4:7], s75 offen offset:1024 lds
    buffer_load_dwordx4 v1, s[4:7], s75 offen offset:2048 lds
    buffer_load_dwordx4 v1, s[4:7], s75 offen offset:3072 lds
    s_add_u32 m0, s60, 45056
    s_add_u32 s75, s75, 4096
    buffer_load_dwordx4 v1, s[4:7], s75 offen lds
    s_add_u32 s75, s42, 20480
    s_add_u32 m0, s60, 61440
    s_nop 0
    buffer_load_dwordx4 v1, s[4:7], s75 offen offset:0 lds
    buffer_load_dwordx4 v1, s[4:7], s75 offen offset:1024 lds
    buffer_load_dwordx4 v1, s[4:7], s75 offen offset:2048 lds
    buffer_load_dwordx4 v1, s[4:7], s75 offen offset:3072 lds
    s_add_u32 m0, s60, 65536
    s_add_u32 s75, s75, 4096
    buffer_load_dwordx4 v1, s[4:7], s75 offen lds
    s_waitcnt vmcnt(10)
    v_subrev_u32 v27, s76, v27
    v_cmp_le_u32 s[84:85], 8, v27
    s_nop 1
    s_cmp_eq_u64 s[84:85], 0
    s_cbranch_scc1 WK_27
    s_mov_b32 s83, 0
WP_28:
    buffer_load_dword v27, v29, s[4:7], s65 offen sc1
    s_add_u32 s83, s83, 1
    s_cmp_gt_u32 s83, 200000
    s_cbranch_scc1 L_END
    s_waitcnt vmcnt(0)
    v_subrev_u32 v27, s76, v27
    v_cmp_le_u32 s[84:85], 8, v27
    s_nop 1
    s_cmp_eq_u64 s[84:85], 0
    s_cbranch_scc0 WP_28
WK_27:
    s_mul_i32 s92, s95, 20480
    s_add_u32 s92, s92, s62
    s_add_u32 s78, s54, s71
    s_add_u32 s78, s78, 327680
    buffer_load_dwordx4 a[160:163], v1, s[4:7], s78 offen offset:0 sc1
    buffer_load_dwordx4 a[164:167], v1, s[4:7], s78 offen offset:1024 sc1
    buffer_load_dwordx4 a[168:171], v1, s[4:7], s78 offen offset:2048 sc1
    buffer_load_dwordx4 a[172:175], v1, s[4:7], s78 offen offset:3072 sc1
    s_add_u32 s78, s78, 4096
    buffer_load_dwordx4 a[176:179], v1, s[4:7], s78 offen offset:0 sc1
    buffer_load_dwordx4 a[180:183], v1, s[4:7], s78 offen offset:1024 sc1
    buffer_load_dwordx4 a[184:187], v1, s[4:7], s78 offen offset:2048 sc1
    buffer_load_dwordx4 a[188:191], v1, s[4:7], s78 offen offset:3072 sc1
    v_lshrrev_b32 v26, 5, v0
    v_bfe_u32 v27, v0, 4, 1
    v_mul_u32_u24 v27, 55296, v27
    v_lshlrev_b32 v26, 8, v26
    v_add_u32 v27, v27, v26
    v_and_b32 v26, 15, v0
    v_lshlrev_b32 v26, 4, v26
    v_add_u32 v132, v27, v26
    s_add_u32 s77, s54, s73
    s_add_u32 s24, s55, s73
    s_barrier
    ds_read_b128 v[88:91], v22 offset:36864
    ds_read_b128 v[92:95], v1 offset:0
    ds_read_b128 v[96:99], v22 offset:37888
    ds_read_b128 v[100:103], v1 offset:1024
    ds_read_b128 v[104:107], v22 offset:38912
    s_add_u32 s78, s78, 4096
    buffer_load_dwordx4 a[192:195], v1, s[4:7], s78 offen offset:0 sc1
    s_waitcnt vmcnt(8)
    s_waitcnt lgkmcnt(4)
    v_mfma_f32_32x32x16_bf16 v[40:55], v[88:91], a[160:163], 0
    ds_read_b128 v[108:111], v1 offset:2048
    s_waitcnt lgkmcnt(4)
    v_mfma_f32_32x32x16_bf16 v[56:71], v[92:95], a[160:163], 0
    ds_read_b128 v[88:91], v22 offset:39936
    buffer_load_dwordx4 a[196:199], v1, s[4:7], s78 offen offset:1024 sc1
    s_waitcnt vmcnt(8)
    s_waitcnt lgkmcnt(4)
    v_mfma_f32_32x32x16_bf16 v[40:55], v[96:99], a[164:167], v[40:55]
    ds_read_b128 v[92:95], v1 offset:3072
    s_waitcnt lgkmcnt(4)
    v_mfma_f32_32x32x16_bf16 v[56:71], v[100:103], a[164:167], v[56:71]
    ds_read_b128 v[96:99], v22 offset:40960
    buffer_load_dwordx4 a[200:203], v1, s[4:7], s78 offen offset:2048 sc1
    s_waitcnt vmcnt(8)
    s_waitcnt lgkmcnt(4)
    v_mfma_f32_32x32x16_bf16 v[40:55], v[104:107], a[168:171], v[40:55]
    ds_read_b128 v[100:103], v1 offset:4096
    s_waitcnt lgkmcnt(4)
    v_mfma_f32_32x32x16_bf16 v[56:71], v[108:111], a[168:171], v[56:71]
    ds_read_b128 v[104:107], v22 offset:41984
    buffer_load_dwordx4 a[204:207], v1, s[4:7], s78 offen offset:3072 sc1
    s_waitcnt vmcnt(8)
    s_waitcnt lgkmcnt(4)
    v_mfma_f32_32x32x16_bf16 v[40:55], v[88:91], a[172:175], v[40:55]
    ds_read_b128 v[108:111], v1 offset:5120
    s_waitcnt lgkmcnt(4)
    v_mfma_f32_32x32x16_bf16 v[56:71], v[92:95], a[172:175], v[56:71]
    ds_read_b128 v[88:91], v22 offset:43008
    s_add_u32 s78, s78, 4096
    buffer_load_dwordx4 a[208:211], v1, s[4:7], s78 offen offset:0 sc1
    s_waitcnt vmcnt(8)
    s_waitcnt lgkmcnt(4)
    v_mfma_f32_32x32x16_bf16 v[40:55], v[96:99], a[176:179], v[40:55]
    ds_read_b128 v[92:95], v1 offset:6144
    s_waitcnt lgkmcnt(4)
    v_mfma_f32_32x32x16_bf16 v[56:71], v[100:103], a[176:179], v[56:71]
    ds_read_b128 v[96:99], v22 offset:44032
    buffer_load_dwordx4 a[212:215], v1, s[4:7], s78 offen offset:1024 sc1
    s_waitcnt vmcnt(8)
    s_waitcnt lgkmcnt(4)
    v_mfma_f32_32x32x16_bf16 v[40:55], v[104:107], a[180:183], v[40:55]
    ds_read_b128 v[100:103], v1 offset:7168
    s_waitcnt lgkmcnt(4)
    v_mfma_f32_32x32x16_bf16 v[56:71], v[108:111], a[180:183], v[56:71]
    ds_read_b128 v[104:107], v22 offset:45056
    buffer_load_dwordx4 a[216:219], v1, s[4:7], s78 offen offset:2048 sc1
    s_waitcnt vmcnt(8)
    s_waitcnt lgkmcnt(4)
    v_mfma_f32_32x32x16_bf16 v[40:55], v[88:91], a[184:187], v[40:55]
    ds_read_b128 v[108:111], v1 offset:8192
    s_waitcnt lgkmcnt(4)
    v_mfma_f32_32x32x16_bf16 v[56:71], v[92:95], a[184:187], v[56:71]
    ds_read_b128 v[88:91], v22 offset:46080
    buffer_load_dwordx4 a[220:223], v1, s[4:7], s78 offen offset:3072 sc1
    s_waitcnt vmcnt(8)
    s_waitcnt lgkmcnt(4)
    v_mfma_f32_32x32x16_bf16 v[40:55], v[96:99], a[188:191], v[40:55]
    ds_read_b128 v[92:95], v1 offset:9216
    s_waitcnt lgkmcnt(4)
    v_mfma_f32_32x32x16_bf16 v[56:71], v[100:103], a[188:191], v[56:71]
    ds_read_b128 v[96:99], v22 offset:47104
    s_add_u32 s78, s78, 4096
    buffer_load_dwordx4 a[224:227], v1, s[4:7], s78 offen offset:0 sc1
    s_waitcnt vmcnt(8)
    s_waitcnt lgkmcnt(4)
    v_mfma_f32_32x32x16_bf16 v[40:55], v[104:107], a[192:195], v[40:55]
    ds_read_b128 v[100:103], v1 offset:10240
    s_waitcnt lgkmcnt(4)
    v_mfma_f32_32x32x16_bf16 v[56:71], v[108:111], a[192:195], v[56:71]
    ds_read_b128 v[104:107], v22 offset:48128
    buffer_load_dwordx4 a[228:231], v1, s[4:7], s78 offen offset:1024 sc1
    s_waitcnt vmcnt(8)
    s_waitcnt lgkmcnt(4)
    v_mfma_f32_32x32x16_bf16 v[40:55], v[88:91], a[196:199], v[40:55]
    ds_read_b128 v[108:111], v1 offset:11264
    s_waitcnt lgkmcnt(4)
    v_mfma_f32_32x32x16_bf16 v[56:71], v[92:95], a[196:199], v[56:71]
    ds_read_b128 v[88:91], v22 offset:49152
    buffer_load_dwordx4 a[232:235], v1, s[4:7], s78 offen offset:2048 sc1
    s_waitcnt vmcnt(8)
    s_waitcnt lgkmcnt(4)
    v_mfma_f32_32x32x16_bf16 v[40:55], v[96:99], a[200:203], v[40:55]
    ds_read_b128 v[92:95], v1 offset:12288
    s_waitcnt lgkmcnt(4)
    v_mfma_f32_32x32x16_bf16 v[56:71], v[100:103], a[200:203], v[56:71]
    ds_read_b128 v[96:99], v22 offset:50176
    buffer_load_dwordx4 a[236:239], v1, s[4:7], s78 offen offset:3072 sc1
    s_waitcnt vmcnt(8)
    s_waitcnt lgkmcnt(4)
    v_mfma_f32_32x32x16_bf16 v[40:55], v[104:107], a[204:207], v[40:55]
    ds_read_b128 v[100:103], v1 offset:13312
    s_waitcnt lgkmcnt(4)
    v_mfma_f32_32x32x16_bf16 v[56:71], v[108:111], a[204:207], v[56:71]
    ds_read_b128 v[104:107], v22 offset:51200
    s_add_u32 s78, s78, 4096
    buffer_load_dwordx4 a[240:243], v1, s[4:7], s78 offen offset:0 sc1
    s_waitcnt vmcnt(8)
    s_waitcnt lgkmcnt(4)
    v_mfma_f32_32x32x16_bf16 v[40:55], v[88:91], a[208:211], v[40:55]
    ds_read_b128 v[108:111], v1 offset:14336
    s_waitcnt lgkmcnt(4)
    v_mfma_f32_32x32x16_bf16 v[56:71], v[92:95], a[208:211], v[56:71]
    ds_read_b128 v[88:91], v22 offset:52224
    buffer_load_dwordx4 a[244:247], v1, s[4:7], s78 offen offset:1024 sc1
    s_waitcnt vmcnt(8)
    s_waitcnt lgkmcnt(4)
    v_mfma_f32_32x32x16_bf16 v[40:55], v[96:99], a[212:215], v[40:55]
    ds_read_b128 v[92:95], v1 offset:15360
    s_waitcnt lgkmcnt(4)
    v_mfma_f32_32x32x16_bf16 v[56:71], v[100:103], a[212:215], v[56:71]
    ds_read_b128 v[96:99], v22 offset:53248
    buffer_load_dwordx4 a[248:251], v1, s[4:7], s78 offen offset:2048 sc1
    s_waitcnt vmcnt(8)
    s_waitcnt lgkmcnt(4)
    v_mfma_f32_32x32x16_bf16 v[40:55], v[104:107], a[216:219], v[40:55]
    ds_read_b128 v[100:103], v1 offset:16384
    v_and_b32 v24, 31, v0
    v_lshlrev_b32 v24, 3, v24
    s_add_u32 s76, s54, s72
    s_add_u32 s76, s76, 1540096
    s_waitcnt lgkmcnt(4)
    v_mfma_f32_32x32x16_bf16 v[56:71], v[108:111], a[216:219], v[56:71]
    ds_read_b128 v[104:107], v22 offset:54272
    buffer_load_dwordx2 v[144:145], v24, s[4:7], s76 offen offset:0 sc1
    buffer_load_dwordx4 a[252:255], v1, s[4:7], s78 offen offset:3072 sc1
    s_waitcnt vmcnt(9)
    s_waitcnt lgkmcnt(4)
    v_mfma_f32_32x32x16_bf16 v[40:55], v[88:91], a[220:223], v[40:55]
    ds_read_b128 v[108:111], v1 offset:17408
    s_waitcnt lgkmcnt(4)
    v_mfma_f32_32x32x16_bf16 v[56:71], v[92:95], a[220:223], v[56:71]
    ds_read_b128 v[88:91], v22 offset:55296
    buffer_load_dwordx2 v[146:147], v24, s[4:7], s76 offen offset:2048 sc1
    s_add_u32 s76, s76, 4096
    s_add_u32 s78, s78, 4096
    buffer_load_dwordx4 v[192:195], v1, s[4:7], s78 offen offset:0 sc1
    s_waitcnt vmcnt(10)
    s_waitcnt lgkmcnt(4)
    v_mfma_f32_32x32x16_bf16 v[40:55], v[96:99], a[224:227], v[40:55]
    ds_read_b128 v[92:95], v1 offset:18432
    s_waitcnt lgkmcnt(4)
    v_mfma_f32_32x32x16_bf16 v[56:71], v[100:103], a[224:227], v[56:71]
    ds_read_b128 v[96:99], v22 offset:56320
    buffer_load_dwordx2 v[148:149], v24, s[4:7], s76 offen offset:0 sc1
    buffer_load_dwordx4 v[196:199], v1, s[4:7], s78 offen offset:1024 sc1
    s_waitcnt vmcnt(11)
    s_waitcnt lgkmcnt(4)
    v_mfma_f32_32x32x16_bf16 v[40:55], v[104:107], a[228:231], v[40:55]
    ds_read_b128 v[100:103], v1 offset:19456
    s_waitcnt lgkmcnt(4)
    v_mfma_f32_32x32x16_bf16 v[56:71], v[108:111], a[228:231], v[56:71]
    s_barrier
    ds_read_b128 v[104:107], v22 offset:57344
    buffer_load_dwordx2 v[150:151], v24, s[4:7], s76 offen offset:2048 sc1
    s_add_u32 s76, s76, 4096
    buffer_load_dwordx4 v[200:203], v1, s[4:7], s78 offen offset:2048 sc1
    s_waitcnt vmcnt(12)
    s_waitcnt lgkmcnt(4)
    v_mfma_f32_32x32x16_bf16 v[40:55], v[88:91], a[232:235], v[40:55]
    ds_read_b128 v[108:111], v1 offset:20480
    s_waitcnt lgkmcnt(4)
    v_mfma_f32_32x32x16_bf16 v[56:71], v[92:95], a[232:235], v[56:71]
    ds_read_b128 v[88:91], v22 offset:58368
    buffer_load_dwordx2 v[152:153], v24, s[4:7], s76 offen offset:0 sc1
    buffer_load_dwordx4 v[204:207], v1, s[4:7], s78 offen offset:3072 sc1
    s_waitcnt vmcnt(13)
    s_waitcnt lgkmcnt(4)
    v_mfma_f32_32x32x16_bf16 v[40:55], v[96:99], a[236:239], v[40:55]
    ds_read_b128 v[92:95], v1 offset:21504
    s_waitcnt lgkmcnt(4)
    v_mfma_f32_32x32x16_bf16 v[56:71], v[100:103], a[236:239], v[56:71]
    ds_read_b128 v[96:99], v22 offset:59392
    buffer_load_dwordx2 v[154:155], v24, s[4:7], s76 offen offset:2048 sc1
    s_add_u32 s76, s76, 4096
    s_add_u32 s78, s78, 4096
    buffer_load_dwordx4 v[208:211], v1, s[4:7], s78 offen offset:0 sc1
    s_waitcnt vmcnt(14)
    s_waitcnt lgkmcnt(4)
    v_mfma_f32_32x32x16_bf16 v[40:55], v[104:107], a[240:243], v[40:55]
    ds_read_b128 v[100:103], v1 offset:22528
    s_waitcnt lgkmcnt(4)
    v_mfma_f32_32x32x16_bf16 v[56:71], v[108:111], a[240:243], v[56:71]
    ds_read_b128 v[104:107], v22 offset:60416
    buffer_load_dwordx2 v[156:157], v24, s[4:7], s76 offen offset:0 sc1
    buffer_load_dwordx4 v[212:215], v1, s[4:7], s78 offen offset:1024 sc1
    s_waitcnt vmcnt(15)
    s_waitcnt lgkmcnt(4)
    v_mfma_f32_32x32x16_bf16 v[40:55], v[88:91], a[244:247], v[40:55]
    ds_read_b128 v[108:111], v1 offset:23552
    s_waitcnt lgkmcnt(4)
    v_mfma_f32_32x32x16_bf16 v[56:71], v[92:95], a[244:247], v[56:71]
    ds_read_b128 v[88:91], v22 offset:61440
    buffer_load_dwordx2 v[158:159], v24, s[4:7], s76 offen offset:2048 sc1
    buffer_load_dwordx4 v[216:219], v1, s[4:7], s78 offen offset:2048 sc1
    s_waitcnt vmcnt(16)
    s_waitcnt lgkmcnt(4)
    v_mfma_f32_32x32x16_bf16 v[40:55], v[96:99], a[248:251], v[40:55]
    ds_read_b128 v[92:95], v1 offset:24576
    s_waitcnt lgkmcnt(4)
    v_mfma_f32_32x32x16_bf16 v[56:71], v[100:103], a[248:251], v[56:71]
    ds_read_b128 v[96:99], v22 offset:62464
    buffer_load_dwordx4 v[220:223], v1, s[4:7], s78 offen offset:3072 sc1
    s_waitcnt vmcnt(15)
    s_waitcnt lgkmcnt(4)
    v_mfma_f32_32x32x16_bf16 v[40:55], v[104:107], a[252:255], v[40:55]
    ds_read_b128 v[100:103], v1 offset:25600
    s_waitcnt lgkmcnt(4)
    v_mfma_f32_32x32x16_bf16 v[56:71], v[108:111], a[252:255], v[56:71]
    ds_read_b128 v[104:107], v22 offset:63488
    s_add_u32 s78, s78, 4096
    buffer_load_dwordx4 v[224:227], v1, s[4:7], s78 offen offset:0 sc1
    s_waitcnt vmcnt(14)
    s_waitcnt lgkmcnt(4)
    v_mfma_f32_32x32x16_bf16 v[40:55], v[88:91], v[192:195], v[40:55]
    ds_read_b128 v[108:111], v1 offset:26624
    s_waitcnt lgkmcnt(4)
    v_mfma_f32_32x32x16_bf16 v[56:71], v[92:95], v[192:195], v[56:71]
    ds_read_b128 v[88:91], v22 offset:64512
    buffer_load_dwordx4 v[228:231], v1, s[4:7], s78 offen offset:1024 sc1
    s_waitcnt vmcnt(13)
    s_waitcnt lgkmcnt(4)
    v_mfma_f32_32x32x16_bf16 v[40:55], v[96:99], v[196:199], v[40:55]
    ds_read_b128 v[92:95], v1 offset:27648
    s_waitcnt lgkmcnt(4)
    v_mfma_f32_32x32x16_bf16 v[56:71], v[100:103], v[196:199], v[56:71]
    ds_read_b128 v[96:99], v23 offset:0
    buffer_load_dwordx4 v[232:235], v1, s[4:7], s78 offen offset:2048 sc1
    s_waitcnt vmcnt(12)
    s_waitcnt lgkmcnt(4)
    v_mfma_f32_32x32x16_bf16 v[40:55], v[104:107], v[200:203], v[40:55]
    ds_read_b128 v[100:103], v1 offset:28672
    s_waitcnt lgkmcnt(4)
    v_mfma_f32_32x32x16_bf16 v[56:71], v[108:111], v[200:203], v[56:71]
    ds_read_b128 v[104:107], v23 offset:1024
    buffer_load_dwordx4 v[236:239], v1, s[4:7], s78 offen offset:3072 sc1
    s_waitcnt vmcnt(11)
    s_waitcnt lgkmcnt(4)
    v_mfma_f32_32x32x16_bf16 v[40:55], v[88:91], v[204:207], v[40:55]
    ds_read_b128 v[108:111], v1 offset:29696
    s_waitcnt lgkmcnt(4)
    v_mfma_f32_32x32x16_bf16 v[56:71], v[92:95], v[204:207], v[56:71]
    ds_read_b128 v[88:91], v23 offset:2048
    s_add_u32 s78, s78, 4096
    buffer_load_dwordx4 v[240:243], v1, s[4:7], s78 offen offset:0 sc1
    s_waitcnt vmcnt(10)
    s_waitcnt vmcnt(7)
    s_waitcnt lgkmcnt(4)
    v_mfma_f32_32x32x16_bf16 v[40:55], v[96:99], v[208:211], v[40:55]
    ds_read_b128 v[92:95], v1 offset:30720
    v_add_f32 v144, v144, v146
    v_add_f32 v145, v145, v147
    v_add_f32 v144, v144, v148
    v_add_f32 v145, v145, v149
    s_waitcnt lgkmcnt(4)
    v_mfma_f32_32x32x16_bf16 v[56:71], v[100:103], v[208:211], v[56:71]
    ds_read_b128 v[96:99], v23 offset:3072
    v_add_f32 v144, v144, v150
    v_add_f32 v145, v145, v151
    v_add_f32 v152, v152, v154
    v_add_f32 v153, v153, v155
    buffer_load_dwordx4 v[244:247], v1, s[4:7], s78 offen offset:1024 sc1
    s_waitcnt lgkmcnt(4)
    v_mfma_f32_32x32x16_bf16 v[40:55], v[104:107], v[212:215], v[40:55]
    ds_read_b128 v[100:103], v1 offset:31744
    v_add_f32 v152, v152, v156
    v_add_f32 v153, v153, v157
    v_add_f32 v152, v152, v158
    v_add_f32 v153, v153, v159
    s_waitcnt lgkmcnt(4)
    v_mfma_f32_32x32x16_bf16 v[56:71], v[108:111], v[212:215], v[56:71]
    ds_read_b128 v[104:107], v23 offset:4096
    v_add_f32 v144, v144, v152
    v_add_f32 v145, v145, v153
    v_mul_f32 v144, 0x3acccccd, v144
    v_mul_f32 v145, 0x3acccccd, v145
    buffer_load_dwordx4 v[248:251], v1, s[4:7], s78 offen offset:2048 sc1
    s_waitcnt vmcnt(8)
    s_waitcnt lgkmcnt(4)
    v_mfma_f32_32x32x16_bf16 v[40:55], v[88:91], v[216:219], v[40:55]
    ds_read_b128 v[108:111], v1 offset:32768
    v_fma_f32 v145, -v144, v144, v145
    v_max_f32 v145, 0, v145
    v_cvt_pk_bf16_f32 v146, v144, v145
    v_lshlrev_b32 v144, 16, v146
    s_waitcnt lgkmcnt(4)
    v_mfma_f32_32x32x16_bf16 v[56:71], v[92:95], v[216:219], v[56:71]
    ds_read_b128 v[88:91], v23 offset:5120
    v_and_b32 v145, 0xffff0000, v146
    v_add_f32 v145, 0x3727c5ac, v145
    v_cvt_pk_bf16_f32 v146, v145, v145
    v_and_b32 v145, 0xffff0000, v146
    buffer_load_dwordx4 v[252:255], v1, s[4:7], s78 offen offset:3072 sc1
    s_waitcnt vmcnt(8)
    s_waitcnt lgkmcnt(4)
    v_mfma_f32_32x32x16_bf16 v[40:55], v[96:99], v[220:223], v[40:55]
    ds_read_b128 v[92:95], v1 offset:33792
    v_sqrt_f32 v145, v145
    s_nop 0
    v_cvt_pk_bf16_f32 v146, v145, v145
    v_and_b32 v145, 0xffff0000, v146
    v_rcp_f32 v145, v145
    s_waitcnt lgkmcnt(4)
    v_mfma_f32_32x32x16_bf16 v[56:71], v[100:103], v[220:223], v[56:71]
    ds_read_b128 v[96:99], v23 offset:6144
    v_xor_b32 v144, 0x80000000, v144
    v_mul_f32 v116, 0xc0135761, v145
    v_mul_f32 v146, v145, v145
    v_mul_f32 v117, v146, v145
    s_waitcnt vmcnt(7)
    s_waitcnt lgkmcnt(4)
    v_mfma_f32_32x32x16_bf16 v[40:55], v[104:107], v[224:227], v[40:55]
    ds_read_b128 v[100:103], v1 offset:34816
    v_mul_f32 v117, 0xbdd2d3e8, v117
    v_rcp_f32 v118, v146
    v_lshrrev_b32 v147, 16, v144
    v_and_b32 v148, 0xffff0000, v144
    s_waitcnt lgkmcnt(4)
    v_mfma_f32_32x32x16_bf16 v[56:71], v[108:111], v[224:227], v[56:71]
    ds_read_b128 v[104:107], v23 offset:7168
    v_or_b32 v148, v148, v147
    v_cmp_gt_u32 vcc, 32, v0
    v_mov_b32 v114, 0
    v_mov_b32 v115, 0
    s_waitcnt vmcnt(6)
    s_waitcnt lgkmcnt(4)
    v_mfma_f32_32x32x16_bf16 v[40:55], v[88:91], v[228:231], v[40:55]
    ds_read_b128 v[108:111], v1 offset:35840
    s_barrier
    s_add_u32 s75, s43, 0
    s_add_u32 m0, s60, 81920
    s_nop 0
    buffer_load_dwordx4 v1, s[4:7], s75 offen offset:0 lds
    v_cndmask_b32 v112, 0, v148, vcc
    s_waitcnt lgkmcnt(4)
    v_mfma_f32_32x32x16_bf16 v[56:71], v[92:95], v[228:231], v[56:71]
    ds_read_b128 v[88:91], v23 offset:8192
    v_cndmask_b32 v113, 0, v147, vcc
    s_waitcnt vmcnt(6)
    s_waitcnt lgkmcnt(4)
    v_mfma_f32_32x32x16_bf16 v[40:55], v[96:99], v[232:235], v[40:55]
    ds_read_b128 v[92:95], v1 offset:36864
    buffer_load_dwordx4 v1, s[4:7], s75 offen offset:1024 lds
    s_waitcnt lgkmcnt(4)
    v_mfma_f32_32x32x16_bf16 v[56:71], v[100:103], v[232:235], v[56:71]
    ds_read_b128 v[96:99], v23 offset:9216
    s_waitcnt vmcnt(6)
    s_waitcnt lgkmcnt(4)
    v_mfma_f32_32x32x16_bf16 v[40:55], v[104:107], v[236:239], v[40:55]
    ds_read_b128 v[100:103], v1 offset:37888
    buffer_load_dwordx4 v1, s[4:7], s75 offen offset:2048 lds
    s_waitcnt lgkmcnt(4)
    v_mfma_f32_32x32x16_bf16 v[56:71], v[108:111], v[236:239], v[56:71]
    ds_read_b128 v[104:107], v23 offset:10240
    s_waitcnt vmcnt(6)
    s_waitcnt lgkmcnt(4)
    v_mfma_f32_32x32x16_bf16 v[40:55], v[88:91], v[240:243], v[40:55]
    ds_read_b128 v[108:111], v1 offset:38912
    buffer_load_dwordx4 v1, s[4:7], s75 offen offset:3072 lds
    s_add_u32 m0, s60, 86016
    s_add_u32 s75, s75, 4096
    s_waitcnt lgkmcnt(4)
    v_mfma_f32_32x32x16_bf16 v[56:71], v[92:95], v[240:243], v[56:71]
    ds_read_b128 v[88:91], v23 offset:11264
    s_waitcnt vmcnt(6)
    s_waitcnt lgkmcnt(4)
    v_mfma_f32_32x32x16_bf16 v[40:55], v[96:99], v[244:247], v[40:55]
    ds_read_b128 v[92:95], v1 offset:39936
    buffer_load_dwordx4 v1, s[4:7], s75 offen lds
    s_add_u32 s75, s43, 20480
    s_add_u32 m0, s60, 102400
    s_waitcnt lgkmcnt(4)
    v_mfma_f32_32x32x16_bf16 v[56:71], v[100:103], v[244:247], v[56:71]
    ds_read_b128 v[96:99], v23 offset:12288
    s_waitcnt vmcnt(6)
    s_waitcnt lgkmcnt(4)
    v_mfma_f32_32x32x16_bf16 v[40:55], v[104:107], v[248:251], v[40:55]
    ds_read_b128 v[100:103], v23 offset:13312
    buffer_load_dwordx4 v1, s[4:7], s75 offen offset:0 lds
    s_waitcnt lgkmcnt(4)
    v_mfma_f32_32x32x16_bf16 v[56:71], v[108:111], v[248:251], v[56:71]
    s_barrier
    ds_read_b128 v[104:107], v1 offset:40960
    s_waitcnt vmcnt(6)
    s_waitcnt lgkmcnt(4)
    v_mfma_f32_32x32x16_bf16 v[40:55], v[88:91], v[252:255], v[40:55]
    ds_read_b128 v[108:111], v1 offset:41984
    buffer_load_dwordx4 v1, s[4:7], s75 offen offset:1024 lds
    s_waitcnt lgkmcnt(4)
    v_mfma_f32_32x32x16_bf16 v[56:71], v[92:95], v[252:255], v[56:71]
    ds_read_b128 v[88:91], v1 offset:43008
    s_waitcnt lgkmcnt(4)
    v_mfma_f32_32x32x16_bf16 v[40:55], v[96:99], v[112:115], v[40:55]
    ds_read_b128 v[92:95], v1 offset:44032
    buffer_load_dwordx4 v1, s[4:7], s75 offen offset:2048 lds
    s_waitcnt lgkmcnt(4)
    v_mfma_f32_32x32x16_bf16 v[56:71], v[100:103], v[112:115], v[56:71]
    ds_read_b128 v[96:99], v1 offset:45056
    s_nop 6
    v_mul_f32 v120, v40, v40
    v_mul_f32 v121, v41, v41
    v_mul_f32 v122, v42, v42
    v_mul_f32 v123, v43, v43
    s_waitcnt lgkmcnt(4)
    v_mfma_f32_32x32x16_bf16 v[72:87], v[104:107], a[160:163], 0
    ds_read_b128 v[100:103], v1 offset:46080
    buffer_load_dwordx4 v1, s[4:7], s75 offen offset:3072 lds
    s_add_u32 m0, s60, 106496
    s_add_u32 s75, s75, 4096
    v_mul_f32 v124, v44, v44
    s_waitcnt lgkmcnt(4)
    v_mfma_f32_32x32x16_bf16 v[72:87], v[108:111], a[164:167], v[72:87]
    ds_read_b128 v[104:107], v1 offset:47104
    v_mul_f32 v125, v45, v45
    v_mul_f32 v126, v46, v46
    v_mul_f32 v127, v47, v47
    v_fma_f32 v120, v120, v117, v116
    s_waitcnt lgkmcnt(4)
    v_mfma_f32_32x32x16_bf16 v[72:87], v[88:91], a[168:171], v[72:87]
    ds_read_b128 v[108:111], v1 offset:48128
    s_barrier
    buffer_load_dwordx4 v1, s[4:7], s75 offen lds
    s_add_u32 s75, s44, 0
    s_add_u32 m0, s60, 122880
    v_fma_f32 v121, v121, v117, v116
    s_waitcnt lgkmcnt(4)
    v_mfma_f32_32x32x16_bf16 v[72:87], v[92:95], a[172:175], v[72:87]
    ds_read_b128 v[88:91], v1 offset:49152
    v_fma_f32 v122, v122, v117, v116
    v_fma_f32 v123, v123, v117, v116
    v_fma_f32 v124, v124, v117, v116
    v_fma_f32 v125, v125, v117, v116
    s_waitcnt lgkmcnt(4)
    v_mfma_f32_32x32x16_bf16 v[72:87], v[96:99], a[176:179], v[72:87]
    ds_read_b128 v[92:95], v1 offset:50176
    buffer_load_dwordx4 v1, s[4:7], s75 offen offset:0 lds
    v_fma_f32 v126, v126, v117, v116
    v_fma_f32 v127, v127, v117, v116
    v_mul_f32 v120, v120, v40
    s_waitcnt lgkmcnt(4)
    v_mfma_f32_32x32x16_bf16 v[72:87], v[100:103], a[180:183], v[72:87]
    ds_read_b128 v[96:99], v1 offset:51200
    v_mul_f32 v121, v121, v41
    v_mul_f32 v122, v122, v42
    v_mul_f32 v123, v123, v43
    v_mul_f32 v124, v124, v44
    s_waitcnt lgkmcnt(4)
    v_mfma_f32_32x32x16_bf16 v[72:87], v[104:107], a[184:187], v[72:87]
    ds_read_b128 v[100:103], v1 offset:52224
    buffer_load_dwordx4 v1, s[4:7], s75 offen offset:1024 lds
    v_mul_f32 v125, v125, v45
    v_mul_f32 v126, v126, v46
    v_mul_f32 v127, v127, v47
    s_waitcnt lgkmcnt(4)
    v_mfma_f32_32x32x16_bf16 v[72:87], v[108:111], a[188:191], v[72:87]
    ds_read_b128 v[104:107], v1 offset:53248
    v_exp_f32 v120, v120
    v_exp_f32 v121, v121
    s_waitcnt lgkmcnt(4)
    v_mfma_f32_32x32x16_bf16 v[72:87], v[88:91], a[192:195], v[72:87]
    ds_read_b128 v[108:111], v1 offset:54272
    buffer_load_dwordx4 v1, s[4:7], s75 offen offset:2048 lds
    v_exp_f32 v122, v122
    s_waitcnt lgkmcnt(4)
    v_mfma_f32_32x32x16_bf16 v[72:87], v[92:95], a[196:199], v[72:87]
    ds_read_b128 v[88:91], v1 offset:55296
    v_exp_f32 v123, v123
    v_exp_f32 v124, v124
    s_waitcnt lgkmcnt(4)
    v_mfma_f32_32x32x16_bf16 v[72:87], v[96:99], a[200:203], v[72:87]
    ds_read_b128 v[92:95], v1 offset:56320
    buffer_load_dwordx4 v1, s[4:7], s75 offen offset:3072 lds
    s_add_u32 m0, s60, 126976
    s_add_u32 s75, s75, 4096
    s_waitcnt lgkmcnt(4)
    v_mfma_f32_32x32x16_bf16 v[72:87], v[100:103], a[204:207], v[72:87]
    ds_read_b128 v[96:99], v1 offset:57344
    v_exp_f32 v125, v125
    v_exp_f32 v126, v126
    s_waitcnt lgkmcnt(4)
    v_mfma_f32_32x32x16_bf16 v[72:87], v[104:107], a[208:211], v[72:87]
    ds_read_b128 v[100:103], v1 offset:58368
    buffer_load_dwordx4 v1, s[4:7], s75 offen lds
    s_add_u32 s75, s44, 20480
    s_add_u32 m0, s60, 0
    s_waitcnt lgkmcnt(4)
    v_mfma_f32_32x32x16_bf16 v[72:87], v[108:111], a[212:215], v[72:87]
    ds_read_b128 v[104:107], v1 offset:59392
    v_exp_f32 v127, v127
    v_mul_f32 v48, v48, v40
    v_mul_f32 v49, v49, v41
    s_waitcnt lgkmcnt(4)
    v_mfma_f32_32x32x16_bf16 v[72:87], v[88:91], a[216:219], v[72:87]
    ds_read_b128 v[108:111], v1 offset:60416
    buffer_load_dwordx4 v1, s[4:7], s75 offen offset:0 lds
    v_mul_f32 v50, v50, v42
    v_mul_f32 v51, v51, v43
    v_mul_f32 v52, v52, v44
    s_waitcnt lgkmcnt(4)
    v_mfma_f32_32x32x16_bf16 v[72:87], v[92:95], a[220:223], v[72:87]
    ds_read_b128 v[88:91], v1 offset:61440
    v_mul_f32 v53, v53, v45
    v_mul_f32 v54, v54, v46
    v_mul_f32 v55, v55, v47
    v_fma_f32 v120, v120, v118, v118
    s_waitcnt lgkmcnt(4)
    v_mfma_f32_32x32x16_bf16 v[72:87], v[96:99], a[224:227], v[72:87]
    ds_read_b128 v[92:95], v1 offset:62464
    buffer_load_dwordx4 v1, s[4:7], s75 offen offset:1024 lds
    v_fma_f32 v121, v121, v118, v118
    v_fma_f32 v122, v122, v118, v118
    v_fma_f32 v123, v123, v118, v118
    s_waitcnt lgkmcnt(4)
    v_mfma_f32_32x32x16_bf16 v[72:87], v[100:103], a[228:231], v[72:87]
    ds_read_b128 v[96:99], v1 offset:63488
    v_fma_f32 v124, v124, v118, v118
    v_fma_f32 v125, v125, v118, v118
    v_fma_f32 v126, v126, v118, v118
    v_fma_f32 v127, v127, v118, v118
    s_waitcnt lgkmcnt(4)
    v_mfma_f32_32x32x16_bf16 v[72:87], v[104:107], a[232:235], v[72:87]
    ds_read_b128 v[100:103], v1 offset:64512
    buffer_load_dwordx4 v1, s[4:7], s75 offen offset:2048 lds
    v_rcp_f32 v120, v120
    s_waitcnt lgkmcnt(4)
    v_mfma_f32_32x32x16_bf16 v[72:87], v[108:111], a[236:239], v[72:87]
    ds_read_b128 v[104:107], v22 offset:0
    v_rcp_f32 v121, v121
    v_rcp_f32 v122, v122
    s_waitcnt lgkmcnt(4)
    v_mfma_f32_32x32x16_bf16 v[72:87], v[88:91], a[240:243], v[72:87]
    ds_read_b128 v[108:111], v22 offset:1024
    buffer_load_dwordx4 v1, s[4:7], s75 offen offset:3072 lds
    s_add_u32 m0, s60, 4096
    s_add_u32 s75, s75, 4096
    s_waitcnt lgkmcnt(4)
    v_mfma_f32_32x32x16_bf16 v[72:87], v[92:95], a[244:247], v[72:87]
    ds_read_b128 v[88:91], v22 offset:2048
    v_rcp_f32 v123, v123
    v_rcp_f32 v124, v124
    s_waitcnt lgkmcnt(4)
    v_mfma_f32_32x32x16_bf16 v[72:87], v[96:99], a[248:251], v[72:87]
    ds_read_b128 v[92:95], v22 offset:3072
    buffer_load_dwordx4 v1, s[4:7], s75 offen lds
    s_add_u32 s75, s45, 0
    s_add_u32 m0, s60, 20480
    s_waitcnt lgkmcnt(4)
    v_mfma_f32_32x32x16_bf16 v[72:87], v[100:103], a[252:255], v[72:87]
    ds_read_b128 v[96:99], v22 offset:4096
    v_rcp_f32 v125, v125
    v_rcp_f32 v126, v126
    s_waitcnt lgkmcnt(4)
    v_mfma_f32_32x32x16_bf16 v[72:87], v[104:107], v[192:195], v[72:87]
    ds_read_b128 v[100:103], v22 offset:5120
    buffer_load_dwordx4 v1, s[4:7], s75 offen offset:0 lds
    v_rcp_f32 v127, v127
    v_mul_f32 v48, v48, v120
    s_waitcnt lgkmcnt(4)
    v_mfma_f32_32x32x16_bf16 v[72:87], v[108:111], v[196:199], v[72:87]
    ds_read_b128 v[104:107], v22 offset:6144
    v_mul_f32 v49, v49, v121
    v_mul_f32 v50, v50, v122
    v_mul_f32 v51, v51, v123
    v_mul_f32 v52, v52, v124
    s_waitcnt lgkmcnt(4)
    v_mfma_f32_32x32x16_bf16 v[72:87], v[88:91], v[200:203], v[72:87]
    ds_read_b128 v[108:111], v22 offset:7168
    buffer_load_dwordx4 v1, s[4:7], s75 offen offset:1024 lds
    v_mul_f32 v53, v53, v125
    v_mul_f32 v54, v54, v126
    v_mul_f32 v55, v55, v127
    s_waitcnt lgkmcnt(4)
    v_mfma_f32_32x32x16_bf16 v[72:87], v[92:95], v[204:207], v[72:87]
    ds_read_b128 v[88:91], v22 offset:8192
    v_cvt_pk_bf16_f32 v128, v48, v49
    v_cvt_pk_bf16_f32 v129, v50, v51
    v_cvt_pk_bf16_f32 v130, v52, v53
    v_cvt_pk_bf16_f32 v131, v54, v55
    s_waitcnt lgkmcnt(4)
    v_mfma_f32_32x32x16_bf16 v[72:87], v[96:99], v[208:211], v[72:87]
    ds_read_b128 v[92:95], v22 offset:9216
    buffer_load_dwordx4 v1, s[4:7], s75 offen offset:2048 lds
    v_mul_f32 v120, v56, v56
    v_mul_f32 v121, v57, v57
    v_mul_f32 v122, v58, v58
    s_waitcnt lgkmcnt(4)
    v_mfma_f32_32x32x16_bf16 v[72:87], v[100:103], v[212:215], v[72:87]
    ds_read_b128 v[96:99], v22 offset:10240
    v_mul_f32 v123, v59, v59
    v_mul_f32 v124, v60, v60
    v_mul_f32 v125, v61, v61
    v_mul_f32 v126, v62, v62
    s_waitcnt lgkmcnt(4)
    v_mfma_f32_32x32x16_bf16 v[72:87], v[104:107], v[216:219], v[72:87]
    ds_read_b128 v[100:103], v22 offset:11264
    buffer_load_dwordx4 v1, s[4:7], s75 offen offset:3072 lds
    s_add_u32 m0, s60, 24576
    s_add_u32 s75, s75, 4096
    v_mul_f32 v127, v63, v63
    s_waitcnt lgkmcnt(4)
    v_mfma_f32_32x32x16_bf16 v[72:87], v[108:111], v[220:223], v[72:87]
    ds_read_b128 v[104:107], v22 offset:12288
    v_fma_f32 v120, v120, v117, v116
    v_fma_f32 v121, v121, v117, v116
    v_fma_f32 v122, v122, v117, v116
    v_fma_f32 v123, v123, v117, v116
    s_waitcnt lgkmcnt(4)
    v_mfma_f32_32x32x16_bf16 v[72:87], v[88:91], v[224:227], v[72:87]
    ds_read_b128 v[108:111], v22 offset:13312
    buffer_load_dwordx4 v1, s[4:7], s75 offen lds
    s_add_u32 s76, s47, s77
    v_fma_f32 v124, v124, v117, v116
    v_fma_f32 v125, v125, v117, v116
    s_waitcnt lgkmcnt(4)
    v_mfma_f32_32x32x16_bf16 v[72:87], v[92:95], v[228:231], v[72:87]
    ds_read_b128 v[88:91], v22 offset:14336
    v_fma_f32 v126, v126, v117, v116
    v_fma_f32 v127, v127, v117, v116
    v_mul_f32 v120, v120, v56
    v_mul_f32 v121, v121, v57
    s_waitcnt lgkmcnt(4)
    v_mfma_f32_32x32x16_bf16 v[72:87], v[96:99], v[232:235], v[72:87]
    ds_read_b128 v[92:95], v22 offset:15360
    buffer_store_dwordx4 v[128:131], v132, s[4:7], s76 offen
    v_mul_f32 v122, v122, v58
    v_mul_f32 v123, v123, v59
    v_mul_f32 v124, v124, v60
    s_waitcnt lgkmcnt(4)
    v_mfma_f32_32x32x16_bf16 v[72:87], v[100:103], v[236:239], v[72:87]
    ds_read_b128 v[96:99], v23 offset:14336
    v_mul_f32 v125, v125, v61
    v_mul_f32 v126, v126, v62
    v_mul_f32 v127, v127, v63
    s_waitcnt lgkmcnt(4)
    v_mfma_f32_32x32x16_bf16 v[72:87], v[104:107], v[240:243], v[72:87]
    s_waitcnt vmcnt(16)
    s_barrier
    ds_read_b128 v[100:103], v22 offset:16384
    s_add_u32 s75, s45, 20480
    s_add_u32 m0, s60, 40960
    s_nop 0
    buffer_load_dwordx4 v1, s[4:7], s75 offen offset:0 lds
    s_waitcnt lgkmcnt(4)
    v_mfma_f32_32x32x16_bf16 v[72:87], v[108:111], v[244:247], v[72:87]
    ds_read_b128 v[104:107], v22 offset:17408
    v_exp_f32 v120, v120
    v_exp_f32 v121, v121
    s_waitcnt lgkmcnt(4)
    v_mfma_f32_32x32x16_bf16 v[72:87], v[88:91], v[248:251], v[72:87]
    ds_read_b128 v[108:111], v22 offset:18432
    buffer_load_dwordx4 v1, s[4:7], s75 offen offset:1024 lds
    v_exp_f32 v122, v122
    s_waitcnt lgkmcnt(4)
    v_mfma_f32_32x32x16_bf16 v[72:87], v[92:95], v[252:255], v[72:87]
    ds_read_b128 v[88:91], v22 offset:19456
    v_exp_f32 v123, v123
    v_exp_f32 v124, v124
    s_waitcnt lgkmcnt(4)
    v_mfma_f32_32x32x16_bf16 v[72:87], v[96:99], v[112:115], v[72:87]
    ds_read_b128 v[92:95], v22 offset:20480
    buffer_load_dwordx4 v1, s[4:7], s75 offen offset:2048 lds
    v_exp_f32 v125, v125
    s_waitcnt lgkmcnt(4)
    v_mfma_f32_32x32x16_bf16 v[40:55], v[100:103], a[160:163], 0
    ds_read_b128 v[96:99], v22 offset:21504
    v_exp_f32 v126, v126
    v_exp_f32 v127, v127
    s_waitcnt lgkmcnt(4)
    v_mfma_f32_32x32x16_bf16 v[40:55], v[104:107], a[164:167], v[40:55]
    ds_read_b128 v[100:103], v22 offset:22528
    buffer_load_dwordx4 v1, s[4:7], s75 offen offset:3072 lds
    s_add_u32 m0, s60, 45056
    s_add_u32 s75, s75, 4096
    v_mul_f32 v64, v64, v56
    s_waitcnt lgkmcnt(4)
    v_mfma_f32_32x32x16_bf16 v[40:55], v[108:111], a[168:171], v[40:55]
    ds_read_b128 v[104:107], v22 offset:23552
    v_mul_f32 v65, v65, v57
    v_mul_f32 v66, v66, v58
    v_mul_f32 v67, v67, v59
    v_mul_f32 v68, v68, v60
    s_waitcnt lgkmcnt(4)
    v_mfma_f32_32x32x16_bf16 v[40:55], v[88:91], a[172:175], v[40:55]
    ds_read_b128 v[108:111], v22 offset:24576
    buffer_load_dwordx4 v1, s[4:7], s75 offen lds
    v_mul_f32 v69, v69, v61
    v_mul_f32 v70, v70, v62
    v_mul_f32 v71, v71, v63
    s_waitcnt lgkmcnt(4)
    v_mfma_f32_32x32x16_bf16 v[40:55], v[92:95], a[176:179], v[40:55]
    ds_read_b128 v[88:91], v22 offset:25600
    v_fma_f32 v120, v120, v118, v118
    v_fma_f32 v121, v121, v118, v118
    v_fma_f32 v122, v122, v118, v118
    v_fma_f32 v123, v123, v118, v118
    s_waitcnt lgkmcnt(4)
    v_mfma_f32_32x32x16_bf16 v[40:55], v[96:99], a[180:183], v[40:55]
    ds_read_b128 v[92:95], v22 offset:26624
    v_fma_f32 v124, v124, v118, v118
    v_fma_f32 v125, v125, v118, v118
    v_fma_f32 v126, v126, v118, v118
    v_fma_f32 v127, v127, v118, v118
    s_waitcnt lgkmcnt(4)
    v_mfma_f32_32x32x16_bf16 v[40:55], v[100:103], a[184:187], v[40:55]
    ds_read_b128 v[96:99], v22 offset:27648
    v_rcp_f32 v120, v120
    v_rcp_f32 v121, v121
    s_waitcnt lgkmcnt(4)
    v_mfma_f32_32x32x16_bf16 v[40:55], v[104:107], a[188:191], v[40:55]
    ds_read_b128 v[100:103], v22 offset:28672
    v_rcp_f32 v122, v122
    v_rcp_f32 v123, v123
    s_waitcnt lgkmcnt(4)
    v_mfma_f32_32x32x16_bf16 v[40:55], v[108:111], a[192:195], v[40:55]
    ds_read_b128 v[104:107], v22 offset:29696
    v_rcp_f32 v124, v124
    v_rcp_f32 v125, v125
    s_waitcnt lgkmcnt(4)
    v_mfma_f32_32x32x16_bf16 v[40:55], v[88:91], a[196:199], v[40:55]
    ds_read_b128 v[108:111], v22 offset:30720
    v_rcp_f32 v126, v126
    v_rcp_f32 v127, v127
    s_waitcnt lgkmcnt(4)
    v_mfma_f32_32x32x16_bf16 v[40:55], v[92:95], a[200:203], v[40:55]
    ds_read_b128 v[88:91], v22 offset:31744
    v_mul_f32 v64, v64, v120
    v_mul_f32 v65, v65, v121
    v_mul_f32 v66, v66, v122
    v_mul_f32 v67, v67, v123
    s_waitcnt lgkmcnt(4)
    v_mfma_f32_32x32x16_bf16 v[40:55], v[96:99], a[204:207], v[40:55]
    ds_read_b128 v[92:95], v22 offset:32768
    v_mul_f32 v68, v68, v124
    v_mul_f32 v69, v69, v125
    v_mul_f32 v70, v70, v126
    v_mul_f32 v71, v71, v127
    s_waitcnt lgkmcnt(4)
    v_mfma_f32_32x32x16_bf16 v[40:55], v[100:103], a[208:211], v[40:55]
    ds_read_b128 v[96:99], v22 offset:33792
    v_cvt_pk_bf16_f32 v128, v64, v65
    v_cvt_pk_bf16_f32 v129, v66, v67
    v_cvt_pk_bf16_f32 v130, v68, v69
    v_cvt_pk_bf16_f32 v131, v70, v71
    s_waitcnt lgkmcnt(4)
    v_mfma_f32_32x32x16_bf16 v[40:55], v[104:107], a[212:215], v[40:55]
    ds_read_b128 v[100:103], v22 offset:34816
    s_add_u32 s76, s48, s77
    buffer_store_dwordx4 v[128:131], v132, s[4:7], s76 offen
    v_mul_f32 v120, v72, v72
    v_mul_f32 v121, v73, v73
    s_waitcnt lgkmcnt(4)
    v_mfma_f32_32x32x16_bf16 v[40:55], v[108:111], a[216:219], v[40:55]
    ds_read_b128 v[104:107], v22 offset:35840
    v_mul_f32 v122, v74, v74
    v_mul_f32 v123, v75, v75
    v_mul_f32 v124, v76, v76
    v_mul_f32 v125, v77, v77
    s_waitcnt lgkmcnt(4)
    v_mfma_f32_32x32x16_bf16 v[40:55], v[88:91], a[220:223], v[40:55]
    ds_read_b128 v[108:111], v22 offset:36864
    v_mul_f32 v126, v78, v78
    v_mul_f32 v127, v79, v79
    v_fma_f32 v120, v120, v117, v116
    v_fma_f32 v121, v121, v117, v116
    s_waitcnt lgkmcnt(4)
    v_mfma_f32_32x32x16_bf16 v[40:55], v[92:95], a[224:227], v[40:55]
    ds_read_b128 v[88:91], v22 offset:37888
    v_fma_f32 v122, v122, v117, v116
    v_fma_f32 v123, v123, v117, v116
    v_fma_f32 v124, v124, v117, v116
    v_fma_f32 v125, v125, v117, v116
    s_waitcnt lgkmcnt(4)
    v_mfma_f32_32x32x16_bf16 v[40:55], v[96:99], a[228:231], v[40:55]
    ds_read_b128 v[92:95], v22 offset:38912
    v_fma_f32 v126, v126, v117, v116
    v_fma_f32 v127, v127, v117, v116
    v_mul_f32 v120, v120, v72
    v_mul_f32 v121, v121, v73
    s_waitcnt lgkmcnt(4)
    v_mfma_f32_32x32x16_bf16 v[40:55], v[100:103], a[232:235], v[40:55]
    ds_read_b128 v[96:99], v22 offset:39936
    v_mul_f32 v122, v122, v74
    v_mul_f32 v123, v123, v75
    v_mul_f32 v124, v124, v76
    v_mul_f32 v125, v125, v77
    s_waitcnt lgkmcnt(4)
    v_mfma_f32_32x32x16_bf16 v[40:55], v[104:107], a[236:239], v[40:55]
    ds_read_b128 v[100:103], v22 offset:40960
    v_mul_f32 v126, v126, v78
    v_mul_f32 v127, v127, v79
    v_exp_f32 v120, v120
    s_waitcnt lgkmcnt(4)
    v_mfma_f32_32x32x16_bf16 v[40:55], v[108:111], a[240:243], v[40:55]
    ds_read_b128 v[104:107], v22 offset:41984
    v_exp_f32 v121, v121
    v_exp_f32 v122, v122
    s_waitcnt lgkmcnt(4)
    v_mfma_f32_32x32x16_bf16 v[40:55], v[88:91], a[244:247], v[40:55]
    ds_read_b128 v[108:111], v22 offset:43008
    v_exp_f32 v123, v123
    v_exp_f32 v124, v124
    s_waitcnt lgkmcnt(4)
    v_mfma_f32_32x32x16_bf16 v[40:55], v[92:95], a[248:251], v[40:55]
    ds_read_b128 v[88:91], v22 offset:44032
    v_exp_f32 v125, v125
    v_exp_f32 v126, v126
    s_waitcnt lgkmcnt(4)
    v_mfma_f32_32x32x16_bf16 v[40:55], v[96:99], a[252:255], v[40:55]
    ds_read_b128 v[92:95], v22 offset:45056
    v_exp_f32 v127, v127
    v_mul_f32 v80, v80, v72
    v_mul_f32 v81, v81, v73
    s_waitcnt lgkmcnt(4)
    v_mfma_f32_32x32x16_bf16 v[40:55], v[100:103], v[192:195], v[40:55]
    ds_read_b128 v[96:99], v22 offset:46080
    v_mul_f32 v82, v82, v74
    v_mul_f32 v83, v83, v75
    v_mul_f32 v84, v84, v76
    v_mul_f32 v85, v85, v77
    s_waitcnt lgkmcnt(4)
    v_mfma_f32_32x32x16_bf16 v[40:55], v[104:107], v[196:199], v[40:55]
    ds_read_b128 v[100:103], v22 offset:47104
    v_mul_f32 v86, v86, v78
    v_mul_f32 v87, v87, v79
    v_fma_f32 v120, v120, v118, v118
    v_fma_f32 v121, v121, v118, v118
    s_waitcnt lgkmcnt(4)
    v_mfma_f32_32x32x16_bf16 v[40:55], v[108:111], v[200:203], v[40:55]
    ds_read_b128 v[104:107], v22 offset:48128
    v_fma_f32 v122, v122, v118, v118
    v_fma_f32 v123, v123, v118, v118
    v_fma_f32 v124, v124, v118, v118
    v_fma_f32 v125, v125, v118, v118
    s_waitcnt lgkmcnt(4)
    v_mfma_f32_32x32x16_bf16 v[40:55], v[88:91], v[204:207], v[40:55]
    ds_read_b128 v[108:111], v22 offset:49152
    v_fma_f32 v126, v126, v118, v118
    v_fma_f32 v127, v127, v118, v118
    v_rcp_f32 v120, v120
    s_waitcnt lgkmcnt(4)
    v_mfma_f32_32x32x16_bf16 v[40:55], v[92:95], v[208:211], v[40:55]
    ds_read_b128 v[88:91], v22 offset:50176
    v_rcp_f32 v121, v121
    v_rcp_f32 v122, v122
    s_waitcnt lgkmcnt(4)
    v_mfma_f32_32x32x16_bf16 v[40:55], v[96:99], v[212:215], v[40:55]
    ds_read_b128 v[92:95], v22 offset:51200
    v_rcp_f32 v123, v123
    v_rcp_f32 v124, v124
    s_waitcnt lgkmcnt(4)
    v_mfma_f32_32x32x16_bf16 v[40:55], v[100:103], v[216:219], v[40:55]
    ds_read_b128 v[96:99], v22 offset:52224
    v_rcp_f32 v125, v125
    v_rcp_f32 v126, v126
    s_waitcnt lgkmcnt(4)
    v_mfma_f32_32x32x16_bf16 v[40:55], v[104:107], v[220:223], v[40:55]
    ds_read_b128 v[100:103], v22 offset:53248
    v_rcp_f32 v127, v127
    v_mul_f32 v80, v80, v120
    v_mul_f32 v81, v81, v121
    s_waitcnt lgkmcnt(4)
    v_mfma_f32_32x32x16_bf16 v[40:55], v[108:111], v[224:227], v[40:55]
    ds_read_b128 v[104:107], v22 offset:54272
    v_mul_f32 v82, v82, v122
    v_mul_f32 v83, v83, v123
    v_mul_f32 v84, v84, v124
    v_mul_f32 v85, v85, v125
    s_waitcnt lgkmcnt(4)
    v_mfma_f32_32x32x16_bf16 v[40:55], v[88:91], v[228:231], v[40:55]
    ds_read_b128 v[108:111], v22 offset:55296
    v_mul_f32 v86, v86, v126
    v_mul_f32 v87, v87, v127
    v_cvt_pk_bf16_f32 v128, v80, v81
    v_cvt_pk_bf16_f32 v129, v82, v83
    s_waitcnt lgkmcnt(4)
    v_mfma_f32_32x32x16_bf16 v[40:55], v[92:95], v[232:235], v[40:55]
    ds_read_b128 v[88:91], v22 offset:56320
    v_cvt_pk_bf16_f32 v130, v84, v85
    v_cvt_pk_bf16_f32 v131, v86, v87
    s_add_u32 s76, s49, s77
    buffer_store_dwordx4 v[128:131], v132, s[4:7], s76 offen
    s_waitcnt lgkmcnt(4)
    v_mfma_f32_32x32x16_bf16 v[40:55], v[96:99], v[236:239], v[40:55]
    ds_read_b128 v[92:95], v23 offset:15360
    s_waitcnt lgkmcnt(4)
    v_mfma_f32_32x32x16_bf16 v[40:55], v[100:103], v[240:243], v[40:55]
    s_waitcnt vmcnt(13)
    s_barrier
    ds_read_b128 v[96:99], v22 offset:57344
    s_add_u32 s75, s46, 0
    s_add_u32 m0, s60, 61440
    s_nop 0
    buffer_load_dwordx4 v1, s[4:7], s75 offen offset:0 lds
    s_waitcnt lgkmcnt(4)
    v_mfma_f32_32x32x16_bf16 v[40:55], v[104:107], v[244:247], v[40:55]
    ds_read_b128 v[100:103], v22 offset:58368
    s_waitcnt lgkmcnt(4)
    v_mfma_f32_32x32x16_bf16 v[40:55], v[108:111], v[248:251], v[40:55]
    ds_read_b128 v[104:107], v22 offset:59392
    buffer_load_dwordx4 v1, s[4:7], s75 offen offset:1024 lds
    s_waitcnt lgkmcnt(4)
    v_mfma_f32_32x32x16_bf16 v[40:55], v[88:91], v[252:255], v[40:55]
    ds_read_b128 v[108:111], v22 offset:60416
    s_waitcnt lgkmcnt(4)
    v_mfma_f32_32x32x16_bf16 v[40:55], v[92:95], v[112:115], v[40:55]
    ds_read_b128 v[88:91], v22 offset:61440
    buffer_load_dwordx4 v1, s[4:7], s75 offen offset:2048 lds
    s_waitcnt lgkmcnt(4)
    v_mfma_f32_32x32x16_bf16 v[56:71], v[96:99], a[160:163], 0
    ds_read_b128 v[92:95], v22 offset:62464
    s_nop 6
    v_mul_f32 v120, v40, v40
    v_mul_f32 v121, v41, v41
    v_mul_f32 v122, v42, v42
    v_mul_f32 v123, v43, v43
    s_waitcnt lgkmcnt(4)
    v_mfma_f32_32x32x16_bf16 v[56:71], v[100:103], a[164:167], v[56:71]
    ds_read_b128 v[96:99], v22 offset:63488
    buffer_load_dwordx4 v1, s[4:7], s75 offen offset:3072 lds
    s_add_u32 m0, s60, 65536
    s_add_u32 s75, s75, 4096
    v_mul_f32 v124, v44, v44
    s_waitcnt lgkmcnt(4)
    v_mfma_f32_32x32x16_bf16 v[56:71], v[104:107], a[168:171], v[56:71]
    ds_read_b128 v[100:103], v22 offset:64512
    v_mul_f32 v125, v45, v45
    v_mul_f32 v126, v46, v46
    v_mul_f32 v127, v47, v47
    v_fma_f32 v120, v120, v117, v116
    s_waitcnt lgkmcnt(4)
    v_mfma_f32_32x32x16_bf16 v[56:71], v[108:111], a[172:175], v[56:71]
    ds_read_b128 v[104:107], v23 offset:0
    buffer_load_dwordx4 v1, s[4:7], s75 offen lds
    s_add_u32 s75, s46, 20480
    s_add_u32 m0, s60, 81920
    v_fma_f32 v121, v121, v117, v116
    s_waitcnt lgkmcnt(4)
    v_mfma_f32_32x32x16_bf16 v[56:71], v[88:91], a[176:179], v[56:71]
    ds_read_b128 v[108:111], v23 offset:1024
    v_fma_f32 v122, v122, v117, v116
    v_fma_f32 v123, v123, v117, v116
    v_fma_f32 v124, v124, v117, v116
    v_fma_f32 v125, v125, v117, v116
    s_waitcnt lgkmcnt(4)
    v_mfma_f32_32x32x16_bf16 v[56:71], v[92:95], a[180:183], v[56:71]
    ds_read_b128 v[88:91], v23 offset:2048
    buffer_load_dwordx4 v1, s[4:7], s75 offen offset:0 lds
    v_fma_f32 v126, v126, v117, v116
    v_fma_f32 v127, v127, v117, v116
    v_mul_f32 v120, v120, v40
    s_waitcnt lgkmcnt(4)
    v_mfma_f32_32x32x16_bf16 v[56:71], v[96:99], a[184:187], v[56:71]
    ds_read_b128 v[92:95], v23 offset:3072
    v_mul_f32 v121, v121, v41
    v_mul_f32 v122, v122, v42
    v_mul_f32 v123, v123, v43
    v_mul_f32 v124, v124, v44
    s_waitcnt lgkmcnt(4)
    v_mfma_f32_32x32x16_bf16 v[56:71], v[100:103], a[188:191], v[56:71]
    ds_read_b128 v[96:99], v23 offset:4096
    buffer_load_dwordx4 v1, s[4:7], s75 offen offset:1024 lds
    v_mul_f32 v125, v125, v45
    v_mul_f32 v126, v126, v46
    v_mul_f32 v127, v127, v47
    s_waitcnt lgkmcnt(4)
    v_mfma_f32_32x32x16_bf16 v[56:71], v[104:107], a[192:195], v[56:71]
    ds_read_b128 v[100:103], v23 offset:5120
    v_exp_f32 v120, v120
    v_exp_f32 v121, v121
    s_waitcnt lgkmcnt(4)
    v_mfma_f32_32x32x16_bf16 v[56:71], v[108:111], a[196:199], v[56:71]
    ds_read_b128 v[104:107], v23 offset:6144
    buffer_load_dwordx4 v1, s[4:7], s75 offen offset:2048 lds
    v_exp_f32 v122, v122
    s_waitcnt lgkmcnt(4)
    v_mfma_f32_32x32x16_bf16 v[56:71], v[88:91], a[200:203], v[56:71]
    ds_read_b128 v[108:111], v23 offset:7168
    v_exp_f32 v123, v123
    v_exp_f32 v124, v124
    s_waitcnt lgkmcnt(4)
    v_mfma_f32_32x32x16_bf16 v[56:71], v[92:95], a[204:207], v[56:71]
    ds_read_b128 v[88:91], v23 offset:8192
    buffer_load_dwordx4 v1, s[4:7], s75 offen offset:3072 lds
    s_add_u32 m0, s60, 86016
    s_add_u32 s75, s75, 4096
    s_waitcnt lgkmcnt(4)
    v_mfma_f32_32x32x16_bf16 v[56:71], v[96:99], a[208:211], v[56:71]
    ds_read_b128 v[92:95], v23 offset:9216
    v_exp_f32 v125, v125
    v_exp_f32 v126, v126
    s_waitcnt lgkmcnt(4)
    v_mfma_f32_32x32x16_bf16 v[56:71], v[100:103], a[212:215], v[56:71]
    ds_read_b128 v[96:99], v23 offset:10240
    buffer_load_dwordx4 v1, s[4:7], s75 offen lds
    v_exp_f32 v127, v127
    v_mul_f32 v48, v48, v40
    s_waitcnt lgkmcnt(4)
    v_mfma_f32_32x32x16_bf16 v[56:71], v[104:107], a[216:219], v[56:71]
    ds_read_b128 v[100:103], v23 offset:11264
    v_mul_f32 v49, v49, v41
    v_mul_f32 v50, v50, v42
    v_mul_f32 v51, v51, v43
    v_mul_f32 v52, v52, v44
    s_waitcnt lgkmcnt(4)
    v_mfma_f32_32x32x16_bf16 v[56:71], v[108:111], a[220:223], v[56:71]
    ds_read_b128 v[104:107], v1 offset:0
    v_mul_f32 v53, v53, v45
    v_mul_f32 v54, v54, v46
    v_mul_f32 v55, v55, v47
    v_fma_f32 v120, v120, v118, v118
    s_waitcnt lgkmcnt(4)
    v_mfma_f32_32x32x16_bf16 v[56:71], v[88:91], a[224:227], v[56:71]
    ds_read_b128 v[108:111], v1 offset:1024
    v_fma_f32 v121, v121, v118, v118
    v_fma_f32 v122, v122, v118, v118
    v_fma_f32 v123, v123, v118, v118
    v_fma_f32 v124, v124, v118, v118
    s_waitcnt lgkmcnt(4)
    v_mfma_f32_32x32x16_bf16 v[56:71], v[92:95], a[228:231], v[56:71]
    ds_read_b128 v[88:91], v1 offset:2048
    v_fma_f32 v125, v125, v118, v118
    v_fma_f32 v126, v126, v118, v118
    v_fma_f32 v127, v127, v118, v118
    s_waitcnt lgkmcnt(4)
    v_mfma_f32_32x32x16_bf16 v[56:71], v[96:99], a[232:235], v[56:71]
    ds_read_b128 v[92:95], v1 offset:3072
    v_rcp_f32 v120, v120
    v_rcp_f32 v121, v121
    s_waitcnt lgkmcnt(4)
    v_mfma_f32_32x32x16_bf16 v[56:71], v[100:103], a[236:239], v[56:71]
    ds_read_b128 v[96:99], v1 offset:4096
    v_rcp_f32 v122, v122
    v_rcp_f32 v123, v123
    s_waitcnt lgkmcnt(4)
    v_mfma_f32_32x32x16_bf16 v[56:71], v[104:107], a[240:243], v[56:71]
    ds_read_b128 v[100:103], v1 offset:5120
    v_rcp_f32 v124, v124
    v_rcp_f32 v125, v125
    s_waitcnt lgkmcnt(4)
    v_mfma_f32_32x32x16_bf16 v[56:71], v[108:111], a[244:247], v[56:71]
    ds_read_b128 v[104:107], v1 offset:6144
    v_rcp_f32 v126, v126
    v_rcp_f32 v127, v127
    s_waitcnt lgkmcnt(4)
    v_mfma_f32_32x32x16_bf16 v[56:71], v[88:91], a[248:251], v[56:71]
    ds_read_b128 v[108:111], v1 offset:7168
    v_mul_f32 v48, v48, v120
    v_mul_f32 v49, v49, v121
    v_mul_f32 v50, v50, v122
    v_mul_f32 v51, v51, v123
    s_waitcnt lgkmcnt(4)
    v_mfma_f32_32x32x16_bf16 v[56:71], v[92:95], a[252:255], v[56:71]
    ds_read_b128 v[88:91], v1 offset:8192
    v_mul_f32 v52, v52, v124
    v_mul_f32 v53, v53, v125
    v_mul_f32 v54, v54, v126
    v_mul_f32 v55, v55, v127
    s_waitcnt lgkmcnt(4)
    v_mfma_f32_32x32x16_bf16 v[56:71], v[96:99], v[192:195], v[56:71]
    ds_read_b128 v[92:95], v1 offset:9216
    v_cvt_pk_bf16_f32 v128, v48, v49
    v_cvt_pk_bf16_f32 v129, v50, v51
    v_cvt_pk_bf16_f32 v130, v52, v53
    v_cvt_pk_bf16_f32 v131, v54, v55
    s_waitcnt lgkmcnt(4)
    v_mfma_f32_32x32x16_bf16 v[56:71], v[100:103], v[196:199], v[56:71]
    ds_read_b128 v[96:99], v1 offset:10240
    s_add_u32 s76, s50, s77
    buffer_store_dwordx4 v[128:131], v132, s[4:7], s76 offen
    s_waitcnt lgkmcnt(4)
    v_mfma_f32_32x32x16_bf16 v[56:71], v[104:107], v[200:203], v[56:71]
    ds_read_b128 v[100:103], v1 offset:11264
    s_waitcnt lgkmcnt(4)
    v_mfma_f32_32x32x16_bf16 v[56:71], v[108:111], v[204:207], v[56:71]
    ds_read_b128 v[104:107], v1 offset:12288
    s_waitcnt lgkmcnt(4)
    v_mfma_f32_32x32x16_bf16 v[56:71], v[88:91], v[208:211], v[56:71]
    ds_read_b128 v[108:111], v1 offset:13312
    s_waitcnt lgkmcnt(4)
    v_mfma_f32_32x32x16_bf16 v[56:71], v[92:95], v[212:215], v[56:71]
    ds_read_b128 v[88:91], v1 offset:14336
    s_waitcnt lgkmcnt(4)
    v_mfma_f32_32x32x16_bf16 v[56:71], v[96:99], v[216:219], v[56:71]
    ds_read_b128 v[92:95], v1 offset:15360
    s_waitcnt lgkmcnt(4)
    v_mfma_f32_32x32x16_bf16 v[56:71], v[100:103], v[220:223], v[56:71]
    ds_read_b128 v[96:99], v1 offset:16384
    s_waitcnt lgkmcnt(4)
    v_mfma_f32_32x32x16_bf16 v[56:71], v[104:107], v[224:227], v[56:71]
    ds_read_b128 v[100:103], v1 offset:17408
    s_waitcnt lgkmcnt(4)
    v_mfma_f32_32x32x16_bf16 v[56:71], v[108:111], v[228:231], v[56:71]
    ds_read_b128 v[104:107], v1 offset:18432
    s_waitcnt lgkmcnt(4)
    v_mfma_f32_32x32x16_bf16 v[56:71], v[88:91], v[232:235], v[56:71]
    ds_read_b128 v[108:111], v1 offset:19456
    s_waitcnt lgkmcnt(4)
    v_mfma_f32_32x32x16_bf16 v[56:71], v[92:95], v[236:239], v[56:71]
    ds_read_b128 v[88:91], v23 offset:16384
    s_waitcnt lgkmcnt(4)
    v_mfma_f32_32x32x16_bf16 v[56:71], v[96:99], v[240:243], v[56:71]
    s_waitcnt vmcnt(13)
    s_barrier
    ds_read_b128 v[92:95], v1 offset:20480
    s_cmp_eq_u32 s92, s94
    s_cselect_b32 s75, s63, s92
    s_add_u32 s92, s92, 20480
    s_cmp_eq_u32 s92, s93
    s_waitcnt lgkmcnt(4)
    v_mfma_f32_32x32x16_bf16 v[56:71], v[100:103], v[244:247], v[56:71]
    ds_read_b128 v[96:99], v1 offset:21504
    s_cselect_b32 s92, s62, s92
    s_add_u32 m0, s60, 102400
    s_nop 0
    buffer_load_dwordx4 v1, s[4:7], s75 offen offset:0 lds
    s_waitcnt lgkmcnt(4)
    v_mfma_f32_32x32x16_bf16 v[56:71], v[104:107], v[248:251], v[56:71]
    ds_read_b128 v[100:103], v1 offset:22528
    s_waitcnt lgkmcnt(4)
    v_mfma_f32_32x32x16_bf16 v[56:71], v[108:111], v[252:255], v[56:71]
    ds_read_b128 v[104:107], v1 offset:23552
    buffer_load_dwordx4 v1, s[4:7], s75 offen offset:1024 lds
    s_waitcnt lgkmcnt(4)
    v_mfma_f32_32x32x16_bf16 v[56:71], v[88:91], v[112:115], v[56:71]
    ds_read_b128 v[108:111], v1 offset:24576
    s_waitcnt lgkmcnt(4)
    v_mfma_f32_32x32x16_bf16 v[72:87], v[92:95], a[160:163], 0
    ds_read_b128 v[88:91], v1 offset:25600
    buffer_load_dwordx4 v1, s[4:7], s75 offen offset:2048 lds
    s_nop 6
    v_mul_f32 v120, v56, v56
    v_mul_f32 v121, v57, v57
    v_mul_f32 v122, v58, v58
    s_waitcnt lgkmcnt(4)
    v_mfma_f32_32x32x16_bf16 v[72:87], v[96:99], a[164:167], v[72:87]
    ds_read_b128 v[92:95], v1 offset:26624
    v_mul_f32 v123, v59, v59
    v_mul_f32 v124, v60, v60
    v_mul_f32 v125, v61, v61
    v_mul_f32 v126, v62, v62
    s_waitcnt lgkmcnt(4)
    v_mfma_f32_32x32x16_bf16 v[72:87], v[100:103], a[168:171], v[72:87]
    ds_read_b128 v[96:99], v1 offset:27648
    buffer_load_dwordx4 v1, s[4:7], s75 offen offset:3072 lds
    s_add_u32 m0, s60, 106496
    s_add_u32 s75, s75, 4096
    v_mul_f32 v127, v63, v63
    s_waitcnt lgkmcnt(4)
    v_mfma_f32_32x32x16_bf16 v[72:87], v[104:107], a[172:175], v[72:87]
    ds_read_b128 v[100:103], v1 offset:28672
    v_fma_f32 v120, v120, v117, v116
    v_fma_f32 v121, v121, v117, v116
    v_fma_f32 v122, v122, v117, v116
    v_fma_f32 v123, v123, v117, v116
    s_waitcnt lgkmcnt(4)
    v_mfma_f32_32x32x16_bf16 v[72:87], v[108:111], a[176:179], v[72:87]
    ds_read_b128 v[104:107], v1 offset:29696
    buffer_load_dwordx4 v1, s[4:7], s75 offen lds
    s_cmp_eq_u32 s92, s94
    s_cselect_b32 s75, s63, s92
    s_add_u32 s92, s92, 20480
    s_waitcnt lgkmcnt(4)
    v_mfma_f32_32x32x16_bf16 v[72:87], v[88:91], a[180:183], v[72:87]
    ds_read_b128 v[108:111], v1 offset:30720
    s_cmp_eq_u32 s92, s93
    s_cselect_b32 s92, s62, s92
    s_add_u32 m0, s60, 122880
    v_fma_f32 v124, v124, v117, v116
    s_waitcnt lgkmcnt(4)
    v_mfma_f32_32x32x16_bf16 v[72:87], v[92:95], a[184:187], v[72:87]
    ds_read_b128 v[88:91], v1 offset:31744
    buffer_load_dwordx4 v1, s[4:7], s75 offen offset:0 lds
    v_fma_f32 v125, v125, v117, v116
    v_fma_f32 v126, v126, v117, v116
    v_fma_f32 v127, v127, v117, v116
    s_waitcnt lgkmcnt(4)
    v_mfma_f32_32x32x16_bf16 v[72:87], v[96:99], a[188:191], v[72:87]
    ds_read_b128 v[92:95], v1 offset:32768
    v_mul_f32 v120, v120, v56
    v_mul_f32 v121, v121, v57
    v_mul_f32 v122, v122, v58
    v_mul_f32 v123, v123, v59
    s_waitcnt lgkmcnt(4)
    v_mfma_f32_32x32x16_bf16 v[72:87], v[100:103], a[192:195], v[72:87]
    ds_read_b128 v[96:99], v1 offset:33792
    buffer_load_dwordx4 v1, s[4:7], s75 offen offset:1024 lds
    v_mul_f32 v124, v124, v60
    v_mul_f32 v125, v125, v61
    v_mul_f32 v126, v126, v62
    s_waitcnt lgkmcnt(4)
    v_mfma_f32_32x32x16_bf16 v[72:87], v[104:107], a[196:199], v[72:87]
    ds_read_b128 v[100:103], v1 offset:34816
    v_mul_f32 v127, v127, v63
    v_exp_f32 v120, v120
    s_waitcnt lgkmcnt(4)
    v_mfma_f32_32x32x16_bf16 v[72:87], v[108:111], a[200:203], v[72:87]
    ds_read_b128 v[104:107], v1 offset:35840
    buffer_load_dwordx4 v1, s[4:7], s75 offen offset:2048 lds
    v_exp_f32 v121, v121
    s_waitcnt lgkmcnt(4)
    v_mfma_f32_32x32x16_bf16 v[72:87], v[88:91], a[204:207], v[72:87]
    ds_read_b128 v[108:111], v1 offset:36864
    v_exp_f32 v122, v122
    v_exp_f32 v123, v123
    s_waitcnt lgkmcnt(4)
    v_mfma_f32_32x32x16_bf16 v[72:87], v[92:95], a[208:211], v[72:87]
    ds_read_b128 v[88:91], v1 offset:37888
    buffer_load_dwordx4 v1, s[4:7], s75 offen offset:3072 lds
    s_add_u32 m0, s60, 126976
    s_add_u32 s75, s75, 4096
    s_waitcnt lgkmcnt(4)
    v_mfma_f32_32x32x16_bf16 v[72:87], v[96:99], a[212:215], v[72:87]
    ds_read_b128 v[92:95], v1 offset:38912
    v_exp_f32 v124, v124
    v_exp_f32 v125, v125
    s_waitcnt lgkmcnt(4)
    v_mfma_f32_32x32x16_bf16 v[72:87], v[100:103], a[216:219], v[72:87]
    ds_read_b128 v[96:99], v1 offset:39936
    buffer_load_dwordx4 v1, s[4:7], s75 offen lds
    v_exp_f32 v126, v126
    s_waitcnt lgkmcnt(4)
    v_mfma_f32_32x32x16_bf16 v[72:87], v[104:107], a[220:223], v[72:87]
    ds_read_b128 v[100:103], v1 offset:40960
    v_exp_f32 v127, v127
    v_mul_f32 v64, v64, v56
    v_mul_f32 v65, v65, v57
    s_waitcnt lgkmcnt(4)
    v_mfma_f32_32x32x16_bf16 v[72:87], v[108:111], a[224:227], v[72:87]
    ds_read_b128 v[104:107], v1 offset:41984
    v_mul_f32 v66, v66, v58
    v_mul_f32 v67, v67, v59
    v_mul_f32 v68, v68, v60
    v_mul_f32 v69, v69, v61
    s_waitcnt lgkmcnt(4)
    v_mfma_f32_32x32x16_bf16 v[72:87], v[88:91], a[228:231], v[72:87]
    ds_read_b128 v[108:111], v1 offset:43008
    v_mul_f32 v70, v70, v62
    v_mul_f32 v71, v71, v63
    v_fma_f32 v120, v120, v118, v118
    v_fma_f32 v121, v121, v118, v118
    s_waitcnt lgkmcnt(4)
    v_mfma_f32_32x32x16_bf16 v[72:87], v[92:95], a[232:235], v[72:87]
    ds_read_b128 v[88:91], v1 offset:44032
    v_fma_f32 v122, v122, v118, v118
    v_fma_f32 v123, v123, v118, v118
    v_fma_f32 v124, v124, v118, v118
    v_fma_f32 v125, v125, v118, v118
    s_waitcnt lgkmcnt(4)
    v_mfma_f32_32x32x16_bf16 v[72:87], v[96:99], a[236:239], v[72:87]
    ds_read_b128 v[92:95], v1 offset:45056
    v_fma_f32 v126, v126, v118, v118
    v_fma_f32 v127, v127, v118, v118
    v_rcp_f32 v120, v120
    s_waitcnt lgkmcnt(4)
    v_mfma_f32_32x32x16_bf16 v[72:87], v[100:103], a[240:243], v[72:87]
    ds_read_b128 v[96:99], v1 offset:46080
    v_rcp_f32 v121, v121
    v_rcp_f32 v122, v122
    s_waitcnt lgkmcnt(4)
    v_mfma_f32_32x32x16_bf16 v[72:87], v[104:107], a[244:247], v[72:87]
    ds_read_b128 v[100:103], v1 offset:47104
    v_rcp_f32 v123, v123
    v_rcp_f32 v124, v124
    s_waitcnt lgkmcnt(4)
    v_mfma_f32_32x32x16_bf16 v[72:87], v[108:111], a[248:251], v[72:87]
    ds_read_b128 v[104:107], v1 offset:48128
    v_rcp_f32 v125, v125
    v_rcp_f32 v126, v126
    s_waitcnt lgkmcnt(4)
    v_mfma_f32_32x32x16_bf16 v[72:87], v[88:91], a[252:255], v[72:87]
    ds_read_b128 v[108:111], v1 offset:49152
    v_rcp_f32 v127, v127
    v_mul_f32 v64, v64, v120
    v_mul_f32 v65, v65, v121
    s_waitcnt lgkmcnt(4)
    v_mfma_f32_32x32x16_bf16 v[72:87], v[92:95], v[192:195], v[72:87]
    ds_read_b128 v[88:91], v1 offset:50176
    v_mul_f32 v66, v66, v122
    v_mul_f32 v67, v67, v123
    v_mul_f32 v68, v68, v124
    v_mul_f32 v69, v69, v125
    s_waitcnt lgkmcnt(4)
    v_mfma_f32_32x32x16_bf16 v[72:87], v[96:99], v[196:199], v[72:87]
    ds_read_b128 v[92:95], v1 offset:51200
    v_mul_f32 v70, v70, v126
    v_mul_f32 v71, v71, v127
    v_cvt_pk_bf16_f32 v128, v64, v65
    v_cvt_pk_bf16_f32 v129, v66, v67
    s_waitcnt lgkmcnt(4)
    v_mfma_f32_32x32x16_bf16 v[72:87], v[100:103], v[200:203], v[72:87]
    ds_read_b128 v[96:99], v1 offset:52224
    v_cvt_pk_bf16_f32 v130, v68, v69
    v_cvt_pk_bf16_f32 v131, v70, v71
    s_add_u32 s76, s51, s77
    buffer_store_dwordx4 v[128:131], v132, s[4:7], s76 offen
    s_waitcnt lgkmcnt(4)
    v_mfma_f32_32x32x16_bf16 v[72:87], v[104:107], v[204:207], v[72:87]
    ds_read_b128 v[100:103], v1 offset:53248
    s_waitcnt lgkmcnt(4)
    v_mfma_f32_32x32x16_bf16 v[72:87], v[108:111], v[208:211], v[72:87]
    ds_read_b128 v[104:107], v1 offset:54272
    s_waitcnt lgkmcnt(4)
    v_mfma_f32_32x32x16_bf16 v[72:87], v[88:91], v[212:215], v[72:87]
    ds_read_b128 v[108:111], v1 offset:55296
    s_waitcnt lgkmcnt(4)
    v_mfma_f32_32x32x16_bf16 v[72:87], v[92:95], v[216:219], v[72:87]
    ds_read_b128 v[88:91], v1 offset:56320
    s_waitcnt lgkmcnt(4)
    v_mfma_f32_32x32x16_bf16 v[72:87], v[96:99], v[220:223], v[72:87]
    ds_read_b128 v[92:95], v1 offset:57344
    s_waitcnt lgkmcnt(4)
    v_mfma_f32_32x32x16_bf16 v[72:87], v[100:103], v[224:227], v[72:87]
    ds_read_b128 v[96:99], v1 offset:58368
    s_waitcnt lgkmcnt(4)
    v_mfma_f32_32x32x16_bf16 v[72:87], v[104:107], v[228:231], v[72:87]
    ds_read_b128 v[100:103], v1 offset:59392
    s_waitcnt lgkmcnt(4)
    v_mfma_f32_32x32x16_bf16 v[72:87], v[108:111], v[232:235], v[72:87]
    ds_read_b128 v[104:107], v1 offset:60416
    s_waitcnt lgkmcnt(4)
    v_mfma_f32_32x32x16_bf16 v[72:87], v[88:91], v[236:239], v[72:87]
    ds_read_b128 v[108:111], v23 offset:17408
    s_waitcnt lgkmcnt(4)
    v_mfma_f32_32x32x16_bf16 v[72:87], v[92:95], v[240:243], v[72:87]
    s_waitcnt vmcnt(12)
    s_barrier
    ds_read_b128 v[88:91], v1 offset:61440
    s_cmp_eq_u32 s92, s94
    s_cselect_b32 s75, s63, s92
    s_add_u32 s92, s92, 20480
    s_cmp_eq_u32 s92, s93
    s_waitcnt lgkmcnt(4)
    v_mfma_f32_32x32x16_bf16 v[72:87], v[96:99], v[244:247], v[72:87]
    ds_read_b128 v[92:95], v1 offset:62464
    s_cselect_b32 s92, s62, s92
    s_add_u32 m0, s60, 0
    s_nop 0
    buffer_load_dwordx4 v1, s[4:7], s75 offen offset:0 lds
    s_waitcnt lgkmcnt(4)
    v_mfma_f32_32x32x16_bf16 v[72:87], v[100:103], v[248:251], v[72:87]
    ds_read_b128 v[96:99], v1 offset:63488
    s_waitcnt lgkmcnt(4)
    v_mfma_f32_32x32x16_bf16 v[72:87], v[104:107], v[252:255], v[72:87]
    ds_read_b128 v[100:103], v1 offset:64512
    buffer_load_dwordx4 v1, s[4:7], s75 offen offset:1024 lds
    s_waitcnt lgkmcnt(4)
    v_mfma_f32_32x32x16_bf16 v[72:87], v[108:111], v[112:115], v[72:87]
    ds_read_b128 v[104:107], v22 offset:0
    s_waitcnt lgkmcnt(4)
    v_mfma_f32_32x32x16_bf16 v[40:55], v[88:91], a[160:163], 0
    ds_read_b128 v[108:111], v22 offset:1024
    buffer_load_dwordx4 v1, s[4:7], s75 offen offset:2048 lds
    s_nop 6
    v_mul_f32 v120, v72, v72
    v_mul_f32 v121, v73, v73
    v_mul_f32 v122, v74, v74
    s_waitcnt lgkmcnt(4)
    v_mfma_f32_32x32x16_bf16 v[40:55], v[92:95], a[164:167], v[40:55]
    ds_read_b128 v[88:91], v22 offset:2048
    v_mul_f32 v123, v75, v75
    v_mul_f32 v124, v76, v76
    v_mul_f32 v125, v77, v77
    v_mul_f32 v126, v78, v78
    s_waitcnt lgkmcnt(4)
    v_mfma_f32_32x32x16_bf16 v[40:55], v[96:99], a[168:171], v[40:55]
    ds_read_b128 v[92:95], v22 offset:3072
    buffer_load_dwordx4 v1, s[4:7], s75 offen offset:3072 lds
    s_add_u32 m0, s60, 4096
    s_add_u32 s75, s75, 4096
    v_mul_f32 v127, v79, v79
    s_waitcnt lgkmcnt(4)
    v_mfma_f32_32x32x16_bf16 v[40:55], v[100:103], a[172:175], v[40:55]
    ds_read_b128 v[96:99], v22 offset:4096
    v_fma_f32 v120, v120, v117, v116
    v_fma_f32 v121, v121, v117, v116
    v_fma_f32 v122, v122, v117, v116
    v_fma_f32 v123, v123, v117, v116
    s_waitcnt lgkmcnt(4)
    v_mfma_f32_32x32x16_bf16 v[40:55], v[104:107], a[176:179], v[40:55]
    ds_read_b128 v[100:103], v22 offset:5120
    buffer_load_dwordx4 v1, s[4:7], s75 offen lds
    s_cmp_eq_u32 s92, s94
    s_cselect_b32 s75, s63, s92
    s_add_u32 s92, s92, 20480
    s_waitcnt lgkmcnt(4)
    v_mfma_f32_32x32x16_bf16 v[40:55], v[108:111], a[180:183], v[40:55]
    ds_read_b128 v[104:107], v22 offset:6144
    s_cmp_eq_u32 s92, s93
    s_cselect_b32 s92, s62, s92
    s_add_u32 m0, s60, 20480
    v_fma_f32 v124, v124, v117, v116
    s_waitcnt lgkmcnt(4)
    v_mfma_f32_32x32x16_bf16 v[40:55], v[88:91], a[184:187], v[40:55]
    ds_read_b128 v[108:111], v22 offset:7168
    buffer_load_dwordx4 v1, s[4:7], s75 offen offset:0 lds
    v_fma_f32 v125, v125, v117, v116
    v_fma_f32 v126, v126, v117, v116
    v_fma_f32 v127, v127, v117, v116
    s_waitcnt lgkmcnt(4)
    v_mfma_f32_32x32x16_bf16 v[40:55], v[92:95], a[188:191], v[40:55]
    ds_read_b128 v[88:91], v22 offset:8192
    v_mul_f32 v120, v120, v72
    v_mul_f32 v121, v121, v73
    v_mul_f32 v122, v122, v74
    v_mul_f32 v123, v123, v75
    s_waitcnt lgkmcnt(4)
    v_mfma_f32_32x32x16_bf16 v[40:55], v[96:99], a[192:195], v[40:55]
    ds_read_b128 v[92:95], v22 offset:9216
    buffer_load_dwordx4 v1, s[4:7], s75 offen offset:1024 lds
    v_mul_f32 v124, v124, v76
    v_mul_f32 v125, v125, v77
    v_mul_f32 v126, v126, v78
    s_waitcnt lgkmcnt(4)
    v_mfma_f32_32x32x16_bf16 v[40:55], v[100:103], a[196:199], v[40:55]
    ds_read_b128 v[96:99], v22 offset:10240
    v_mul_f32 v127, v127, v79
    v_exp_f32 v120, v120
    s_waitcnt lgkmcnt(4)
    v_mfma_f32_32x32x16_bf16 v[40:55], v[104:107], a[200:203], v[40:55]
    ds_read_b128 v[100:103], v22 offset:11264
    buffer_load_dwordx4 v1, s[4:7], s75 offen offset:2048 lds
    v_exp_f32 v121, v121
    s_waitcnt lgkmcnt(4)
    v_mfma_f32_32x32x16_bf16 v[40:55], v[108:111], a[204:207], v[40:55]
    ds_read_b128 v[104:107], v22 offset:12288
    v_exp_f32 v122, v122
    v_exp_f32 v123, v123
    s_waitcnt lgkmcnt(4)
    v_mfma_f32_32x32x16_bf16 v[40:55], v[88:91], a[208:211], v[40:55]
    ds_read_b128 v[108:111], v22 offset:13312
    buffer_load_dwordx4 v1, s[4:7], s75 offen offset:3072 lds
    s_add_u32 m0, s60, 24576
    s_add_u32 s75, s75, 4096
    s_waitcnt lgkmcnt(4)
    v_mfma_f32_32x32x16_bf16 v[40:55], v[92:95], a[212:215], v[40:55]
    ds_read_b128 v[88:91], v22 offset:14336
    v_exp_f32 v124, v124
    v_exp_f32 v125, v125
    s_waitcnt lgkmcnt(4)
    v_mfma_f32_32x32x16_bf16 v[40:55], v[96:99], a[216:219], v[40:55]
    ds_read_b128 v[92:95], v22 offset:15360
    buffer_load_dwordx4 v1, s[4:7], s75 offen lds
    v_exp_f32 v126, v126
    s_waitcnt lgkmcnt(4)
    v_mfma_f32_32x32x16_bf16 v[40:55], v[100:103], a[220:223], v[40:55]
    ds_read_b128 v[96:99], v22 offset:16384
    v_exp_f32 v127, v127
    v_mul_f32 v80, v80, v72
    v_mul_f32 v81, v81, v73
    s_waitcnt lgkmcnt(4)
    v_mfma_f32_32x32x16_bf16 v[40:55], v[104:107], a[224:227], v[40:55]
    ds_read_b128 v[100:103], v22 offset:17408
    v_mul_f32 v82, v82, v74
    v_mul_f32 v83, v83, v75
    v_mul_f32 v84, v84, v76
    v_mul_f32 v85, v85, v77
    s_waitcnt lgkmcnt(4)
    v_mfma_f32_32x32x16_bf16 v[40:55], v[108:111], a[228:231], v[40:55]
    ds_read_b128 v[104:107], v22 offset:18432
    v_mul_f32 v86, v86, v78
    v_mul_f32 v87, v87, v79
    v_fma_f32 v120, v120, v118, v118
    v_fma_f32 v121, v121, v118, v118
    s_waitcnt lgkmcnt(4)
    v_mfma_f32_32x32x16_bf16 v[40:55], v[88:91], a[232:235], v[40:55]
    ds_read_b128 v[108:111], v22 offset:19456
    v_fma_f32 v122, v122, v118, v118
    v_fma_f32 v123, v123, v118, v118
    v_fma_f32 v124, v124, v118, v118
    v_fma_f32 v125, v125, v118, v118
    s_waitcnt lgkmcnt(4)
    v_mfma_f32_32x32x16_bf16 v[40:55], v[92:95], a[236:239], v[40:55]
    ds_read_b128 v[88:91], v22 offset:20480
    v_fma_f32 v126, v126, v118, v118
    v_fma_f32 v127, v127, v118, v118
    v_rcp_f32 v120, v120
    s_waitcnt lgkmcnt(4)
    v_mfma_f32_32x32x16_bf16 v[40:55], v[96:99], a[240:243], v[40:55]
    ds_read_b128 v[92:95], v22 offset:21504
    v_rcp_f32 v121, v121
    v_rcp_f32 v122, v122
    s_waitcnt lgkmcnt(4)
    v_mfma_f32_32x32x16_bf16 v[40:55], v[100:103], a[244:247], v[40:55]
    ds_read_b128 v[96:99], v22 offset:22528
    v_rcp_f32 v123, v123
    v_rcp_f32 v124, v124
    s_waitcnt lgkmcnt(4)
    v_mfma_f32_32x32x16_bf16 v[40:55], v[104:107], a[248:251], v[40:55]
    ds_read_b128 v[100:103], v22 offset:23552
    v_rcp_f32 v125, v125
    v_rcp_f32 v126, v126
    s_waitcnt lgkmcnt(4)
    v_mfma_f32_32x32x16_bf16 v[40:55], v[108:111], a[252:255], v[40:55]
    ds_read_b128 v[104:107], v22 offset:24576
    v_rcp_f32 v127, v127
    v_mul_f32 v80, v80, v120
    v_mul_f32 v81, v81, v121
    s_waitcnt lgkmcnt(4)
    v_mfma_f32_32x32x16_bf16 v[40:55], v[88:91], v[192:195], v[40:55]
    ds_read_b128 v[108:111], v22 offset:25600
    v_mul_f32 v82, v82, v122
    v_mul_f32 v83, v83, v123
    v_mul_f32 v84, v84, v124
    v_mul_f32 v85, v85, v125
    s_waitcnt lgkmcnt(4)
    v_mfma_f32_32x32x16_bf16 v[40:55], v[92:95], v[196:199], v[40:55]
    ds_read_b128 v[88:91], v22 offset:26624
    v_mul_f32 v86, v86, v126
    v_mul_f32 v87, v87, v127
    v_cvt_pk_bf16_f32 v128, v80, v81
    v_cvt_pk_bf16_f32 v129, v82, v83
    s_waitcnt lgkmcnt(4)
    v_mfma_f32_32x32x16_bf16 v[40:55], v[96:99], v[200:203], v[40:55]
    ds_read_b128 v[92:95], v22 offset:27648
    v_cvt_pk_bf16_f32 v130, v84, v85
    v_cvt_pk_bf16_f32 v131, v86, v87
    s_add_u32 s76, s52, s77
    buffer_store_dwordx4 v[128:131], v132, s[4:7], s76 offen
    s_waitcnt lgkmcnt(4)
    v_mfma_f32_32x32x16_bf16 v[40:55], v[100:103], v[204:207], v[40:55]
    ds_read_b128 v[96:99], v22 offset:28672
    s_waitcnt lgkmcnt(4)
    v_mfma_f32_32x32x16_bf16 v[40:55], v[104:107], v[208:211], v[40:55]
    ds_read_b128 v[100:103], v22 offset:29696
    s_waitcnt lgkmcnt(4)
    v_mfma_f32_32x32x16_bf16 v[40:55], v[108:111], v[212:215], v[40:55]
    ds_read_b128 v[104:107], v22 offset:30720
    s_waitcnt lgkmcnt(4)
    v_mfma_f32_32x32x16_bf16 v[40:55], v[88:91], v[216:219], v[40:55]
    ds_read_b128 v[108:111], v22 offset:31744
    s_waitcnt lgkmcnt(4)
    v_mfma_f32_32x32x16_bf16 v[40:55], v[92:95], v[220:223], v[40:55]
    ds_read_b128 v[88:91], v22 offset:32768
    s_waitcnt lgkmcnt(4)
    v_mfma_f32_32x32x16_bf16 v[40:55], v[96:99], v[224:227], v[40:55]
    ds_read_b128 v[92:95], v22 offset:33792
    s_waitcnt lgkmcnt(4)
    v_mfma_f32_32x32x16_bf16 v[40:55], v[100:103], v[228:231], v[40:55]
    ds_read_b128 v[96:99], v22 offset:34816
    s_waitcnt lgkmcnt(4)
    v_mfma_f32_32x32x16_bf16 v[40:55], v[104:107], v[232:235], v[40:55]
    ds_read_b128 v[100:103], v22 offset:35840
    s_waitcnt lgkmcnt(4)
    v_mfma_f32_32x32x16_bf16 v[40:55], v[108:111], v[236:239], v[40:55]
    ds_read_b128 v[104:107], v23 offset:18432
    s_waitcnt lgkmcnt(4)
    v_mfma_f32_32x32x16_bf16 v[40:55], v[88:91], v[240:243], v[40:55]
    s_waitcnt lgkmcnt(3)
    v_mfma_f32_32x32x16_bf16 v[40:55], v[92:95], v[244:247], v[40:55]
    s_waitcnt lgkmcnt(2)
    v_mfma_f32_32x32x16_bf16 v[40:55], v[96:99], v[248:251], v[40:55]
    s_waitcnt lgkmcnt(1)
    v_mfma_f32_32x32x16_bf16 v[40:55], v[100:103], v[252:255], v[40:55]
    s_waitcnt lgkmcnt(0)
    v_mfma_f32_32x32x16_bf16 v[40:55], v[104:107], v[112:115], v[40:55]
    s_barrier
    s_nop 10
    v_mul_f32 v120, v40, v40
    v_mul_f32 v121, v41, v41
    v_mul_f32 v122, v42, v42
    v_mul_f32 v123, v43, v43
    v_mul_f32 v124, v44, v44
    v_mul_f32 v125, v45, v45
    v_mul_f32 v126, v46, v46
    v_mul_f32 v127, v47, v47
    v_fma_f32 v120, v120, v117, v116
    v_fma_f32 v121, v121, v117, v116
    v_fma_f32 v122, v122, v117, v116
    v_fma_f32 v123, v123, v117, v116
    v_fma_f32 v124, v124, v117, v116
    v_fma_f32 v125, v125, v117, v116
    v_fma_f32 v126, v126, v117, v116
    v_fma_f32 v127, v127, v117, v116
    v_mul_f32 v120, v120, v40
    v_mul_f32 v121, v121, v41
    v_mul_f32 v122, v122, v42
    v_mul_f32 v123, v123, v43
    v_mul_f32 v124, v124, v44
    v_mul_f32 v125, v125, v45
    v_mul_f32 v126, v126, v46
    v_mul_f32 v127, v127, v47
    v_exp_f32 v120, v120
    v_exp_f32 v121, v121
    v_exp_f32 v122, v122
    v_exp_f32 v123, v123
    v_exp_f32 v124, v124
    v_exp_f32 v125, v125
    v_exp_f32 v126, v126
    v_exp_f32 v127, v127
    v_mul_f32 v48, v48, v40
    v_mul_f32 v49, v49, v41
    v_mul_f32 v50, v50, v42
    v_mul_f32 v51, v51, v43
    v_mul_f32 v52, v52, v44
    v_mul_f32 v53, v53, v45
    v_mul_f32 v54, v54, v46
    v_mul_f32 v55, v55, v47
    v_fma_f32 v120, v120, v118, v118
    v_fma_f32 v121, v121, v118, v118
    v_fma_f32 v122, v122, v118, v118
    v_fma_f32 v123, v123, v118, v118
    v_fma_f32 v124, v124, v118, v118
    v_fma_f32 v125, v125, v118, v118
    v_fma_f32 v126, v126, v118, v118
    v_fma_f32 v127, v127, v118, v118
    v_rcp_f32 v120, v120
    v_rcp_f32 v121, v121
    v_rcp_f32 v122, v122
    v_rcp_f32 v123, v123
    v_rcp_f32 v124, v124
    v_rcp_f32 v125, v125
    v_rcp_f32 v126, v126
    v_rcp_f32 v127, v127
    v_mul_f32 v48, v48, v120
    v_mul_f32 v49, v49, v121
    v_mul_f32 v50, v50, v122
    v_mul_f32 v51, v51, v123
    v_mul_f32 v52, v52, v124
    v_mul_f32 v53, v53, v125
    v_mul_f32 v54, v54, v126
    v_mul_f32 v55, v55, v127
    v_cvt_pk_bf16_f32 v128, v48, v49
    v_cvt_pk_bf16_f32 v129, v50, v51
    v_cvt_pk_bf16_f32 v130, v52, v53
    v_cvt_pk_bf16_f32 v131, v54, v55
    s_add_u32 s76, s53, s77
    buffer_store_dwordx4 v[128:131], v132, s[4:7], s76 offen
    s_lshl_b32 s75, s30, 8
    s_add_u32 s75, s75, 160832
    v_and_b32 v25, 15, v0
    v_lshlrev_b32 v25, 4, v25
    v_add_u32 v25, s75, v25
    ds_read_b128 v[28:31], v25
    s_add_u32 s39, s39, 1
    s_add_u32 s76, s86, s39
    s_add_u32 s76, s76, 0x20
    s_lshl_b32 s75, s29, 4
    s_lshl_b32 s77, s30, 2
    s_add_u32 s75, s75, s77
    s_add_u32 s75, s75, s65
    v_mov_b32 v24, s76
    v_mov_b32 v26, 0
    s_waitcnt vmcnt(0)
    s_cmp_eq_u32 s36, 0
    s_cbranch_scc0 WS_29
    s_mov_b32 exec_lo, 0x1
    s_mov_b32 exec_hi, 0x0
    buffer_store_dword v24, v26, s[4:7], s75 offen
    s_mov_b64 exec, -1
WT_30:
    s_waitcnt lgkmcnt(0)
    buffer_load_dword v27, v30, s[4:7], s65 offen sc1
    s_cmp_eq_u32 s92, s94
    s_cselect_b32 s75, s63, s92
    s_add_u32 s92, s92, 20480
    s_cmp_eq_u32 s92, s93
    s_cselect_b32 s92, s62, s92
    s_add_u32 m0, s60, 40960
    s_nop 0
    buffer_load_dwordx4 v1, s[4:7], s75 offen offset:0 lds
    buffer_load_dwordx4 v1, s[4:7], s75 offen offset:1024 lds
    buffer_load_dwordx4 v1, s[4:7], s75 offen offset:2048 lds
    buffer_load_dwordx4 v1, s[4:7], s75 offen offset:3072 lds
    s_add_u32 m0, s60, 45056
    s_add_u32 s75, s75, 4096
    buffer_load_dwordx4 v1, s[4:7], s75 offen lds
    s_cmp_eq_u32 s92, s94
    s_cselect_b32 s75, s63, s92
    s_add_u32 s92, s92, 20480
    s_cmp_eq_u32 s92, s93
    s_cselect_b32 s92, s62, s92
    s_add_u32 m0, s60, 61440
    s_nop 0
    buffer_load_dwordx4 v1, s[4:7], s75 offen offset:0 lds
    buffer_load_dwordx4 v1, s[4:7], s75 offen offset:1024 lds
    buffer_load_dwordx4 v1, s[4:7], s75 offen offset:2048 lds
    buffer_load_dwordx4 v1, s[4:7], s75 offen offset:3072 lds
    s_add_u32 m0, s60, 65536
    s_add_u32 s75, s75, 4096
    buffer_load_dwordx4 v1, s[4:7], s75 offen lds
    s_waitcnt vmcnt(10)
    v_subrev_u32 v27, s76, v27
    v_cmp_le_u32 s[84:85], 8, v27
    s_nop 1
    s_cmp_eq_u64 s[84:85], 0
    s_cbranch_scc1 WK_31
    s_mov_b32 s83, 0
WP_32:
    buffer_load_dword v27, v30, s[4:7], s65 offen sc1
    s_add_u32 s83, s83, 1
    s_cmp_gt_u32 s83, 200000
    s_cbranch_scc1 L_END
    s_waitcnt vmcnt(0)
    v_subrev_u32 v27, s76, v27
    v_cmp_le_u32 s[84:85], 8, v27
    s_nop 1
    s_cmp_eq_u64 s[84:85], 0
    s_cbranch_scc0 WP_32
WK_31:
    s_lshl_b32 s75, s33, 2
    s_add_u32 s75, s75, s30
    s_mul_i32 s77, s75, 55296
    s_add_u32 s77, s77, 655360
    s_add_u32 s77, s77, s54
    s_add_u32 s97, s77, 57344
    s_add_u32 s98, s77, 53248
    s_lshl_b32 s96, s95, 12
    s_add_u32 s96, s96, s77
    s_cmp_eq_u32 s96, s98
    s_cselect_b32 s99, 0x40000000, s96
    buffer_load_dwordx4 a[160:163], v1, s[4:7], s96 offen offset:0 sc1
    buffer_load_dwordx4 a[164:167], v1, s[4:7], s96 offen offset:1024 sc1
    buffer_load_dwordx4 a[168:171], v1, s[4:7], s99 offen offset:2048 sc1
    buffer_load_dwordx4 a[172:175], v1, s[4:7], s99 offen offset:3072 sc1
    s_add_u32 s96, s96, 4096
    s_cmp_eq_u32 s96, s97
    s_cselect_b32 s96, s77, s96
    s_cmp_eq_u32 s96, s98
    s_cselect_b32 s99, 0x40000000, s96
    buffer_load_dwordx4 a[176:179], v1, s[4:7], s96 offen offset:0 sc1
    buffer_load_dwordx4 a[180:183], v1, s[4:7], s96 offen offset:1024 sc1
    buffer_load_dwordx4 a[184:187], v1, s[4:7], s99 offen offset:2048 sc1
    buffer_load_dwordx4 a[188:191], v1, s[4:7], s99 offen offset:3072 sc1
    s_add_u32 s96, s96, 4096
    s_cmp_eq_u32 s96, s97
    s_cselect_b32 s96, s77, s96
    v_lshrrev_b32 v24, 4, v0
    v_and_b32 v25, 15, v0
    v_lshrrev_b32 v26, 1, v24
    v_lshlrev_b32 v26, 9, v26
    v_and_b32 v24, 1, v24
    v_lshlrev_b32 v24, 3, v24
    v_lshlrev_b32 v125, 4, v25
    v_add_u32 v125, v125, v26
    v_add_u32 v125, v125, v24
    s_barrier
    ds_read_b128 v[80:83], v22 offset:36864
    ds_read_b128 v[84:87], v22 offset:37888
    ds_read_b128 v[88:91], v22 offset:38912
    ds_read_b128 v[92:95], v22 offset:39936
    ds_read_b128 v[96:99], v22 offset:40960
    ds_read_b128 v[100:103], v22 offset:41984
    ds_read_b128 v[104:107], v22 offset:43008
    ds_read_b128 v[108:111], v22 offset:44032
    s_waitcnt vmcnt(7)
    s_waitcnt lgkmcnt(6)
    v_mfma_f32_16x16x32_bf16 v[40:43], v[80:83], a[160:163], 0
    ds_read_b128 v[112:115], v22 offset:45056
    s_cmp_eq_u32 s96, s98
    s_cselect_b32 s99, 0x40000000, s96
    buffer_load_dwordx4 a[192:195], v1, s[4:7], s96 offen offset:0 sc1
    v_mfma_f32_16x16x32_bf16 v[44:47], v[84:87], a[160:163], 0
    ds_read_b128 v[116:119], v22 offset:46080
    s_waitcnt lgkmcnt(6)
    v_mfma_f32_16x16x32_bf16 v[48:51], v[88:91], a[160:163], 0
    ds_read_b128 v[80:83], v22 offset:47104
    buffer_load_dwordx4 a[196:199], v1, s[4:7], s96 offen offset:1024 sc1
    v_mfma_f32_16x16x32_bf16 v[52:55], v[92:95], a[160:163], 0
    ds_read_b128 v[84:87], v22 offset:48128
    s_waitcnt lgkmcnt(6)
    v_mfma_f32_16x16x32_bf16 v[56:59], v[96:99], a[160:163], 0
    ds_read_b128 v[88:91], v22 offset:49152
    s_waitcnt vmcnt(8)
    v_mfma_f32_16x16x32_bf16 v[40:43], v[100:103], a[164:167], v[40:43]
    ds_read_b128 v[92:95], v22 offset:50176
    buffer_load_dwordx4 a[200:203], v1, s[4:7], s99 offen offset:2048 sc1
    s_waitcnt lgkmcnt(6)
    v_mfma_f32_16x16x32_bf16 v[44:47], v[104:107], a[164:167], v[44:47]
    ds_read_b128 v[96:99], v22 offset:51200
    v_mfma_f32_16x16x32_bf16 v[48:51], v[108:111], a[164:167], v[48:51]
    ds_read_b128 v[100:103], v22 offset:52224
    buffer_load_dwordx4 a[204:207], v1, s[4:7], s99 offen offset:3072 sc1
    s_add_u32 s96, s96, 4096
    s_cmp_eq_u32 s96, s97
    s_cselect_b32 s96, s77, s96
    s_waitcnt lgkmcnt(6)
    v_mfma_f32_16x16x32_bf16 v[52:55], v[112:115], a[164:167], v[52:55]
    ds_read_b128 v[104:107], v22 offset:53248
    v_mfma_f32_16x16x32_bf16 v[56:59], v[116:119], a[164:167], v[56:59]
    ds_read_b128 v[108:111], v22 offset:54272
    s_waitcnt vmcnt(9)
    s_waitcnt lgkmcnt(6)
    v_mfma_f32_16x16x32_bf16 v[40:43], v[80:83], a[168:171], v[40:43]
    ds_read_b128 v[112:115], v22 offset:55296
    s_cmp_eq_u32 s96, s98
    s_cselect_b32 s99, 0x40000000, s96
    buffer_load_dwordx4 a[208:211], v1, s[4:7], s96 offen offset:0 sc1
    v_mfma_f32_16x16x32_bf16 v[44:47], v[84:87], a[168:171], v[44:47]
    ds_read_b128 v[116:119], v22 offset:56320
    s_waitcnt lgkmcnt(6)
    v_mfma_f32_16x16x32_bf16 v[48:51], v[88:91], a[168:171], v[48:51]
    ds_read_b128 v[80:83], v22 offset:57344
    v_mfma_f32_16x16x32_bf16 v[52:55], v[92:95], a[168:171], v[52:55]
    ds_read_b128 v[84:87], v22 offset:58368
    buffer_load_dwordx4 a[212:215], v1, s[4:7], s96 offen offset:1024 sc1
    s_waitcnt lgkmcnt(6)
    v_mfma_f32_16x16x32_bf16 v[56:59], v[96:99], a[168:171], v[56:59]
    ds_read_b128 v[88:91], v22 offset:59392
    s_waitcnt vmcnt(10)
    v_mfma_f32_16x16x32_bf16 v[40:43], v[100:103], a[172:175], v[40:43]
    ds_read_b128 v[92:95], v22 offset:60416
    buffer_load_dwordx4 a[216:219], v1, s[4:7], s99 offen offset:2048 sc1
    s_waitcnt lgkmcnt(6)
    v_mfma_f32_16x16x32_bf16 v[44:47], v[104:107], a[172:175], v[44:47]
    ds_read_b128 v[96:99], v22 offset:61440
    v_mfma_f32_16x16x32_bf16 v[48:51], v[108:111], a[172:175], v[48:51]
    ds_read_b128 v[100:103], v22 offset:62464
    s_waitcnt lgkmcnt(6)
    v_mfma_f32_16x16x32_bf16 v[52:55], v[112:115], a[172:175], v[52:55]
    ds_read_b128 v[104:107], v22 offset:63488
    buffer_load_dwordx4 a[220:223], v1, s[4:7], s99 offen offset:3072 sc1
    s_add_u32 s96, s96, 4096
    s_cmp_eq_u32 s96, s97
    s_cselect_b32 s96, s77, s96
    v_mfma_f32_16x16x32_bf16 v[56:59], v[116:119], a[172:175], v[56:59]
    ds_read_b128 v[108:111], v22 offset:64512
    s_waitcnt vmcnt(11)
    s_waitcnt lgkmcnt(6)
    v_mfma_f32_16x16x32_bf16 v[40:43], v[80:83], a[176:179], v[40:43]
    ds_read_b128 v[112:115], v23 offset:0
    s_cmp_eq_u32 s96, s98
    s_cselect_b32 s99, 0x40000000, s96
    buffer_load_dwordx4 a[224:227], v1, s[4:7], s96 offen offset:0 sc1
    v_mfma_f32_16x16x32_bf16 v[44:47], v[84:87], a[176:179], v[44:47]
    ds_read_b128 v[116:119], v23 offset:1024
    s_waitcnt lgkmcnt(6)
    v_mfma_f32_16x16x32_bf16 v[48:51], v[88:91], a[176:179], v[48:51]
    ds_read_b128 v[80:83], v23 offset:2048
    v_mfma_f32_16x16x32_bf16 v[52:55], v[92:95], a[176:179], v[52:55]
    ds_read_b128 v[84:87], v23 offset:3072
    buffer_load_dwordx4 a[228:231], v1, s[4:7], s96 offen offset:1024 sc1
    s_waitcnt lgkmcnt(6)
    v_mfma_f32_16x16x32_bf16 v[56:59], v[96:99], a[176:179], v[56:59]
    ds_read_b128 v[88:91], v23 offset:4096
    s_waitcnt vmcnt(12)
    v_mfma_f32_16x16x32_bf16 v[40:43], v[100:103], a[180:183], v[40:43]
    ds_read_b128 v[92:95], v23 offset:5120
    s_waitcnt lgkmcnt(6)
    v_mfma_f32_16x16x32_bf16 v[44:47], v[104:107], a[180:183], v[44:47]
    ds_read_b128 v[96:99], v23 offset:6144
    buffer_load_dwordx4 a[232:235], v1, s[4:7], s99 offen offset:2048 sc1
    v_mfma_f32_16x16x32_bf16 v[48:51], v[108:111], a[180:183], v[48:51]
    ds_read_b128 v[100:103], v23 offset:7168
    s_waitcnt lgkmcnt(6)
    v_mfma_f32_16x16x32_bf16 v[52:55], v[112:115], a[180:183], v[52:55]
    ds_read_b128 v[104:107], v23 offset:8192
    buffer_load_dwordx4 a[236:239], v1, s[4:7], s99 offen offset:3072 sc1
    s_add_u32 s96, s96, 4096
    s_cmp_eq_u32 s96, s97
    s_cselect_b32 s96, s77, s96
    v_mfma_f32_16x16x32_bf16 v[56:59], v[116:119], a[180:183], v[56:59]
    ds_read_b128 v[108:111], v23 offset:9216
    s_waitcnt vmcnt(13)
    s_waitcnt lgkmcnt(6)
    v_mfma_f32_16x16x32_bf16 v[40:43], v[80:83], a[184:187], v[40:43]
    ds_read_b128 v[112:115], v23 offset:10240
    v_mfma_f32_16x16x32_bf16 v[44:47], v[84:87], a[184:187], v[44:47]
    ds_read_b128 v[116:119], v23 offset:11264
    s_cmp_eq_u32 s96, s98
    s_cselect_b32 s99, 0x40000000, s96
    buffer_load_dwordx4 a[240:243], v1, s[4:7], s96 offen offset:0 sc1
    s_waitcnt lgkmcnt(6)
    v_mfma_f32_16x16x32_bf16 v[48:51], v[88:91], a[184:187], v[48:51]
    s_waitcnt lgkmcnt(0)
    s_barrier
    ds_read_b128 v[80:83], v1 offset:0
    v_mfma_f32_16x16x32_bf16 v[52:55], v[92:95], a[184:187], v[52:55]
    ds_read_b128 v[84:87], v1 offset:1024
    buffer_load_dwordx4 a[244:247], v1, s[4:7], s96 offen offset:1024 sc1
    s_waitcnt lgkmcnt(6)
    v_mfma_f32_16x16x32_bf16 v[56:59], v[96:99], a[184:187], v[56:59]
    ds_read_b128 v[88:91], v1 offset:2048
    s_waitcnt vmcnt(14)
    v_mfma_f32_16x16x32_bf16 v[40:43], v[100:103], a[188:191], v[40:43]
    ds_read_b128 v[92:95], v1 offset:3072
    s_waitcnt lgkmcnt(6)
    v_mfma_f32_16x16x32_bf16 v[44:47], v[104:107], a[188:191], v[44:47]
    ds_read_b128 v[96:99], v1 offset:4096
    buffer_load_dwordx4 a[248:251], v1, s[4:7], s99 offen offset:2048 sc1
    v_mfma_f32_16x16x32_bf16 v[48:51], v[108:111], a[188:191], v[48:51]
    ds_read_b128 v[100:103], v1 offset:5120
    s_waitcnt lgkmcnt(6)
    v_mfma_f32_16x16x32_bf16 v[52:55], v[112:115], a[188:191], v[52:55]
    ds_read_b128 v[104:107], v1 offset:6144
    v_mfma_f32_16x16x32_bf16 v[56:59], v[116:119], a[188:191], v[56:59]
    ds_read_b128 v[108:111], v1 offset:7168
    buffer_load_dwordx4 a[252:255], v1, s[4:7], s99 offen offset:3072 sc1
    s_add_u32 s96, s96, 4096
    s_cmp_eq_u32 s96, s97
    s_cselect_b32 s96, s77, s96
    s_waitcnt vmcnt(15)
    s_waitcnt lgkmcnt(6)
    v_mfma_f32_16x16x32_bf16 v[40:43], v[80:83], a[192:195], v[40:43]
    ds_read_b128 v[112:115], v1 offset:8192
    v_mfma_f32_16x16x32_bf16 v[44:47], v[84:87], a[192:195], v[44:47]
    ds_read_b128 v[116:119], v1 offset:9216
    s_cmp_eq_u32 s96, s98
    s_cselect_b32 s99, 0x40000000, s96
    buffer_load_dwordx4 a[160:163], v1, s[4:7], s96 offen offset:0 sc1
    s_waitcnt lgkmcnt(6)
    v_mfma_f32_16x16x32_bf16 v[48:51], v[88:91], a[192:195], v[48:51]
    ds_read_b128 v[80:83], v1 offset:10240
    v_mfma_f32_16x16x32_bf16 v[52:55], v[92:95], a[192:195], v[52:55]
    ds_read_b128 v[84:87], v1 offset:11264
    s_waitcnt lgkmcnt(6)
    v_mfma_f32_16x16x32_bf16 v[56:59], v[96:99], a[192:195], v[56:59]
    ds_read_b128 v[88:91], v1 offset:12288
    buffer_load_dwordx4 a[164:167], v1, s[4:7], s96 offen offset:1024 sc1
    s_waitcnt vmcnt(16)
    v_mfma_f32_16x16x32_bf16 v[40:43], v[100:103], a[196:199], v[40:43]
    ds_read_b128 v[92:95], v1 offset:13312
    s_waitcnt lgkmcnt(6)
    v_mfma_f32_16x16x32_bf16 v[44:47], v[104:107], a[196:199], v[44:47]
    ds_read_b128 v[96:99], v1 offset:14336
    buffer_load_dwordx4 a[168:171], v1, s[4:7], s99 offen offset:2048 sc1
    v_mfma_f32_16x16x32_bf16 v[48:51], v[108:111], a[196:199], v[48:51]
    ds_read_b128 v[100:103], v1 offset:15360
    s_waitcnt lgkmcnt(6)
    v_mfma_f32_16x16x32_bf16 v[52:55], v[112:115], a[196:199], v[52:55]
    ds_read_b128 v[104:107], v1 offset:16384
    v_mfma_f32_16x16x32_bf16 v[56:59], v[116:119], a[196:199], v[56:59]
    ds_read_b128 v[108:111], v1 offset:17408
    buffer_load_dwordx4 a[172:175], v1, s[4:7], s99 offen offset:3072 sc1
    s_add_u32 s96, s96, 4096
    s_cmp_eq_u32 s96, s97
    s_cselect_b32 s96, s77, s96
    s_waitcnt vmcnt(17)
    s_waitcnt lgkmcnt(6)
    v_mfma_f32_16x16x32_bf16 v[40:43], v[80:83], a[200:203], v[40:43]
    ds_read_b128 v[112:115], v1 offset:18432
    v_mfma_f32_16x16x32_bf16 v[44:47], v[84:87], a[200:203], v[44:47]
    ds_read_b128 v[116:119], v1 offset:19456
    s_waitcnt lgkmcnt(6)
    v_mfma_f32_16x16x32_bf16 v[48:51], v[88:91], a[200:203], v[48:51]
    ds_read_b128 v[80:83], v1 offset:20480
    s_cmp_eq_u32 s92, s94
    s_cselect_b32 s75, s63, s92
    s_add_u32 s92, s92, 20480
    s_cmp_eq_u32 s92, s93
    s_cselect_b32 s92, s62, s92
    s_add_u32 m0, s60, 81920
    s_nop 0
    buffer_load_dwordx4 v1, s[4:7], s75 offen offset:0 lds
    v_mfma_f32_16x16x32_bf16 v[52:55], v[92:95], a[200:203], v[52:55]
    ds_read_b128 v[84:87], v1 offset:21504
    s_waitcnt lgkmcnt(6)
    v_mfma_f32_16x16x32_bf16 v[56:59], v[96:99], a[200:203], v[56:59]
    ds_read_b128 v[88:91], v1 offset:22528
    buffer_load_dwordx4 v1, s[4:7], s75 offen offset:1024 lds
    s_waitcnt vmcnt(18)
    v_mfma_f32_16x16x32_bf16 v[40:43], v[100:103], a[204:207], v[40:43]
    ds_read_b128 v[92:95], v1 offset:23552
    s_waitcnt lgkmcnt(6)
    v_mfma_f32_16x16x32_bf16 v[44:47], v[104:107], a[204:207], v[44:47]
    ds_read_b128 v[96:99], v1 offset:24576
    v_mfma_f32_16x16x32_bf16 v[48:51], v[108:111], a[204:207], v[48:51]
    ds_read_b128 v[100:103], v1 offset:25600
    buffer_load_dwordx4 v1, s[4:7], s75 offen offset:2048 lds
    s_waitcnt lgkmcnt(6)
    v_mfma_f32_16x16x32_bf16 v[52:55], v[112:115], a[204:207], v[52:55]
    ds_read_b128 v[104:107], v1 offset:26624
    v_mfma_f32_16x16x32_bf16 v[56:59], v[116:119], a[204:207], v[56:59]
    ds_read_b128 v[108:111], v1 offset:27648
    buffer_load_dwordx4 v1, s[4:7], s75 offen offset:3072 lds
    s_waitcnt vmcnt(19)
    s_waitcnt lgkmcnt(6)
    v_mfma_f32_16x16x32_bf16 v[40:43], v[80:83], a[208:211], v[40:43]
    ds_read_b128 v[112:115], v1 offset:28672
    v_mfma_f32_16x16x32_bf16 v[44:47], v[84:87], a[208:211], v[44:47]
    ds_read_b128 v[116:119], v1 offset:29696
    s_waitcnt lgkmcnt(6)
    v_mfma_f32_16x16x32_bf16 v[48:51], v[88:91], a[208:211], v[48:51]
    ds_read_b128 v[80:83], v1 offset:30720
    s_add_u32 m0, s60, 86016
    s_add_u32 s75, s75, 4096
    buffer_load_dwordx4 v1, s[4:7], s75 offen lds
    v_mfma_f32_16x16x32_bf16 v[52:55], v[92:95], a[208:211], v[52:55]
    ds_read_b128 v[84:87], v1 offset:31744
    s_waitcnt lgkmcnt(6)
    v_mfma_f32_16x16x32_bf16 v[56:59], v[96:99], a[208:211], v[56:59]
    ds_read_b128 v[88:91], v1 offset:32768
    s_waitcnt vmcnt(19)
    v_mfma_f32_16x16x32_bf16 v[40:43], v[100:103], a[212:215], v[40:43]
    ds_read_b128 v[92:95], v1 offset:33792
    s_cmp_eq_u32 s92, s94
    s_cselect_b32 s75, s63, s92
    s_add_u32 s92, s92, 20480
    s_cmp_eq_u32 s92, s93
    s_cselect_b32 s92, s62, s92
    s_add_u32 m0, s60, 102400
    s_nop 0
    buffer_load_dwordx4 v1, s[4:7], s75 offen offset:0 lds
    s_waitcnt lgkmcnt(6)
    v_mfma_f32_16x16x32_bf16 v[44:47], v[104:107], a[212:215], v[44:47]
    ds_read_b128 v[96:99], v1 offset:34816
    s_lshl_b32 s25, s30, 10
    v_mfma_f32_16x16x32_bf16 v[48:51], v[108:111], a[212:215], v[48:51]
    ds_read_b128 v[100:103], v1 offset:35840
    buffer_load_dwordx4 v1, s[4:7], s75 offen offset:1024 lds
    s_waitcnt lgkmcnt(6)
    v_mfma_f32_16x16x32_bf16 v[52:55], v[112:115], a[212:215], v[52:55]
    ds_read_b128 v[104:107], v1 offset:36864
    s_add_u32 s25, s25, 156672
    v_mfma_f32_16x16x32_bf16 v[56:59], v[116:119], a[212:215], v[56:59]
    ds_read_b128 v[108:111], v1 offset:37888
    v_add_u32 v132, s25, v1
    s_waitcnt vmcnt(20)
    s_waitcnt lgkmcnt(6)
    v_mfma_f32_16x16x32_bf16 v[40:43], v[80:83], a[216:219], v[40:43]
    ds_read_b128 v[112:115], v1 offset:38912
    buffer_load_dwordx4 v1, s[4:7], s75 offen offset:2048 lds
    v_mfma_f32_16x16x32_bf16 v[44:47], v[84:87], a[216:219], v[44:47]
    ds_read_b128 v[116:119], v1 offset:39936
    ds_read_b128 v[128:131], v132
    s_waitcnt lgkmcnt(6)
    v_mfma_f32_16x16x32_bf16 v[48:51], v[88:91], a[216:219], v[48:51]
    s_waitcnt lgkmcnt(0)
    s_barrier
    ds_read_b128 v[80:83], v1 offset:40960
    buffer_load_dwordx4 v1, s[4:7], s75 offen offset:3072 lds
    v_mfma_f32_16x16x32_bf16 v[52:55], v[92:95], a[216:219], v[52:55]
    ds_read_b128 v[84:87], v1 offset:41984
    s_waitcnt lgkmcnt(6)
    v_mfma_f32_16x16x32_bf16 v[56:59], v[96:99], a[216:219], v[56:59]
    ds_read_b128 v[88:91], v1 offset:43008
    s_waitcnt vmcnt(21)
    v_mfma_f32_16x16x32_bf16 v[40:43], v[100:103], a[220:223], v[40:43]
    ds_read_b128 v[92:95], v1 offset:44032
    s_add_u32 m0, s60, 106496
    s_add_u32 s75, s75, 4096
    buffer_load_dwordx4 v1, s[4:7], s75 offen lds
    s_waitcnt lgkmcnt(6)
    v_mfma_f32_16x16x32_bf16 v[44:47], v[104:107], a[220:223], v[44:47]
    ds_read_b128 v[96:99], v1 offset:45056
    v_mfma_f32_16x16x32_bf16 v[48:51], v[108:111], a[220:223], v[48:51]
    ds_read_b128 v[100:103], v1 offset:46080
    s_waitcnt lgkmcnt(6)
    v_mfma_f32_16x16x32_bf16 v[52:55], v[112:115], a[220:223], v[52:55]
    ds_read_b128 v[104:107], v1 offset:47104
    s_cmp_eq_u32 s96, s98
    s_cselect_b32 s99, 0x40000000, s96
    buffer_load_dwordx4 a[176:179], v1, s[4:7], s96 offen offset:0 sc1
    v_mfma_f32_16x16x32_bf16 v[56:59], v[116:119], a[220:223], v[56:59]
    ds_read_b128 v[108:111], v1 offset:48128
    s_waitcnt vmcnt(22)
    s_waitcnt lgkmcnt(6)
    v_mfma_f32_16x16x32_bf16 v[40:43], v[80:83], a[224:227], v[40:43]
    ds_read_b128 v[112:115], v1 offset:49152
    buffer_load_dwordx4 a[180:183], v1, s[4:7], s96 offen offset:1024 sc1
    v_mfma_f32_16x16x32_bf16 v[44:47], v[84:87], a[224:227], v[44:47]
    ds_read_b128 v[116:119], v1 offset:50176
    s_waitcnt lgkmcnt(6)
    v_mfma_f32_16x16x32_bf16 v[48:51], v[88:91], a[224:227], v[48:51]
    ds_read_b128 v[80:83], v1 offset:51200
    v_mfma_f32_16x16x32_bf16 v[52:55], v[92:95], a[224:227], v[52:55]
    ds_read_b128 v[84:87], v1 offset:52224
    buffer_load_dwordx4 a[184:187], v1, s[4:7], s99 offen offset:2048 sc1
    s_waitcnt lgkmcnt(6)
    v_mfma_f32_16x16x32_bf16 v[56:59], v[96:99], a[224:227], v[56:59]
    ds_read_b128 v[88:91], v1 offset:53248
    s_waitcnt vmcnt(23)
    v_mfma_f32_16x16x32_bf16 v[40:43], v[100:103], a[228:231], v[40:43]
    ds_read_b128 v[92:95], v1 offset:54272
    buffer_load_dwordx4 a[188:191], v1, s[4:7], s99 offen offset:3072 sc1
    s_add_u32 s96, s96, 4096
    s_cmp_eq_u32 s96, s97
    s_cselect_b32 s96, s77, s96
    s_waitcnt lgkmcnt(6)
    v_mfma_f32_16x16x32_bf16 v[44:47], v[104:107], a[228:231], v[44:47]
    ds_read_b128 v[96:99], v1 offset:55296
    s_waitcnt lgkmcnt(0)
    v_mfma_f32_16x16x32_bf16 v[48:51], v[108:111], a[228:231], v[48:51]
    ds_read_b128 v[100:103], v1 offset:56320
    buffer_load_dword v255, v131, s[4:7], s37 offen
    s_waitcnt lgkmcnt(6)
    v_mfma_f32_16x16x32_bf16 v[52:55], v[112:115], a[228:231], v[52:55]
    ds_read_b128 v[104:107], v1 offset:57344
    s_cmp_eq_u32 s96, s98
    s_cselect_b32 s99, 0x40000000, s96
    buffer_load_dwordx4 a[192:195], v1, s[4:7], s96 offen offset:0 sc1
    v_mfma_f32_16x16x32_bf16 v[56:59], v[116:119], a[228:231], v[56:59]
    ds_read_b128 v[108:111], v1 offset:58368
    s_waitcnt vmcnt(25)
    s_waitcnt lgkmcnt(6)
    v_mfma_f32_16x16x32_bf16 v[40:43], v[80:83], a[232:235], v[40:43]
    ds_read_b128 v[112:115], v1 offset:59392
    v_mfma_f32_16x16x32_bf16 v[44:47], v[84:87], a[232:235], v[44:47]
    ds_read_b128 v[116:119], v1 offset:60416
    buffer_load_dwordx4 a[196:199], v1, s[4:7], s96 offen offset:1024 sc1
    s_waitcnt lgkmcnt(6)
    v_mfma_f32_16x16x32_bf16 v[48:51], v[88:91], a[232:235], v[48:51]
    ds_read_b128 v[80:83], v1 offset:61440
    v_mfma_f32_16x16x32_bf16 v[52:55], v[92:95], a[232:235], v[52:55]
    ds_read_b128 v[84:87], v1 offset:62464
    buffer_load_dwordx4 a[200:203], v1, s[4:7], s99 offen offset:2048 sc1
    s_waitcnt lgkmcnt(6)
    v_mfma_f32_16x16x32_bf16 v[56:59], v[96:99], a[232:235], v[56:59]
    ds_read_b128 v[88:91], v1 offset:63488
    s_waitcnt vmcnt(26)
    v_mfma_f32_16x16x32_bf16 v[40:43], v[100:103], a[236:239], v[40:43]
    ds_read_b128 v[92:95], v1 offset:64512
    s_waitcnt lgkmcnt(6)
    v_mfma_f32_16x16x32_bf16 v[44:47], v[104:107], a[236:239], v[44:47]
    ds_read_b128 v[96:99], v22 offset:0
    buffer_load_dwordx4 a[204:207], v1, s[4:7], s99 offen offset:3072 sc1
    s_add_u32 s96, s96, 4096
    s_cmp_eq_u32 s96, s97
    s_cselect_b32 s96, s77, s96
    v_mfma_f32_16x16x32_bf16 v[48:51], v[108:111], a[236:239], v[48:51]
    ds_read_b128 v[100:103], v22 offset:1024
    s_waitcnt lgkmcnt(6)
    v_mfma_f32_16x16x32_bf16 v[52:55], v[112:115], a[236:239], v[52:55]
    ds_read_b128 v[104:107], v22 offset:2048
    s_cmp_eq_u32 s92, s94
    s_cselect_b32 s75, s63, s92
    s_add_u32 s92, s92, 20480
    s_cmp_eq_u32 s92, s93
    s_cselect_b32 s92, s62, s92
    s_add_u32 m0, s60, 122880
    s_nop 0
    buffer_load_dwordx4 v1, s[4:7], s75 offen offset:0 lds
    v_mfma_f32_16x16x32_bf16 v[56:59], v[116:119], a[236:239], v[56:59]
    ds_read_b128 v[108:111], v22 offset:3072
    s_waitcnt vmcnt(27)
    s_waitcnt lgkmcnt(6)
    v_mfma_f32_16x16x32_bf16 v[40:43], v[80:83], a[240:243], v[40:43]
    ds_read_b128 v[112:115], v22 offset:4096
    v_mfma_f32_16x16x32_bf16 v[44:47], v[84:87], a[240:243], v[44:47]
    ds_read_b128 v[116:119], v22 offset:5120
    buffer_load_dwordx4 v1, s[4:7], s75 offen offset:1024 lds
    s_waitcnt lgkmcnt(6)
    v_mfma_f32_16x16x32_bf16 v[48:51], v[88:91], a[240:243], v[48:51]
    ds_read_b128 v[80:83], v22 offset:6144
    v_mfma_f32_16x16x32_bf16 v[52:55], v[92:95], a[240:243], v[52:55]
    ds_read_b128 v[84:87], v22 offset:7168
    s_waitcnt lgkmcnt(6)
    v_mfma_f32_16x16x32_bf16 v[56:59], v[96:99], a[240:243], v[56:59]
    ds_read_b128 v[88:91], v22 offset:8192
    buffer_load_dwordx4 v1, s[4:7], s75 offen offset:2048 lds
    s_waitcnt vmcnt(28)
    v_mfma_f32_16x16x32_bf16 v[40:43], v[100:103], a[244:247], v[40:43]
    ds_read_b128 v[92:95], v22 offset:9216
    s_waitcnt lgkmcnt(6)
    v_mfma_f32_16x16x32_bf16 v[44:47], v[104:107], a[244:247], v[44:47]
    ds_read_b128 v[96:99], v22 offset:10240
    buffer_load_dwordx4 v1, s[4:7], s75 offen offset:3072 lds
    v_mfma_f32_16x16x32_bf16 v[48:51], v[108:111], a[244:247], v[48:51]
    ds_read_b128 v[100:103], v22 offset:11264
    s_waitcnt lgkmcnt(6)
    v_mfma_f32_16x16x32_bf16 v[52:55], v[112:115], a[244:247], v[52:55]
    ds_read_b128 v[104:107], v22 offset:12288
    v_mfma_f32_16x16x32_bf16 v[56:59], v[116:119], a[244:247], v[56:59]
    ds_read_b128 v[108:111], v22 offset:13312
    s_add_u32 m0, s60, 126976
    s_add_u32 s75, s75, 4096
    buffer_load_dwordx4 v1, s[4:7], s75 offen lds
    s_waitcnt vmcnt(29)
    s_waitcnt lgkmcnt(6)
    v_mfma_f32_16x16x32_bf16 v[40:43], v[80:83], a[248:251], v[40:43]
    ds_read_b128 v[112:115], v22 offset:14336
    v_mfma_f32_16x16x32_bf16 v[44:47], v[84:87], a[248:251], v[44:47]
    ds_read_b128 v[116:119], v22 offset:15360
    s_cmp_eq_u32 s92, s94
    s_cselect_b32 s75, s63, s92
    s_add_u32 s92, s92, 20480
    s_cmp_eq_u32 s92, s93
    s_cselect_b32 s92, s62, s92
    s_add_u32 m0, s60, 0
    s_nop 0
    buffer_load_dwordx4 v1, s[4:7], s75 offen offset:0 lds
    s_waitcnt lgkmcnt(6)
    v_mfma_f32_16x16x32_bf16 v[48:51], v[88:91], a[248:251], v[48:51]
    s_waitcnt vmcnt(15)
    s_waitcnt lgkmcnt(0)
    s_barrier
    ds_read_b128 v[80:83], v22 offset:16384
    v_mfma_f32_16x16x32_bf16 v[52:55], v[92:95], a[248:251], v[52:55]
    ds_read_b128 v[84:87], v22 offset:17408
    s_waitcnt lgkmcnt(6)
    v_mfma_f32_16x16x32_bf16 v[56:59], v[96:99], a[248:251], v[56:59]
    ds_read_b128 v[88:91], v22 offset:18432
    buffer_load_dwordx4 v1, s[4:7], s75 offen offset:1024 lds
    v_mfma_f32_16x16x32_bf16 v[40:43], v[100:103], a[252:255], v[40:43]
    ds_read_b128 v[92:95], v22 offset:19456
    s_waitcnt lgkmcnt(6)
    v_mfma_f32_16x16x32_bf16 v[44:47], v[104:107], a[252:255], v[44:47]
    ds_read_b128 v[96:99], v22 offset:20480
    v_mfma_f32_16x16x32_bf16 v[48:51], v[108:111], a[252:255], v[48:51]
    ds_read_b128 v[100:103], v22 offset:21504
    buffer_load_dwordx4 v1, s[4:7], s75 offen offset:2048 lds
    s_waitcnt lgkmcnt(6)
    v_mfma_f32_16x16x32_bf16 v[52:55], v[112:115], a[252:255], v[52:55]
    ds_read_b128 v[104:107], v22 offset:22528
    v_mfma_f32_16x16x32_bf16 v[56:59], v[116:119], a[252:255], v[56:59]
    ds_read_b128 v[108:111], v22 offset:23552
    buffer_load_dwordx4 v1, s[4:7], s75 offen offset:3072 lds
    s_waitcnt lgkmcnt(6)
    v_mfma_f32_16x16x32_bf16 v[40:43], v[80:83], a[160:163], v[40:43]
    ds_read_b128 v[112:115], v22 offset:24576
    v_mfma_f32_16x16x32_bf16 v[44:47], v[84:87], a[160:163], v[44:47]
    ds_read_b128 v[116:119], v22 offset:25600
    s_waitcnt lgkmcnt(6)
    v_mfma_f32_16x16x32_bf16 v[48:51], v[88:91], a[160:163], v[48:51]
    ds_read_b128 v[80:83], v22 offset:26624
    s_add_u32 m0, s60, 4096
    s_add_u32 s75, s75, 4096
    buffer_load_dwordx4 v1, s[4:7], s75 offen lds
    v_mfma_f32_16x16x32_bf16 v[52:55], v[92:95], a[160:163], v[52:55]
    ds_read_b128 v[84:87], v22 offset:27648
    s_waitcnt lgkmcnt(6)
    v_mfma_f32_16x16x32_bf16 v[56:59], v[96:99], a[160:163], v[56:59]
    ds_read_b128 v[88:91], v22 offset:28672
    s_cmp_eq_u32 s96, s98
    s_cselect_b32 s99, 0x40000000, s96
    buffer_load_dwordx4 a[208:211], v1, s[4:7], s96 offen offset:0 sc1
    v_mfma_f32_16x16x32_bf16 v[40:43], v[100:103], a[164:167], v[40:43]
    ds_read_b128 v[92:95], v22 offset:29696
    s_waitcnt lgkmcnt(6)
    v_mfma_f32_16x16x32_bf16 v[44:47], v[104:107], a[164:167], v[44:47]
    ds_read_b128 v[96:99], v22 offset:30720
    v_mfma_f32_16x16x32_bf16 v[48:51], v[108:111], a[164:167], v[48:51]
    ds_read_b128 v[100:103], v22 offset:31744
    buffer_load_dwordx4 a[212:215], v1, s[4:7], s96 offen offset:1024 sc1
    s_waitcnt lgkmcnt(6)
    v_mfma_f32_16x16x32_bf16 v[52:55], v[112:115], a[164:167], v[52:55]
    ds_read_b128 v[104:107], v22 offset:32768
    v_mfma_f32_16x16x32_bf16 v[56:59], v[116:119], a[164:167], v[56:59]
    ds_read_b128 v[108:111], v22 offset:33792
    s_waitcnt lgkmcnt(6)
    v_mfma_f32_16x16x32_bf16 v[40:43], v[80:83], a[168:171], v[40:43]
    ds_read_b128 v[112:115], v22 offset:34816
    buffer_load_dwordx4 a[216:219], v1, s[4:7], s99 offen offset:2048 sc1
    v_mfma_f32_16x16x32_bf16 v[44:47], v[84:87], a[168:171], v[44:47]
    ds_read_b128 v[116:119], v22 offset:35840
    s_waitcnt lgkmcnt(6)
    v_mfma_f32_16x16x32_bf16 v[48:51], v[88:91], a[168:171], v[48:51]
    ds_read_b128 v[80:83], v22 offset:36864
    buffer_load_dwordx4 a[220:223], v1, s[4:7], s99 offen offset:3072 sc1
    s_add_u32 s96, s96, 4096
    s_cmp_eq_u32 s96, s97
    s_cselect_b32 s96, s77, s96
    v_mfma_f32_16x16x32_bf16 v[52:55], v[92:95], a[168:171], v[52:55]
    ds_read_b128 v[84:87], v22 offset:37888
    s_waitcnt lgkmcnt(6)
    v_mfma_f32_16x16x32_bf16 v[56:59], v[96:99], a[168:171], v[56:59]
    ds_read_b128 v[88:91], v22 offset:38912
    v_mfma_f32_16x16x32_bf16 v[40:43], v[100:103], a[172:175], v[40:43]
    ds_read_b128 v[92:95], v22 offset:39936
    s_cmp_eq_u32 s96, s98
    s_cselect_b32 s99, 0x40000000, s96
    buffer_load_dwordx4 a[224:227], v1, s[4:7], s96 offen offset:0 sc1
    s_waitcnt lgkmcnt(6)
    v_mfma_f32_16x16x32_bf16 v[44:47], v[104:107], a[172:175], v[44:47]
    ds_read_b128 v[96:99], v22 offset:40960
    v_mfma_f32_16x16x32_bf16 v[48:51], v[108:111], a[172:175], v[48:51]
    ds_read_b128 v[100:103], v22 offset:41984
    buffer_load_dwordx4 a[228:231], v1, s[4:7], s96 offen offset:1024 sc1
    s_waitcnt lgkmcnt(6)
    v_mfma_f32_16x16x32_bf16 v[52:55], v[112:115], a[172:175], v[52:55]
    ds_read_b128 v[104:107], v22 offset:43008
    v_mfma_f32_16x16x32_bf16 v[56:59], v[116:119], a[172:175], v[56:59]
    ds_read_b128 v[108:111], v22 offset:44032
    s_waitcnt vmcnt(24)
    s_waitcnt lgkmcnt(6)
    v_mfma_f32_16x16x32_bf16 v[40:43], v[80:83], a[176:179], v[40:43]
    ds_read_b128 v[112:115], v22 offset:45056
    buffer_load_dwordx4 a[232:235], v1, s[4:7], s99 offen offset:2048 sc1
    v_mfma_f32_16x16x32_bf16 v[44:47], v[84:87], a[176:179], v[44:47]
    ds_read_b128 v[116:119], v22 offset:46080
    s_waitcnt lgkmcnt(6)
    v_mfma_f32_16x16x32_bf16 v[48:51], v[88:91], a[176:179], v[48:51]
    ds_read_b128 v[80:83], v22 offset:47104
    v_mfma_f32_16x16x32_bf16 v[52:55], v[92:95], a[176:179], v[52:55]
    ds_read_b128 v[84:87], v22 offset:48128
    buffer_load_dwordx4 a[236:239], v1, s[4:7], s99 offen offset:3072 sc1
    s_add_u32 s96, s96, 4096
    s_cmp_eq_u32 s96, s97
    s_cselect_b32 s96, s77, s96
    s_waitcnt lgkmcnt(6)
    v_mfma_f32_16x16x32_bf16 v[56:59], v[96:99], a[176:179], v[56:59]
    ds_read_b128 v[88:91], v22 offset:49152
    s_waitcnt vmcnt(25)
    v_mfma_f32_16x16x32_bf16 v[40:43], v[100:103], a[180:183], v[40:43]
    ds_read_b128 v[92:95], v22 offset:50176
    s_cmp_eq_u32 s92, s94
    s_cselect_b32 s75, s63, s92
    s_add_u32 s92, s92, 20480
    s_cmp_eq_u32 s92, s93
    s_cselect_b32 s92, s62, s92
    s_add_u32 m0, s60, 20480
    s_nop 0
    buffer_load_dwordx4 v1, s[4:7], s75 offen offset:0 lds
    s_waitcnt lgkmcnt(6)
    v_mfma_f32_16x16x32_bf16 v[44:47], v[104:107], a[180:183], v[44:47]
    ds_read_b128 v[96:99], v22 offset:51200
    v_mfma_f32_16x16x32_bf16 v[48:51], v[108:111], a[180:183], v[48:51]
    ds_read_b128 v[100:103], v22 offset:52224
    s_waitcnt lgkmcnt(6)
    v_mfma_f32_16x16x32_bf16 v[52:55], v[112:115], a[180:183], v[52:55]
    ds_read_b128 v[104:107], v22 offset:53248
    buffer_load_dwordx4 v1, s[4:7], s75 offen offset:1024 lds
    v_mfma_f32_16x16x32_bf16 v[56:59], v[116:119], a[180:183], v[56:59]
    ds_read_b128 v[108:111], v22 offset:54272
    s_waitcnt vmcnt(26)
    s_waitcnt lgkmcnt(6)
    v_mfma_f32_16x16x32_bf16 v[40:43], v[80:83], a[184:187], v[40:43]
    ds_read_b128 v[112:115], v22 offset:55296
    buffer_load_dwordx4 v1, s[4:7], s75 offen offset:2048 lds
    v_mfma_f32_16x16x32_bf16 v[44:47], v[84:87], a[184:187], v[44:47]
    ds_read_b128 v[116:119], v22 offset:56320
    s_waitcnt lgkmcnt(6)
    v_mfma_f32_16x16x32_bf16 v[48:51], v[88:91], a[184:187], v[48:51]
    s_waitcnt vmcnt(11)
    s_waitcnt lgkmcnt(0)
    s_barrier
    ds_read_b128 v[80:83], v22 offset:57344
    v_mfma_f32_16x16x32_bf16 v[52:55], v[92:95], a[184:187], v[52:55]
    ds_read_b128 v[84:87], v22 offset:58368
    buffer_load_dwordx4 v1, s[4:7], s75 offen offset:3072 lds
    s_waitcnt lgkmcnt(6)
    v_mfma_f32_16x16x32_bf16 v[56:59], v[96:99], a[184:187], v[56:59]
    ds_read_b128 v[88:91], v22 offset:59392
    v_mfma_f32_16x16x32_bf16 v[40:43], v[100:103], a[188:191], v[40:43]
    ds_read_b128 v[92:95], v22 offset:60416
    s_waitcnt lgkmcnt(6)
    v_mfma_f32_16x16x32_bf16 v[44:47], v[104:107], a[188:191], v[44:47]
    ds_read_b128 v[96:99], v22 offset:61440
    s_add_u32 m0, s60, 24576
    s_add_u32 s75, s75, 4096
    buffer_load_dwordx4 v1, s[4:7], s75 offen lds
    v_mfma_f32_16x16x32_bf16 v[48:51], v[108:111], a[188:191], v[48:51]
    ds_read_b128 v[100:103], v22 offset:62464
    s_waitcnt lgkmcnt(6)
    v_mfma_f32_16x16x32_bf16 v[52:55], v[112:115], a[188:191], v[52:55]
    ds_read_b128 v[104:107], v22 offset:63488
    s_cmp_eq_u32 s92, s94
    s_cselect_b32 s75, s63, s92
    s_add_u32 s92, s92, 20480
    s_cmp_eq_u32 s92, s93
    s_cselect_b32 s92, s62, s92
    s_add_u32 m0, s60, 40960
    s_nop 0
    buffer_load_dwordx4 v1, s[4:7], s75 offen offset:0 lds
    v_mfma_f32_16x16x32_bf16 v[56:59], v[116:119], a[188:191], v[56:59]
    ds_read_b128 v[108:111], v22 offset:64512
    s_waitcnt lgkmcnt(6)
    v_mfma_f32_16x16x32_bf16 v[40:43], v[80:83], a[192:195], v[40:43]
    ds_read_b128 v[112:115], v23 offset:0
    v_mfma_f32_16x16x32_bf16 v[44:47], v[84:87], a[192:195], v[44:47]
    ds_read_b128 v[116:119], v23 offset:1024
    buffer_load_dwordx4 v1, s[4:7], s75 offen offset:1024 lds
    s_waitcnt lgkmcnt(6)
    v_mfma_f32_16x16x32_bf16 v[48:51], v[88:91], a[192:195], v[48:51]
    ds_read_b128 v[80:83], v23 offset:2048
    v_mfma_f32_16x16x32_bf16 v[52:55], v[92:95], a[192:195], v[52:55]
    ds_read_b128 v[84:87], v23 offset:3072
    buffer_load_dwordx4 v1, s[4:7], s75 offen offset:2048 lds
    s_waitcnt lgkmcnt(6)
    v_mfma_f32_16x16x32_bf16 v[56:59], v[96:99], a[192:195], v[56:59]
    ds_read_b128 v[88:91], v23 offset:4096
    v_mfma_f32_16x16x32_bf16 v[40:43], v[100:103], a[196:199], v[40:43]
    ds_read_b128 v[92:95], v23 offset:5120
    s_waitcnt lgkmcnt(6)
    v_mfma_f32_16x16x32_bf16 v[44:47], v[104:107], a[196:199], v[44:47]
    ds_read_b128 v[96:99], v23 offset:6144
    buffer_load_dwordx4 v1, s[4:7], s75 offen offset:3072 lds
    v_mfma_f32_16x16x32_bf16 v[48:51], v[108:111], a[196:199], v[48:51]
    ds_read_b128 v[100:103], v23 offset:7168
    s_waitcnt lgkmcnt(6)
    v_mfma_f32_16x16x32_bf16 v[52:55], v[112:115], a[196:199], v[52:55]
    ds_read_b128 v[104:107], v23 offset:8192
    v_mfma_f32_16x16x32_bf16 v[56:59], v[116:119], a[196:199], v[56:59]
    ds_read_b128 v[108:111], v23 offset:9216
    s_add_u32 m0, s60, 45056
    s_add_u32 s75, s75, 4096
    buffer_load_dwordx4 v1, s[4:7], s75 offen lds
    s_waitcnt lgkmcnt(6)
    v_mfma_f32_16x16x32_bf16 v[40:43], v[80:83], a[200:203], v[40:43]
    ds_read_b128 v[112:115], v23 offset:10240
    v_mfma_f32_16x16x32_bf16 v[44:47], v[84:87], a[200:203], v[44:47]
    ds_read_b128 v[116:119], v23 offset:11264
    s_cmp_eq_u32 s96, s98
    s_cselect_b32 s99, 0x40000000, s96
    buffer_load_dwordx4 a[240:243], v1, s[4:7], s96 offen offset:0 sc1
    s_waitcnt lgkmcnt(6)
    v_mfma_f32_16x16x32_bf16 v[48:51], v[88:91], a[200:203], v[48:51]
    ds_read_b128 v[80:83], v1 offset:0
    v_mfma_f32_16x16x32_bf16 v[52:55], v[92:95], a[200:203], v[52:55]
    ds_read_b128 v[84:87], v1 offset:1024
    s_waitcnt lgkmcnt(6)
    v_mfma_f32_16x16x32_bf16 v[56:59], v[96:99], a[200:203], v[56:59]
    ds_read_b128 v[88:91], v1 offset:2048
    buffer_load_dwordx4 a[244:247], v1, s[4:7], s96 offen offset:1024 sc1
    v_mfma_f32_16x16x32_bf16 v[40:43], v[100:103], a[204:207], v[40:43]
    ds_read_b128 v[92:95], v1 offset:3072
    s_waitcnt lgkmcnt(6)
    v_mfma_f32_16x16x32_bf16 v[44:47], v[104:107], a[204:207], v[44:47]
    ds_read_b128 v[96:99], v1 offset:4096
    buffer_load_dwordx4 a[248:251], v1, s[4:7], s99 offen offset:2048 sc1
    v_mfma_f32_16x16x32_bf16 v[48:51], v[108:111], a[204:207], v[48:51]
    ds_read_b128 v[100:103], v1 offset:5120
    s_waitcnt lgkmcnt(6)
    v_mfma_f32_16x16x32_bf16 v[52:55], v[112:115], a[204:207], v[52:55]
    ds_read_b128 v[104:107], v1 offset:6144
    v_mfma_f32_16x16x32_bf16 v[56:59], v[116:119], a[204:207], v[56:59]
    ds_read_b128 v[108:111], v1 offset:7168
    buffer_load_dwordx4 a[252:255], v1, s[4:7], s99 offen offset:3072 sc1
    s_add_u32 s96, s96, 4096
    s_cmp_eq_u32 s96, s97
    s_cselect_b32 s96, s77, s96
    s_waitcnt vmcnt(21)
    s_waitcnt lgkmcnt(6)
    v_mfma_f32_16x16x32_bf16 v[40:43], v[80:83], a[208:211], v[40:43]
    ds_read_b128 v[112:115], v1 offset:8192
    v_mfma_f32_16x16x32_bf16 v[44:47], v[84:87], a[208:211], v[44:47]
    ds_read_b128 v[116:119], v1 offset:9216
    s_waitcnt lgkmcnt(6)
    v_mfma_f32_16x16x32_bf16 v[48:51], v[88:91], a[208:211], v[48:51]
    ds_read_b128 v[80:83], v1 offset:10240
    s_cmp_eq_u32 s96, s98
    s_cselect_b32 s99, 0x40000000, s96
    buffer_load_dwordx4 a[160:163], v1, s[4:7], s96 offen offset:0 sc1
    v_mfma_f32_16x16x32_bf16 v[52:55], v[92:95], a[208:211], v[52:55]
    ds_read_b128 v[84:87], v1 offset:11264
    s_waitcnt lgkmcnt(6)
    v_mfma_f32_16x16x32_bf16 v[56:59], v[96:99], a[208:211], v[56:59]
    ds_read_b128 v[88:91], v1 offset:12288
    buffer_load_dwordx4 a[164:167], v1, s[4:7], s96 offen offset:1024 sc1
    s_waitcnt vmcnt(22)
    v_mfma_f32_16x16x32_bf16 v[40:43], v[100:103], a[212:215], v[40:43]
    ds_read_b128 v[92:95], v1 offset:13312
    s_waitcnt lgkmcnt(6)
    v_mfma_f32_16x16x32_bf16 v[44:47], v[104:107], a[212:215], v[44:47]
    ds_read_b128 v[96:99], v1 offset:14336
    v_mfma_f32_16x16x32_bf16 v[48:51], v[108:111], a[212:215], v[48:51]
    ds_read_b128 v[100:103], v1 offset:15360
    buffer_load_dwordx4 a[168:171], v1, s[4:7], s99 offen offset:2048 sc1
    s_waitcnt lgkmcnt(6)
    v_mfma_f32_16x16x32_bf16 v[52:55], v[112:115], a[212:215], v[52:55]
    ds_read_b128 v[104:107], v1 offset:16384
    v_mfma_f32_16x16x32_bf16 v[56:59], v[116:119], a[212:215], v[56:59]
    ds_read_b128 v[108:111], v1 offset:17408
    buffer_load_dwordx4 a[172:175], v1, s[4:7], s99 offen offset:3072 sc1
    s_add_u32 s96, s96, 4096
    s_cmp_eq_u32 s96, s97
    s_cselect_b32 s96, s77, s96
    s_waitcnt vmcnt(23)
    s_waitcnt lgkmcnt(6)
    v_mfma_f32_16x16x32_bf16 v[40:43], v[80:83], a[216:219], v[40:43]
    ds_read_b128 v[112:115], v1 offset:18432
    v_mfma_f32_16x16x32_bf16 v[44:47], v[84:87], a[216:219], v[44:47]
    ds_read_b128 v[116:119], v1 offset:19456
    s_waitcnt lgkmcnt(6)
    v_mfma_f32_16x16x32_bf16 v[48:51], v[88:91], a[216:219], v[48:51]
    s_waitcnt vmcnt(8)
    s_waitcnt lgkmcnt(0)
    s_barrier
    ds_read_b128 v[80:83], v1 offset:20480
    s_cmp_eq_u32 s92, s94
    s_cselect_b32 s75, s63, s92
    s_add_u32 s92, s92, 20480
    s_cmp_eq_u32 s92, s93
    s_cselect_b32 s92, s62, s92
    s_add_u32 m0, s60, 61440
    s_nop 0
    buffer_load_dwordx4 v1, s[4:7], s75 offen offset:0 lds
    v_mfma_f32_16x16x32_bf16 v[52:55], v[92:95], a[216:219], v[52:55]
    ds_read_b128 v[84:87], v1 offset:21504
    s_waitcnt lgkmcnt(6)
    v_mfma_f32_16x16x32_bf16 v[56:59], v[96:99], a[216:219], v[56:59]
    ds_read_b128 v[88:91], v1 offset:22528
    v_mfma_f32_16x16x32_bf16 v[40:43], v[100:103], a[220:223], v[40:43]
    ds_read_b128 v[92:95], v1 offset:23552
    buffer_load_dwordx4 v1, s[4:7], s75 offen offset:1024 lds
    s_waitcnt lgkmcnt(6)
    v_mfma_f32_16x16x32_bf16 v[44:47], v[104:107], a[220:223], v[44:47]
    ds_read_b128 v[96:99], v1 offset:24576
    v_mfma_f32_16x16x32_bf16 v[48:51], v[108:111], a[220:223], v[48:51]
    ds_read_b128 v[100:103], v1 offset:25600
    buffer_load_dwordx4 v1, s[4:7], s75 offen offset:2048 lds
    s_waitcnt lgkmcnt(6)
    v_mfma_f32_16x16x32_bf16 v[52:55], v[112:115], a[220:223], v[52:55]
    ds_read_b128 v[104:107], v1 offset:26624
    v_mfma_f32_16x16x32_bf16 v[56:59], v[116:119], a[220:223], v[56:59]
    ds_read_b128 v[108:111], v1 offset:27648
    s_waitcnt lgkmcnt(6)
    v_mfma_f32_16x16x32_bf16 v[40:43], v[80:83], a[224:227], v[40:43]
    ds_read_b128 v[112:115], v1 offset:28672
    buffer_load_dwordx4 v1, s[4:7], s75 offen offset:3072 lds
    v_mfma_f32_16x16x32_bf16 v[44:47], v[84:87], a[224:227], v[44:47]
    ds_read_b128 v[116:119], v1 offset:29696
    s_waitcnt lgkmcnt(6)
    v_mfma_f32_16x16x32_bf16 v[48:51], v[88:91], a[224:227], v[48:51]
    ds_read_b128 v[80:83], v1 offset:30720
    s_add_u32 m0, s60, 65536
    s_add_u32 s75, s75, 4096
    buffer_load_dwordx4 v1, s[4:7], s75 offen lds
    v_mfma_f32_16x16x32_bf16 v[52:55], v[92:95], a[224:227], v[52:55]
    ds_read_b128 v[84:87], v1 offset:31744
    s_waitcnt lgkmcnt(6)
    v_mfma_f32_16x16x32_bf16 v[56:59], v[96:99], a[224:227], v[56:59]
    ds_read_b128 v[88:91], v1 offset:32768
    v_mfma_f32_16x16x32_bf16 v[40:43], v[100:103], a[228:231], v[40:43]
    ds_read_b128 v[92:95], v1 offset:33792
    s_cmp_eq_u32 s92, s94
    s_cselect_b32 s75, s63, s92
    s_add_u32 s92, s92, 20480
    s_cmp_eq_u32 s92, s93
    s_cselect_b32 s92, s62, s92
    s_add_u32 m0, s60, 81920
    s_nop 0
    buffer_load_dwordx4 v1, s[4:7], s75 offen offset:0 lds
    s_waitcnt lgkmcnt(6)
    v_mfma_f32_16x16x32_bf16 v[44:47], v[104:107], a[228:231], v[44:47]
    ds_read_b128 v[96:99], v1 offset:34816
    v_mfma_f32_16x16x32_bf16 v[48:51], v[108:111], a[228:231], v[48:51]
    ds_read_b128 v[100:103], v1 offset:35840
    s_waitcnt lgkmcnt(6)
    v_mfma_f32_16x16x32_bf16 v[52:55], v[112:115], a[228:231], v[52:55]
    ds_read_b128 v[104:107], v1 offset:36864
    buffer_load_dwordx4 v1, s[4:7], s75 offen offset:1024 lds
    v_mfma_f32_16x16x32_bf16 v[56:59], v[116:119], a[228:231], v[56:59]
    ds_read_b128 v[108:111], v1 offset:37888
    s_waitcnt lgkmcnt(6)
    v_mfma_f32_16x16x32_bf16 v[40:43], v[80:83], a[232:235], v[40:43]
    ds_read_b128 v[112:115], v1 offset:38912
    buffer_load_dwordx4 v1, s[4:7], s75 offen offset:2048 lds
    v_mfma_f32_16x16x32_bf16 v[44:47], v[84:87], a[232:235], v[44:47]
    ds_read_b128 v[116:119], v1 offset:39936
    buffer_load_dwordx4 v1, s[4:7], s75 offen offset:3072 lds
    s_waitcnt lgkmcnt(6)
    v_mfma_f32_16x16x32_bf16 v[48:51], v[88:91], a[232:235], v[48:51]
    ds_read_b128 v[80:83], v1 offset:40960
    s_add_u32 m0, s60, 86016
    s_add_u32 s75, s75, 4096
    buffer_load_dwordx4 v1, s[4:7], s75 offen lds
    v_mfma_f32_16x16x32_bf16 v[52:55], v[92:95], a[232:235], v[52:55]
    ds_read_b128 v[84:87], v1 offset:41984
    s_waitcnt lgkmcnt(6)
    v_mfma_f32_16x16x32_bf16 v[56:59], v[96:99], a[232:235], v[56:59]
    ds_read_b128 v[88:91], v1 offset:43008
    v_mfma_f32_16x16x32_bf16 v[40:43], v[100:103], a[236:239], v[40:43]
    ds_read_b128 v[92:95], v1 offset:44032
    s_cmp_eq_u32 s96, s98
    s_cselect_b32 s99, 0x40000000, s96
    buffer_load_dwordx4 a[176:179], v1, s[4:7], s96 offen offset:0 sc1
    s_waitcnt lgkmcnt(6)
    v_mfma_f32_16x16x32_bf16 v[44:47], v[104:107], a[236:239], v[44:47]
    ds_read_b128 v[96:99], v1 offset:45056
    v_mfma_f32_16x16x32_bf16 v[48:51], v[108:111], a[236:239], v[48:51]
    ds_read_b128 v[100:103], v1 offset:46080
    s_waitcnt lgkmcnt(6)
    v_mfma_f32_16x16x32_bf16 v[52:55], v[112:115], a[236:239], v[52:55]
    ds_read_b128 v[104:107], v1 offset:47104
    buffer_load_dwordx4 a[180:183], v1, s[4:7], s96 offen offset:1024 sc1
    v_mfma_f32_16x16x32_bf16 v[56:59], v[116:119], a[236:239], v[56:59]
    ds_read_b128 v[108:111], v1 offset:48128
    s_waitcnt vmcnt(19)
    s_waitcnt lgkmcnt(6)
    v_mfma_f32_16x16x32_bf16 v[40:43], v[80:83], a[240:243], v[40:43]
    ds_read_b128 v[112:115], v1 offset:49152
    buffer_load_dwordx4 a[184:187], v1, s[4:7], s99 offen offset:2048 sc1
    v_mfma_f32_16x16x32_bf16 v[44:47], v[84:87], a[240:243], v[44:47]
    ds_read_b128 v[116:119], v1 offset:50176
    s_waitcnt lgkmcnt(6)
    v_mfma_f32_16x16x32_bf16 v[48:51], v[88:91], a[240:243], v[48:51]
    ds_read_b128 v[80:83], v1 offset:51200
    v_mfma_f32_16x16x32_bf16 v[52:55], v[92:95], a[240:243], v[52:55]
    ds_read_b128 v[84:87], v1 offset:52224
    buffer_load_dwordx4 a[188:191], v1, s[4:7], s99 offen offset:3072 sc1
    s_add_u32 s96, s96, 4096
    s_cmp_eq_u32 s96, s97
    s_cselect_b32 s96, s77, s96
    s_waitcnt lgkmcnt(6)
    v_mfma_f32_16x16x32_bf16 v[56:59], v[96:99], a[240:243], v[56:59]
    ds_read_b128 v[88:91], v1 offset:53248
    s_waitcnt vmcnt(20)
    v_mfma_f32_16x16x32_bf16 v[40:43], v[100:103], a[244:247], v[40:43]
    ds_read_b128 v[92:95], v1 offset:54272
    s_waitcnt lgkmcnt(6)
    v_mfma_f32_16x16x32_bf16 v[44:47], v[104:107], a[244:247], v[44:47]
    ds_read_b128 v[96:99], v1 offset:55296
    v_mfma_f32_16x16x32_bf16 v[48:51], v[108:111], a[244:247], v[48:51]
    ds_read_b128 v[100:103], v1 offset:56320
    s_waitcnt lgkmcnt(6)
    v_mfma_f32_16x16x32_bf16 v[52:55], v[112:115], a[244:247], v[52:55]
    ds_read_b128 v[104:107], v1 offset:57344
    v_mfma_f32_16x16x32_bf16 v[56:59], v[116:119], a[244:247], v[56:59]
    ds_read_b128 v[108:111], v1 offset:58368
    s_waitcnt vmcnt(19)
    s_waitcnt lgkmcnt(6)
    v_mfma_f32_16x16x32_bf16 v[40:43], v[80:83], a[248:251], v[40:43]
    ds_read_b128 v[112:115], v1 offset:59392
    v_mfma_f32_16x16x32_bf16 v[44:47], v[84:87], a[248:251], v[44:47]
    ds_read_b128 v[116:119], v1 offset:60416
    s_waitcnt lgkmcnt(6)
    v_mfma_f32_16x16x32_bf16 v[48:51], v[88:91], a[248:251], v[48:51]
    s_waitcnt vmcnt(4)
    s_waitcnt lgkmcnt(0)
    s_barrier
    ds_read_b128 v[80:83], v1 offset:61440
    v_mfma_f32_16x16x32_bf16 v[52:55], v[92:95], a[248:251], v[52:55]
    ds_read_b128 v[84:87], v1 offset:62464
    s_waitcnt lgkmcnt(6)
    v_mfma_f32_16x16x32_bf16 v[56:59], v[96:99], a[248:251], v[56:59]
    ds_read_b128 v[88:91], v1 offset:63488
    v_mfma_f32_16x16x32_bf16 v[40:43], v[100:103], a[252:255], v[40:43]
    ds_read_b128 v[92:95], v1 offset:64512
    s_waitcnt lgkmcnt(6)
    v_mfma_f32_16x16x32_bf16 v[44:47], v[104:107], a[252:255], v[44:47]
    ds_read_b128 v[96:99], v22 offset:0
    v_mfma_f32_16x16x32_bf16 v[48:51], v[108:111], a[252:255], v[48:51]
    ds_read_b128 v[100:103], v22 offset:1024
    s_waitcnt lgkmcnt(6)
    v_mfma_f32_16x16x32_bf16 v[52:55], v[112:115], a[252:255], v[52:55]
    ds_read_b128 v[104:107], v22 offset:2048
    v_mfma_f32_16x16x32_bf16 v[56:59], v[116:119], a[252:255], v[56:59]
    ds_read_b128 v[108:111], v22 offset:3072
    s_waitcnt lgkmcnt(6)
    v_mfma_f32_16x16x32_bf16 v[40:43], v[80:83], a[160:163], v[40:43]
    ds_read_b128 v[112:115], v22 offset:4096
    v_mfma_f32_16x16x32_bf16 v[44:47], v[84:87], a[160:163], v[44:47]
    ds_read_b128 v[116:119], v22 offset:5120
    s_waitcnt lgkmcnt(6)
    v_mfma_f32_16x16x32_bf16 v[48:51], v[88:91], a[160:163], v[48:51]
    ds_read_b128 v[80:83], v22 offset:6144
    v_mfma_f32_16x16x32_bf16 v[52:55], v[92:95], a[160:163], v[52:55]
    ds_read_b128 v[84:87], v22 offset:7168
    s_waitcnt lgkmcnt(6)
    v_mfma_f32_16x16x32_bf16 v[56:59], v[96:99], a[160:163], v[56:59]
    ds_read_b128 v[88:91], v22 offset:8192
    v_mfma_f32_16x16x32_bf16 v[40:43], v[100:103], a[164:167], v[40:43]
    ds_read_b128 v[92:95], v22 offset:9216
    s_waitcnt lgkmcnt(6)
    v_mfma_f32_16x16x32_bf16 v[44:47], v[104:107], a[164:167], v[44:47]
    ds_read_b128 v[96:99], v22 offset:10240
    v_mfma_f32_16x16x32_bf16 v[48:51], v[108:111], a[164:167], v[48:51]
    ds_read_b128 v[100:103], v22 offset:11264
    s_waitcnt lgkmcnt(6)
    v_mfma_f32_16x16x32_bf16 v[52:55], v[112:115], a[164:167], v[52:55]
    ds_read_b128 v[104:107], v22 offset:12288
    v_mfma_f32_16x16x32_bf16 v[56:59], v[116:119], a[164:167], v[56:59]
    ds_read_b128 v[108:111], v22 offset:13312
    s_waitcnt lgkmcnt(6)
    v_mfma_f32_16x16x32_bf16 v[40:43], v[80:83], a[168:171], v[40:43]
    ds_read_b128 v[112:115], v22 offset:14336
    v_mfma_f32_16x16x32_bf16 v[44:47], v[84:87], a[168:171], v[44:47]
    ds_read_b128 v[116:119], v22 offset:15360
    s_waitcnt lgkmcnt(6)
    v_mfma_f32_16x16x32_bf16 v[48:51], v[88:91], a[168:171], v[48:51]
    ds_read_b128 v[80:83], v22 offset:16384
    v_mfma_f32_16x16x32_bf16 v[52:55], v[92:95], a[168:171], v[52:55]
    ds_read_b128 v[84:87], v22 offset:17408
    s_waitcnt lgkmcnt(6)
    v_mfma_f32_16x16x32_bf16 v[56:59], v[96:99], a[168:171], v[56:59]
    ds_read_b128 v[88:91], v22 offset:18432
    v_mfma_f32_16x16x32_bf16 v[40:43], v[100:103], a[172:175], v[40:43]
    ds_read_b128 v[92:95], v22 offset:19456
    s_waitcnt lgkmcnt(6)
    v_mfma_f32_16x16x32_bf16 v[44:47], v[104:107], a[172:175], v[44:47]
    ds_read_b128 v[96:99], v22 offset:20480
    v_mfma_f32_16x16x32_bf16 v[48:51], v[108:111], a[172:175], v[48:51]
    ds_read_b128 v[100:103], v22 offset:21504
    s_waitcnt lgkmcnt(6)
    v_mfma_f32_16x16x32_bf16 v[52:55], v[112:115], a[172:175], v[52:55]
    ds_read_b128 v[104:107], v22 offset:22528
    v_mfma_f32_16x16x32_bf16 v[56:59], v[116:119], a[172:175], v[56:59]
    ds_read_b128 v[108:111], v22 offset:23552
    s_waitcnt vmcnt(3)
    s_waitcnt lgkmcnt(6)
    v_mfma_f32_16x16x32_bf16 v[40:43], v[80:83], a[176:179], v[40:43]
    ds_read_b128 v[112:115], v22 offset:24576
    v_mfma_f32_16x16x32_bf16 v[44:47], v[84:87], a[176:179], v[44:47]
    ds_read_b128 v[116:119], v22 offset:25600
    s_waitcnt lgkmcnt(6)
    v_mfma_f32_16x16x32_bf16 v[48:51], v[88:91], a[176:179], v[48:51]
    ds_read_b128 v[80:83], v22 offset:26624
    v_mfma_f32_16x16x32_bf16 v[52:55], v[92:95], a[176:179], v[52:55]
    ds_read_b128 v[84:87], v22 offset:27648
    s_waitcnt lgkmcnt(6)
    v_mfma_f32_16x16x32_bf16 v[56:59], v[96:99], a[176:179], v[56:59]
    ds_read_b128 v[88:91], v22 offset:28672
    s_waitcnt vmcnt(2)
    v_mfma_f32_16x16x32_bf16 v[40:43], v[100:103], a[180:183], v[40:43]
    ds_read_b128 v[92:95], v22 offset:29696
    s_waitcnt lgkmcnt(6)
    v_mfma_f32_16x16x32_bf16 v[44:47], v[104:107], a[180:183], v[44:47]
    ds_read_b128 v[96:99], v22 offset:30720
    v_mfma_f32_16x16x32_bf16 v[48:51], v[108:111], a[180:183], v[48:51]
    ds_read_b128 v[100:103], v22 offset:31744
    s_waitcnt lgkmcnt(6)
    v_mfma_f32_16x16x32_bf16 v[52:55], v[112:115], a[180:183], v[52:55]
    ds_read_b128 v[104:107], v22 offset:32768
    v_mfma_f32_16x16x32_bf16 v[56:59], v[116:119], a[180:183], v[56:59]
    ds_read_b128 v[108:111], v22 offset:33792
    s_waitcnt vmcnt(1)
    s_waitcnt lgkmcnt(6)
    v_mfma_f32_16x16x32_bf16 v[40:43], v[80:83], a[184:187], v[40:43]
    ds_read_b128 v[112:115], v22 offset:34816
    v_mfma_f32_16x16x32_bf16 v[44:47], v[84:87], a[184:187], v[44:47]
    ds_read_b128 v[116:119], v22 offset:35840
    s_waitcnt lgkmcnt(6)
    v_mfma_f32_16x16x32_bf16 v[48:51], v[88:91], a[184:187], v[48:51]
    v_mfma_f32_16x16x32_bf16 v[52:55], v[92:95], a[184:187], v[52:55]
    s_waitcnt lgkmcnt(4)
    v_mfma_f32_16x16x32_bf16 v[56:59], v[96:99], a[184:187], v[56:59]
    s_waitcnt vmcnt(0)
    v_mfma_f32_16x16x32_bf16 v[40:43], v[100:103], a[188:191], v[40:43]
    s_waitcnt lgkmcnt(2)
    v_mfma_f32_16x16x32_bf16 v[44:47], v[104:107], a[188:191], v[44:47]
    v_mfma_f32_16x16x32_bf16 v[48:51], v[108:111], a[188:191], v[48:51]
    s_waitcnt lgkmcnt(0)
    v_mfma_f32_16x16x32_bf16 v[52:55], v[112:115], a[188:191], v[52:55]
    s_waitcnt lgkmcnt(0)
    v_mfma_f32_16x16x32_bf16 v[56:59], v[116:119], a[188:191], v[56:59]
    v_lshlrev_b32 v24, 16, v2
    v_and_b32 v25, 0xffff0000, v2
    v_pk_add_f32 v[40:41], v[40:41], v[24:25]
    v_lshlrev_b32 v26, 16, v3
    v_and_b32 v27, 0xffff0000, v3
    v_pk_add_f32 v[42:43], v[42:43], v[26:27]
    v_lshlrev_b32 v28, 16, v4
    v_and_b32 v29, 0xffff0000, v4
    v_pk_add_f32 v[44:45], v[44:45], v[28:29]
    v_lshlrev_b32 v30, 16, v5
    v_and_b32 v31, 0xffff0000, v5
    v_pk_add_f32 v[46:47], v[46:47], v[30:31]
    v_lshlrev_b32 v24, 16, v6
    v_and_b32 v25, 0xffff0000, v6
    v_pk_add_f32 v[48:49], v[48:49], v[24:25]
    v_lshlrev_b32 v26, 16, v7
    v_and_b32 v27, 0xffff0000, v7
    v_pk_add_f32 v[50:51], v[50:51], v[26:27]
    v_lshlrev_b32 v28, 16, v8
    v_and_b32 v29, 0xffff0000, v8
    v_pk_add_f32 v[52:53], v[52:53], v[28:29]
    v_lshlrev_b32 v30, 16, v9
    v_and_b32 v31, 0xffff0000, v9
    v_pk_add_f32 v[54:55], v[54:55], v[30:31]
    v_lshlrev_b32 v24, 16, v10
    v_and_b32 v25, 0xffff0000, v10
    v_pk_add_f32 v[56:57], v[56:57], v[24:25]
    v_lshlrev_b32 v26, 16, v11
    v_and_b32 v27, 0xffff0000, v11
    v_pk_add_f32 v[58:59], v[58:59], v[26:27]
    v_cvt_pk_bf16_f32 v2, v40, v41
    v_cvt_pk_bf16_f32 v3, v42, v43
    v_cvt_pk_bf16_f32 v4, v44, v45
    v_cvt_pk_bf16_f32 v5, v46, v47
    v_cvt_pk_bf16_f32 v6, v48, v49
    v_cvt_pk_bf16_f32 v7, v50, v51
    v_cvt_pk_bf16_f32 v8, v52, v53
    v_cvt_pk_bf16_f32 v9, v54, v55
    v_cvt_pk_bf16_f32 v10, v56, v57
    v_cvt_pk_bf16_f32 v11, v58, v59
    s_cmp_eq_u32 s35, 1
    s_cbranch_scc1 FO_33
    s_mul_i32 s75, s36, 3457024
    s_add_u32 s75, s75, s37
    s_add_u32 s76, s75, s70
    s_add_u32 s76, s76, 3440640
    s_add_u32 s75, s75, s69
    s_add_u32 s75, s75, 3112960
    buffer_store_dwordx2 v[2:3], v125, s[4:7], s75 offen offset:0
    buffer_store_dwordx2 v[4:5], v125, s[4:7], s75 offen offset:1024
    buffer_store_dwordx2 v[6:7], v125, s[4:7], s75 offen offset:2048
    buffer_store_dwordx2 v[8:9], v125, s[4:7], s75 offen offset:3072
    s_add_u32 s78, s75, 4096
    buffer_store_dwordx2 v[10:11], v125, s[4:7], s78 offen
    v_mov_b32 v34, 0x3f803f80
    v_mov_b32 v32, 0
    v_mov_b32 v33, 0
    v_mov_b32 v37, 0
    v_mov_b32 v38, 0
    v_dot2_f32_bf16 v32, v2, v34, v32
    v_dot2_f32_bf16 v33, v2, v2, v33
    v_dot2_f32_bf16 v37, v3, v34, v37
    v_dot2_f32_bf16 v38, v3, v3, v38
    v_dot2_f32_bf16 v32, v4, v34, v32
    v_dot2_f32_bf16 v33, v4, v4, v33
    v_dot2_f32_bf16 v37, v5, v34, v37
    v_dot2_f32_bf16 v38, v5, v5, v38
    v_dot2_f32_bf16 v32, v6, v34, v32
    v_dot2_f32_bf16 v33, v6, v6, v33
    v_dot2_f32_bf16 v37, v7, v34, v37
    v_dot2_f32_bf16 v38, v7, v7, v38
    v_dot2_f32_bf16 v32, v8, v34, v32
    v_dot2_f32_bf16 v33, v8, v8, v33
    v_dot2_f32_bf16 v37, v9, v34, v37
    v_dot2_f32_bf16 v38, v9, v9, v38
    v_dot2_f32_bf16 v32, v10, v34, v32
    v_dot2_f32_bf16 v33, v10, v10, v33
    v_dot2_f32_bf16 v37, v11, v34, v37
    v_dot2_f32_bf16 v38, v11, v11, v38
    s_nop 1
    v_add_f32 v32, v32, v37
    v_add_f32 v33, v33, v38
    v_mov_b32 v35, v32
    v_mov_b32 v36, v33
    s_nop 0
    v_permlane32_swap_b32 v32, v35
    v_permlane32_swap_b32 v33, v36
    v_add_f32 v32, v32, v35
    v_add_f32 v33, v33, v36
    v_mov_b32 v35, v32
    v_mov_b32 v36, v33
    s_nop 0
    v_permlane16_swap_b32 v32, v35
    v_permlane16_swap_b32 v33, v36
    v_add_f32 v32, v32, v35
    v_add_f32 v33, v33, v36
    v_and_b32 v24, 15, v0
    v_lshlrev_b32 v24, 3, v24
    s_mov_b32 exec_lo, 0xffff
    s_mov_b32 exec_hi, 0x0
    buffer_store_dwordx2 v[32:33], v24, s[4:7], s76 offen
    s_mov_b64 exec, -1
    s_lshl_b32 s75, s33, 2
    s_add_u32 s75, s75, s30
    s_cmp_eq_u32 s75, 15
    s_cbranch_scc0 FN_34
    s_mul_i32 s75, s34, 2560
    s_add_u32 s75, s75, s37
    s_add_u32 s75, s75, 6930432
    v_lshrrev_b32 v26, 4, v0
    v_and_b32 v27, 15, v0
    v_lshrrev_b32 v28, 1, v26
    v_lshlrev_b32 v28, 8, v28
    v_and_b32 v26, 1, v26
    v_lshlrev_b32 v26, 3, v26
    v_lshlrev_b32 v27, 4, v27
    v_add_u32 v26, v26, v27
    v_add_u32 v26, v26, v28
    buffer_store_dwordx2 v[2:3], v26, s[4:7], s75 offen offset:0 sc1
    buffer_store_dwordx2 v[4:5], v26, s[4:7], s75 offen offset:512 sc1
    buffer_store_dwordx2 v[6:7], v26, s[4:7], s75 offen offset:1024 sc1
    buffer_store_dwordx2 v[8:9], v26, s[4:7], s75 offen offset:1536 sc1
    buffer_store_dwordx2 v[10:11], v26, s[4:7], s75 offen offset:2048 sc1
    s_lshl_b32 s75, s34, 7
    s_add_u32 s75, s75, s37
    s_add_u32 s75, s75, 6950912
    s_mov_b32 exec_lo, 0xffff
    s_mov_b32 exec_hi, 0x0
    buffer_store_dwordx2 v[32:33], v24, s[4:7], s75 offen sc1
    s_mov_b64 exec, -1
FN_34:
    v_and_b32 v24, 15, v0
    v_lshrrev_b32 v25, 4, v0
    v_lshrrev_b32 v26, 1, v25
    v_lshlrev_b32 v26, 10, v26
    v_and_b32 v25, 1, v25
    v_lshlrev_b32 v25, 9, v25
    v_lshlrev_b32 v172, 4, v24
    v_add_u32 v172, v172, v25
    v_add_u32 v172, v172, v26
    v_add_u32 v173, 256, v172
    s_mul_i32 s79, s36, 3457024
    s_add_u32 s79, s79, s37
    s_add_u32 s79, s79, 3112960
    s_add_u32 s79, s79, s71
    s_lshl_b32 s80, s30, 11
    s_add_u32 s80, s80, 65536
    s_barrier
    s_lshl_b32 s75, s30, 8
    s_add_u32 s75, s75, 160832
    v_and_b32 v25, 15, v0
    v_lshlrev_b32 v25, 4, v25
    v_add_u32 v25, s75, v25
    ds_read_b128 v[28:31], v25
    s_add_u32 s39, s39, 1
    s_add_u32 s76, s86, s39
    s_add_u32 s76, s76, 0x20
    s_lshl_b32 s75, s29, 4
    s_lshl_b32 s77, s30, 2
    s_add_u32 s75, s75, s77
    s_add_u32 s75, s75, s65
    v_mov_b32 v24, s76
    v_mov_b32 v26, 0
    s_waitcnt vmcnt(0)
    s_cmp_eq_u32 s36, 0
    s_cbranch_scc0 WS_35
    s_mov_b32 exec_lo, 0x1
    s_mov_b32 exec_hi, 0x0
    buffer_store_dword v24, v26, s[4:7], s75 offen
    s_mov_b64 exec, -1
WT_36:
    s_waitcnt lgkmcnt(0)
    buffer_load_dword v27, v29, s[4:7], s65 offen sc1
    s_lshl_b32 s20, s33, 2
    s_add_u32 s20, s20, s101
    s_cmp_eq_u32 s20, 15
    s_cbranch_scc0 XH_39
    s_add_u32 s20, s86, 2
    v_mov_b32 v32, s20
    s_lshl_b32 s20, s28, 7
    s_lshl_b32 s21, s34, 2
    s_add_u32 s20, s20, s21
    s_add_u32 s20, s20, 65997824
    s_mov_b32 exec_lo, 0x1
    s_mov_b32 exec_hi, 0x0
    buffer_store_dword v32, v26, s[4:7], s20 offen sc1
    s_mov_b64 exec, -1
XH_39:
    s_waitcnt vmcnt(0)
    v_subrev_u32 v27, s76, v27
    v_cmp_le_u32 s[84:85], 8, v27
    s_nop 1
    s_cmp_eq_u64 s[84:85], 0
    s_cbranch_scc1 WK_37
    s_mov_b32 s83, 0
WP_38:
    buffer_load_dword v27, v29, s[4:7], s65 offen sc1
    s_add_u32 s83, s83, 1
    s_cmp_gt_u32 s83, 200000
    s_cbranch_scc1 L_END
    s_waitcnt vmcnt(0)
    v_subrev_u32 v27, s76, v27
    v_cmp_le_u32 s[84:85], 8, v27
    s_nop 1
    s_cmp_eq_u64 s[84:85], 0
    s_cbranch_scc0 WP_38
WK_37:
    s_mov_b32 s35, 1
    s_mov_b32 s87, s61
    s_mov_b32 s55, s37
    s_mul_i32 s54, s35, 1556480
    s_add_u32 s54, s54, 3457024
    s_mul_i32 s54, s54, s36
    s_add_u32 s54, s54, s37
    s_nop 7
    s_nop 7
    s_branch L_P1_L1
FO_33:
    v_and_b32 v24, 15, v0
    v_lshrrev_b32 v25, 4, v0
    v_mul_u32_u24 v24, 1280, v24
    v_lshlrev_b32 v25, 3, v25
    v_add_u32 v24, v24, v25
    s_lshl_b32 s75, s28, 8
    s_lshl_b32 s76, s33, 6
    s_add_u32 s75, s75, s76
    s_lshl_b32 s76, s101, 4
    s_add_u32 s75, s75, s76
    s_mul_i32 s75, s75, 1280
    s_mul_i32 s76, s34, 160
    s_add_u32 s75, s75, s76
    buffer_store_dwordx2 v[2:3], v24, s[12:15], s75 offen offset:0
    buffer_store_dwordx2 v[4:5], v24, s[12:15], s75 offen offset:32
    buffer_store_dwordx2 v[6:7], v24, s[12:15], s75 offen offset:64
    buffer_store_dwordx2 v[8:9], v24, s[12:15], s75 offen offset:96
    buffer_store_dwordx2 v[10:11], v24, s[12:15], s75 offen offset:128
L_END:
    s_waitcnt vmcnt(0)
    s_endpgm
WS_21:
    buffer_wbl2 sc1
    s_waitcnt vmcnt(0)
    s_mov_b32 exec_lo, 0x1
    s_mov_b32 exec_hi, 0x0
    buffer_store_dword v24, v26, s[4:7], s75 offen sc1
    s_mov_b64 exec, -1
    s_branch WT_22
WS_25:
    buffer_wbl2 sc1
    s_waitcnt vmcnt(0)
    s_mov_b32 exec_lo, 0x1
    s_mov_b32 exec_hi, 0x0
    buffer_store_dword v24, v26, s[4:7], s75 offen sc1
    s_mov_b64 exec, -1
    s_branch WT_26
WS_29:
    buffer_wbl2 sc1
    s_waitcnt vmcnt(0)
    s_mov_b32 exec_lo, 0x1
    s_mov_b32 exec_hi, 0x0
    buffer_store_dword v24, v26, s[4:7], s75 offen sc1
    s_mov_b64 exec, -1
    s_branch WT_30
WS_35:
    buffer_wbl2 sc1
    s_waitcnt vmcnt(0)
    s_mov_b32 exec_lo, 0x1
    s_mov_b32 exec_hi, 0x0
    buffer_store_dword v24, v26, s[4:7], s75 offen sc1
    s_mov_b64 exec, -1
    s_branch WT_36
.p2align 6
.type relayout_tab,@object
relayout_tab:
.long 0, 15360, 30720, 46080, 61440, 76800, 92160, 107520, 3840, 52, 5, 1280, 15, 80, 122880, 2457600
.long 0, 13824, 0, 13824, 27648, 41472, 27648, 41472, 3456, 32, 8, 55296, 16, 128, 110592, 2211840
.long 0, 10240, 5120, 15360, 20480, 30720, 25600, 35840, 1280, 16, 16, 0, 16, 256, 40960, 2211840
.long 0, 25600, 5120, 30720, 10240, 35840, 15360, 40960, 1280, 16, 16, 0, 16, 256, 51200, 819200
.long 20480, 46080, 71680, 97280, 122880, 148480, 174080, 199680, 1280, 16, 16, 0, 16, 256, 204800, 819200
.long 0, 20480, 40960, 61440, 81920, 102400, 122880, 143360
.long 0, 40960, 81920, 122880, 1024, 41984, 82944, 123904
.long 0, 1024, 2048, 3072, 4096, 276480, 277504, 278528
.long 279552, 280576, 552960, 553984, 555008, 556032, 557056, 829440
.long 830464, 831488, 832512, 833536, 1105920, 1106944, 1107968, 1108992
.long 1110016, 1382400, 1383424, 1384448, 1385472, 1386496, 1658880, 1659904
.long 1660928, 1661952, 1662976, 1935360, 1936384, 1937408, 1938432, 1939456
.long 0, 1024, 2048, 3072, 4096, 102400, 103424, 104448
.long 105472, 106496, 204800, 205824, 206848, 207872, 208896, 307200
.long 308224, 309248, 310272, 311296, 409600, 410624, 411648, 412672
.long 413696, 512000, 513024, 514048, 515072, 516096, 614400, 615424
.long 616448, 617472, 618496, 716800, 717824, 718848, 719872, 720896
.long 0, 1, 32, 33, 2, 3, 34, 4, 5, 35, 36, 6, 7, 37, 8, 9, 38, 39, 10, 11, 40, 12, 13, 41, 42, 14, 15, 43, 16, 17, 44, 45, 18, 19, 46, 20, 21, 47, 48, 22, 23, 49, 24, 25, 50, 26, 27, 51, 28, 29, 52, 30, 31, 53, 0, 0
.size relayout_tab, 928
.section .rodata,"a"
.p2align 6
.amdhsa_kernel interleave_layers__sliding_local_dilated__glu_gated_geglu__prompt_kernel
  .amdhsa_next_free_vgpr 512
  .amdhsa_next_free_sgpr 102
  .amdhsa_accum_offset 256
  .amdhsa_group_segment_fixed_size 0
  .amdhsa_kernarg_size 80
  .amdhsa_user_sgpr_count 2
  .amdhsa_user_sgpr_kernarg_segment_ptr 1
  .amdhsa_system_sgpr_workgroup_id_x 1
.end_amdhsa_kernel
```
